```python
import torch

def _softmax(x, axis=-1):
    return torch.softmax(x, dim=axis)
def _gelu(x):
    return torch.nn.functional.gelu(x, approximate="tanh")
def _silu(x):
    return torch.nn.functional.silu(x)
def _sigmoid(x):
    return torch.sigmoid(x)
def _layernorm(x, axis=-1, eps=1e-5):
    m = x.mean(dim=axis, keepdim=True)
    v = x.var(dim=axis, keepdim=True, unbiased=False)
    return (x - m) / torch.sqrt(v + eps)
def _scatter_add(tgt, idx, src, axis=0):
    return tgt.clone().index_add_(axis, idx, src)
def _segment_sum(src, seg, n):
    out = torch.zeros((n,) + src.shape[1:], dtype=src.dtype)
    return out.index_add_(0, seg, src)
def _pad(x, pw):
    flat = tuple(v for pair in reversed(pw) for v in pair)
    return torch.nn.functional.pad(x, flat)

kernel_name = 'gated_mix__spectral_gfnet__linear_attn_block__prompt'

def setup_inputs():

    _w = (lambda a: (lambda t: t.to(torch.bfloat16) if t.is_floating_point() else t)(torch.as_tensor(a)))
    def _A_setup():
        B, S, D = 1, 2048, 640
        Df = D // 2 + 1
        return {
            "x": _w((lambda *s: torch.randn(*s, dtype=torch.bfloat16) * 0.05)(B, S, D)),
            "w_r": _w((lambda *s: torch.randn(*s, dtype=torch.bfloat16) * 1.6)(S, Df) * 0.02),
            "w_i": _w((lambda *s: torch.randn(*s, dtype=torch.bfloat16) * 1.6)(S, Df) * 0.02),
        }
    _A_in = _A_setup()

    def _B_setup():
        B, S, D = 1, 2048, 640
        return {
            "x": _w((lambda *s: torch.randn(*s, dtype=torch.bfloat16) * 0.05)(B, S, D)),
            "wqkv": _w((lambda *s: torch.randn(*s, dtype=torch.bfloat16) * 0.4)(D, 3 * D)),
            "wo": _w((lambda *s: torch.randn(*s, dtype=torch.bfloat16) * 0.05)(D, D)),
        }
    _B_in = _B_setup()

    return {
        "A_x": _A_in["x"],
        "A_w_r": _A_in["w_r"],
        "A_w_i": _A_in["w_i"],
        "B_x": _B_in["x"],
        "B_wqkv": _B_in["wqkv"],
        "B_wo": _B_in["wo"],
        "gate_w": _w((lambda *s: torch.randn(*s, dtype=torch.bfloat16) * 0.05)(640) * 16.0),
    }

def reference(A_x, A_w_r, A_w_i, B_x, B_wqkv, B_wo, gate_w):
    def _A_ref(x, w_r, w_i):
        B, S, D = x.shape
        X = (lambda x, axes=(-2,-1): torch.fft.rfft2(x.float(), dim=axes))(x, axes=(-2, -1))
        W = w_r + 1j * w_i
        X = X * W
        y = (lambda x, s, axes=(-2,-1): torch.fft.irfft2(x, s=s, dim=axes).to(torch.bfloat16))(X, (S, D), axes=(-2, -1))
        return y

    def _B_ref(x, wqkv, wo):
        B, S, D = x.shape
        H = 32; Dh = D // H
        qkv = (lambda x, *d: x.permute(*d))((x @ wqkv).reshape(B, S, 3, H, Dh), 2, 0, 3, 1, 4)
        q, k, v = qkv[0], qkv[1], qkv[2]
        phi = lambda t: torch.where(t > 0, t + 1, torch.exp(t)) + 1e-6
        pq, pk = phi(q), phi(k)
        kv = torch.einsum("bhsd,bhse->bhde", pk, v)
        z = torch.einsum("bhsd->bhd", pk)
        num = torch.einsum("bhqd,bhde->bhqe", pq, kv)
        den = torch.einsum("bhqd,bhd->bhq", pq, z)[..., None] + 1e-6
        o = num / den
        return (lambda x, *d: x.permute(*d))(o, 0, 2, 1, 3).reshape(B, S, D) @ wo

    x = A_x
    g = _sigmoid((x * gate_w).sum(-1, keepdims=True))
    a = _A_ref(x, A_w_r, A_w_i)
    b = _B_ref(x, B_wqkv, B_wo)
    return g * a + (1 - g) * b
```

```asm
; @launch grid=(256,1,1) block=(256,1,1) lds=159808
.amdgcn_target "amdgcn-amd-amdhsa--gfx950"
.text
.globl gated_mix__spectral_gfnet__linear_attn_block__prompt_kernel
.p2align 8
.type gated_mix__spectral_gfnet__linear_attn_block__prompt_kernel,@function
gated_mix__spectral_gfnet__linear_attn_block__prompt_kernel:
Lstart:
    s_cmp_ge_u32 s2, 256
    s_cbranch_scc1 Lend
    s_load_dwordx16 s[68:83], s[0:1], 0
    s_load_dwordx4 s[84:87], s[0:1], 64
    v_lshrrev_b32 v4, 6, v0
    v_and_b32 v1, 63, v0
    v_readfirstlane_b32 s40, v4
    s_getpc_b64 s[36:37]
Lpc:
    s_add_u32 s24, s36, tab_base@rel32@lo+4
    s_addc_u32 s25, s37, tab_base@rel32@hi+12
    s_mov_b32 s38, Lfin-Lpc
    s_mov_b32 s39, 0x20000
    v_lshlrev_b32 v9, 4, v1
    s_lshr_b32 s62, s2, 3
    s_and_b32 s63, s2, 7
    s_lshl_b32 s64, s62, 10
    s_cmp_eq_u32 s40, 3
    s_cbranch_scc0 Lnocpf
    buffer_load_dwordx4 v[96:99], v9, s[36:39], s64 offen
Lnocpf:
    v_and_b32 v2, 15, v1
    v_lshrrev_b32 v3, 4, v1
    s_lshr_b32 s44, s63, 2
    s_lshl_b32 s44, s44, 3
    s_lshr_b32 s64, s62, 2
    s_add_u32 s44, s44, s64
    s_and_b32 s41, s40, 1
    s_lshr_b32 s42, s40, 1
    v_and_b32 v5, 7, v1
    v_xor_b32 v5, v5, v3
    v_lshrrev_b32 v4, 3, v1
    v_mul_u32_u24 v4, 40960, v4
    v_lshl_add_u32 v180, v5, 4, v4
    v_xor_b32 v181, 64, v180
    s_lshl_b32 s65, s44, 1
    s_add_u32 s65, s65, s42
    s_mul_i32 s65, s65, 1280
    s_mul_i32 s64, s41, 1310720
    s_add_u32 s98, s65, s64
    s_bfe_u32 s43, s62, 0x10001
    s_and_b32 s45, s63, 3
    s_lshl_b32 s45, s45, 1
    s_and_b32 s64, s62, 1
    s_add_u32 s45, s45, s64
    s_lshl_b32 s58, s63, 2
    s_lshr_b32 s64, s62, 3
    s_add_u32 s58, s58, s64
    s_and_b32 s59, s62, 7
    s_lshr_b32 s64, s62, 2
    s_and_b32 s64, s64, 7
    s_mul_i32 s64, s64, 5
    s_and_b32 s65, s62, 3
    s_mul_i32 s65, s65, 10
    s_add_u32 s64, s64, s65
    s_and_b32 s65, s63, 3
    s_mul_i32 s65, s65, 10
    s_add_u32 s64, s64, s65
    s_lshr_b32 s65, s63, 2
    s_mul_i32 s65, s65, 20
    s_add_u32 s64, s64, s65
    s_lshr_b32 s64, s64, 2
    s_mul_i32 s65, s64, 26
    s_lshr_b32 s65, s65, 8
    s_mul_i32 s65, s65, 10
    s_sub_u32 s54, s64, s65
    s_lshl_b32 s51, s40, 12
    s_lshl_b32 s48, s54, 7
    s_add_u32 s48, s48, s98
    s_mov_b32 s26, 854016
    s_mov_b32 s27, 0x20000
    s_cmp_eq_u32 s43, 0
    s_cbranch_scc0 LefF
    s_mov_b32 s65, 851968
    buffer_load_dwordx4 v[200:203], v9, s[24:27], s65 offen offset:0
    buffer_load_dwordx4 v[204:207], v9, s[24:27], s65 offen offset:1024
    s_branch LefT
LefF:
    s_cmp_eq_u32 s42, 0
    s_cbranch_scc0 LefT
    s_mov_b32 s65, 835584
    buffer_load_dwordx4 a[120:123], v9, s[24:27], s65 offen offset:0
    buffer_load_dwordx4 a[124:127], v9, s[24:27], s65 offen offset:1024
    buffer_load_dwordx4 a[128:131], v9, s[24:27], s65 offen offset:2048
    buffer_load_dwordx4 a[132:135], v9, s[24:27], s65 offen offset:3072
    s_mov_b32 s65, 839680
    buffer_load_dwordx4 a[136:139], v9, s[24:27], s65 offen offset:0
    buffer_load_dwordx4 a[140:143], v9, s[24:27], s65 offen offset:1024
    buffer_load_dwordx4 a[144:147], v9, s[24:27], s65 offen offset:2048
    buffer_load_dwordx4 a[148:151], v9, s[24:27], s65 offen offset:3072
LefT:
    s_andn2_b32 s62, s43, s42
    s_sub_u32 s63, 1, s43
    s_add_u32 s64, s42, 1
    s_mul_i32 s63, s63, s64
    s_mul_i32 s63, s63, 1280
    s_mul_i32 s64, s45, 160
    s_add_u32 s63, s63, s64
    s_mul_i32 s64, s41, 122880
    s_add_u32 s63, s63, s64
    s_mul_i32 s64, s45, 102400
    s_mul_i32 s65, s41, 5120
    s_add_u32 s64, s64, s65
    s_mul_i32 s52, s42, 10256
    s_add_u32 s52, s52, s65
    s_add_u32 s52, s52, 16384
    s_cmp_eq_u32 s62, 1
    s_cselect_b32 s63, s64, s63
    s_mov_b32 s50, 245760
    s_cselect_b32 s50, 10240, s50
    s_cselect_b64 s[66:67], -1, 0
    s_mul_i32 s49, s54, s50
    s_mov_b32 s64, 3840
    v_add_u32 v4, 0, v1
    v_mul_u32_u24 v5, 0x199a, v4
    v_lshrrev_b32 v5, 16, v5
    v_lshlrev_b32 v4, 4, v4
    v_mul_u32_u24 v6, 160, v5
    v_sub_u32 v6, v4, v6
    v_and_b32 v7, 3, v5
    v_bfe_u32 v8, v5, 2, 2
    v_lshl_or_b32 v7, v8, 3, v7
    v_lshrrev_b32 v8, 4, v5
    v_lshl_or_b32 v7, v8, 2, v7
    v_mad_u32_u24 v7, v7, s64, v6
    v_cndmask_b32 v7, v7, v4, s[66:67]
    v_add_u32 v184, s63, v7
    s_waitcnt lgkmcnt(0)
    s_mov_b32 s4, s68
    s_mov_b32 s5, s69
    s_mov_b32 s6, 2621440
    s_mov_b32 s7, 0x20000
    s_cmp_eq_u32 s62, 1
    s_cselect_b32 s8, s24, s76
    s_cselect_b32 s9, s25, s77
    s_mov_b32 s10, 2457600
    s_cselect_b32 s10, 819200, s10
    s_mov_b32 s11, 0x20000
    s_add_u32 m0, s51, 0
    s_add_u32 s65, s48, 0
    buffer_load_dwordx4 v180, s[4:7], s65 offen  lds
    v_add_u32 v4, 64, v1
    v_mul_u32_u24 v5, 0x199a, v4
    v_lshrrev_b32 v5, 16, v5
    v_lshlrev_b32 v4, 4, v4
    v_mul_u32_u24 v6, 160, v5
    v_sub_u32 v6, v4, v6
    v_and_b32 v7, 3, v5
    v_bfe_u32 v8, v5, 2, 2
    v_lshl_or_b32 v7, v8, 3, v7
    v_lshrrev_b32 v8, 4, v5
    v_lshl_or_b32 v7, v8, 2, v7
    v_mad_u32_u24 v7, v7, s64, v6
    v_cndmask_b32 v7, v7, v4, s[66:67]
    v_add_u32 v185, s63, v7
    s_add_u32 m0, s51, 1024
    s_add_u32 s65, s48, 327680
    buffer_load_dwordx4 v181, s[4:7], s65 offen  lds
    v_add_u32 v4, 128, v1
    v_mul_u32_u24 v5, 0x199a, v4
    v_lshrrev_b32 v5, 16, v5
    v_lshlrev_b32 v4, 4, v4
    v_mul_u32_u24 v6, 160, v5
    v_sub_u32 v6, v4, v6
    v_and_b32 v7, 3, v5
    v_bfe_u32 v8, v5, 2, 2
    v_lshl_or_b32 v7, v8, 3, v7
    v_lshrrev_b32 v8, 4, v5
    v_lshl_or_b32 v7, v8, 2, v7
    v_mad_u32_u24 v7, v7, s64, v6
    v_cndmask_b32 v7, v7, v4, s[66:67]
    v_add_u32 v186, s63, v7
    s_add_u32 m0, s51, 2048
    s_add_u32 s65, s48, 655360
    buffer_load_dwordx4 v180, s[4:7], s65 offen  lds
    v_add_u32 v4, 192, v1
    v_mul_u32_u24 v5, 0x199a, v4
    v_lshrrev_b32 v5, 16, v5
    v_lshlrev_b32 v4, 4, v4
    v_mul_u32_u24 v6, 160, v5
    v_sub_u32 v6, v4, v6
    v_and_b32 v7, 3, v5
    v_bfe_u32 v8, v5, 2, 2
    v_lshl_or_b32 v7, v8, 3, v7
    v_lshrrev_b32 v8, 4, v5
    v_lshl_or_b32 v7, v8, 2, v7
    v_mad_u32_u24 v7, v7, s64, v6
    v_cndmask_b32 v7, v7, v4, s[66:67]
    v_add_u32 v187, s63, v7
    s_add_u32 m0, s51, 3072
    s_add_u32 s65, s48, 983040
    buffer_load_dwordx4 v181, s[4:7], s65 offen  lds
    v_add_u32 v4, 256, v1
    v_mul_u32_u24 v5, 0x199a, v4
    v_lshrrev_b32 v5, 16, v5
    v_lshlrev_b32 v4, 4, v4
    v_mul_u32_u24 v6, 160, v5
    v_sub_u32 v6, v4, v6
    v_and_b32 v7, 3, v5
    v_bfe_u32 v8, v5, 2, 2
    v_lshl_or_b32 v7, v8, 3, v7
    v_lshrrev_b32 v8, 4, v5
    v_lshl_or_b32 v7, v8, 2, v7
    v_mad_u32_u24 v7, v7, s64, v6
    v_cndmask_b32 v7, v7, v4, s[66:67]
    v_add_u32 v188, s63, v7
    s_add_u32 m0, s52, 0
    s_nop 0
    buffer_load_dwordx4 v184, s[8:11], s49 offen  lds
    s_mov_b32 s12, s86
    s_mov_b32 s13, s87
    s_mov_b32 s14, 9470080
    s_mov_b32 s15, 0x20000
    s_mov_b32 s28, s78
    s_mov_b32 s29, s79
    s_mov_b32 s30, 819200
    s_add_u32 m0, s52, 1024
    s_nop 0
    buffer_load_dwordx4 v185, s[8:11], s49 offen  lds
    s_mov_b32 s31, 0x20000
    s_lshl_b32 s55, s2, 2
    s_add_u32 s55, s55, s40
    s_mul_i32 s62, s55, 1639
    s_lshr_b32 s62, s62, 16
    s_mul_i32 s63, s62, 40
    s_sub_u32 s63, s55, s63
    s_mul_i32 s64, s63, 52
    s_add_u32 m0, s52, 2048
    s_nop 0
    buffer_load_dwordx4 v186, s[8:11], s49 offen  lds
    s_lshr_b32 s64, s64, 8
    s_mul_i32 s96, s64, 5
    s_sub_u32 s63, s63, s96
    s_mul_i32 s64, s64, 80
    s_lshl_b32 s62, s62, 2
    v_bfe_u32 v4, v1, 3, 2
    v_add_u32 v4, s62, v4
    v_mul_u32_u24 v5, 0x3334, v4
    s_add_u32 m0, s52, 3072
    s_nop 0
    buffer_load_dwordx4 v187, s[8:11], s49 offen  lds
    v_lshrrev_b32 v5, 16, v5
    v_lshrrev_b32 v6, 5, v1
    v_add_u32 v5, v5, v6
    v_mul_u32_u24 v5, 20, v5
    v_lshl_add_u32 v5, v4, 2, v5
    v_bfe_u32 v4, v1, 1, 2
    v_add_u32 v5, v5, v4
    s_lshr_b32 s62, s63, 1
    s_add_u32 m0, s52, 4096
    s_nop 0
    buffer_load_dwordx4 v188, s[8:11], s49 offen  lds
    s_mul_i32 s62, s62, 640
    s_and_b32 s96, s63, 1
    s_lshl_b32 s96, s96, 5
    s_add_u32 s62, s62, s96
    s_movk_i32 s96, 640
    s_cmp_eq_u32 s63, 4
    s_cselect_b32 s62, 64, s62
    s_cselect_b32 s63, s96, 16
    v_and_b32 v4, 1, v1
    v_mul_u32_u24 v4, s63, v4
    s_add_u32 s54, s54, 1
    s_cmp_eq_u32 s54, 10
    s_cselect_b32 s54, 0, s54
    s_lshl_b32 s48, s54, 7
    s_add_u32 s48, s48, s98
    s_mul_i32 s49, s54, s50
    s_add_u32 s51, s51, 36880
    s_add_u32 s52, s52, 36880
    s_movk_i32 s63, 1280
    v_mad_u32_u24 v213, v5, s63, v4
    s_add_u32 s62, s62, s64
    s_cmp_lt_u32 s2, 200
    s_cselect_b32 s96, s62, 2146435072
    s_lshl_b32 s62, s55, 6
    s_add_u32 s53, s62, 7864320
    v_lshlrev_b32 v217, 2, v1
    v_mov_b32 v212, 0
    s_mov_b32 s92, s96
    s_mov_b32 s93, s53
    v_mov_b32 v176, v213
    v_mov_b32 v177, v217
    s_mov_b32 s16, s70
    s_mov_b32 s17, s71
    s_mov_b32 s18, 1314816
    s_mov_b32 s19, 0x20000
    s_mov_b32 s20, s72
    s_mov_b32 s21, s73
    s_mov_b32 s22, 1314816
    s_mov_b32 s23, 0x20000
    s_mov_b32 s36, s80
    s_mov_b32 s37, s81
    s_mov_b32 s38, 1280
    s_mov_b32 s39, 0x20000
    s_mov_b32 s32, s82
    s_mov_b32 s33, s83
    s_mov_b32 s34, 2621440
    s_mov_b32 s35, 0x20000
    v_mov_b32 v5, 0
    v_lshlrev_b32 v4, 2, v2
    v_add_u32 v4, 155648, v4
    ds_write_b32 v4, v5
    v_lshrrev_b32 v4, 1, v2
    v_xor_b32 v4, v4, v3
    v_lshlrev_b32 v4, 4, v4
    v_lshl_add_u32 v4, v2, 7, v4
    s_lshl_b32 s62, s41, 13
    v_add_u32 v189, s62, v4
    v_xor_b32 v190, 64, v189
    v_lshrrev_b32 v4, 2, v1
    v_mul_u32_u24 v4, 160, v4
    v_and_b32 v5, 3, v1
    v_lshlrev_b32 v5, 3, v5
    v_add_u32 v4, v4, v5
    s_mul_i32 s62, s42, 80
    s_mul_i32 s63, s42, 10256
    s_cmp_eq_u32 s43, 0
    s_cselect_b32 s62, s62, s63
    s_cselect_b32 s63, 10176, 0
    s_add_u32 s62, s62, 16384
    v_add_u32 v191, s62, v4
    v_add_u32 v192, 32, v191
    v_mov_b32 v6, s63
    v_cmp_lt_u32 vcc, 8, v5
    s_nop 1
    v_cndmask_b32 v6, 0, v6, vcc
    v_add3_u32 v193, v191, v6, 64
    v_add_u32 v4, s63, v191
    v_add_u32 v194, 96, v4
    v_add_u32 v195, 0x80, v4
    s_lshr_b32 s62, s44, 1
    s_lshl_b32 s62, s62, 3
    s_add_u32 s62, s62, s45
    s_lshr_b32 s63, s62, 5
    s_add_u32 s63, s63, 8
    s_bfe_u32 s64, s62, 0x10004
    s_mul_i32 s64, s64, 10
    s_add_u32 s63, s63, s64
    s_and_b32 s57, s44, 3
    s_lshr_b32 s64, s44, 3
    s_lshl_b32 s64, s64, 2
    s_add_u32 s57, s57, s64
    s_bfe_u32 s64, s44, 0x10002
    s_mul_i32 s64, s64, 10
    s_add_u32 s57, s57, s64
    s_and_b32 s64, s62, 15
    s_lshl_b32 s64, s64, 1
    s_add_u32 s64, s64, s41
    s_lshl_b32 s62, s45, 2
    s_add_u32 s62, s62, s40
    s_cmp_eq_u32 s43, 0
    s_cselect_b32 s56, s62, s64
    s_cselect_b32 s57, s57, s63
    s_or_b32 s62, s44, s42
    s_and_b32 s62, s62, s43
    s_xor_b32 s60, s62, 1
    s_lshl_b32 s62, s57, 6
    s_cmp_ge_u32 s57, 10
    s_cselect_b32 s63, 638, 0
    s_sub_u32 s62, s62, s63
    s_cmp_eq_u32 s60, 1
    s_cselect_b32 s62, s62, 2146435072
    s_mov_b32 s63, 164352
    v_lshlrev_b32 v10, 2, v2
    v_add_u32 v10, s62, v10
    v_mad_u32_u24 v214, v3, s63, v10
    v_sub_u32 v11, 3, v3
    v_mad_u32_u24 v215, v11, s63, v10
    s_movk_i32 s64, 1024
    s_cmp_eq_u32 s56, 0
    s_cselect_b32 s62, 657408, 0
    s_cselect_b32 s64, 32, s64
    v_mov_b32 v11, s62
    v_cmp_eq_u32 vcc, 0, v3
    s_nop 1
    v_cndmask_b32 v11, 0, v11, vcc
    v_sub_u32 v11, 164352, v11
    v_add_u32 v216, v215, v11
    s_add_u32 s64, s64, s56
    s_mul_i32 s94, s56, 642
    s_mul_i32 s95, s64, 642
    v_mul_u32_u24 v4, 41088, v2
    v_mov_b32 v5, s94
    v_mov_b32 v6, s95
    v_and_b32 v7, 16, v1
    v_cmp_eq_u32 vcc, 0, v7
    s_nop 1
    v_cndmask_b32 v5, v6, v5, vcc
    v_add_u32 v4, v4, v5
    v_sub_u32 v5, 1314816, v4
    v_mov_b32 v6, 657408
    v_cmp_eq_u32 vcc, 0, v4
    s_nop 1
    v_cndmask_b32 v5, v5, v6, vcc
    v_cmp_gt_u32 vcc, 32, v1
    s_nop 1
    v_cndmask_b32 v4, v5, v4, vcc
    s_cmp_eq_u32 s57, 0
    s_cselect_b32 s62, 0, 2146435072
    v_add_u32 v254, s62, v4
    v_mov_b32 v208, 2146435072
    v_mov_b32 v209, 2146435072
    v_mov_b32 v210, 2146435072
    v_mov_b32 v211, 2146435072
    s_mul_i32 s62, s41, 1
    s_mul_i32 s63, s41, 9
    s_add_u32 s63, s63, 2
    s_cmp_eq_u32 s42, 0
    s_cselect_b32 s101, s62, s63
    s_cselect_b32 s64, 4, 44
    s_mul_i32 s62, s59, 5120
    s_mul_i32 s63, s101, 40960
    s_add_u32 s62, s62, s63
    s_add_u32 s99, s62, 7929856
    s_add_u32 s100, s99, 368640
    s_mov_b32 s85, 0
    s_min_u32 s84, s85, 8
    s_cmp_eq_u32 s42, 0
    s_cselect_b32 s84, 0, s84
    s_mul_i32 s62, s84, 40960
    s_add_u32 s96, s99, s62
    v_min_u32 v9, s64, v1
    v_lshlrev_b32 v4, 3, v1
    s_lshl_b32 s62, s40, 10
    s_add_u32 s62, s62, 155712
    v_add_u32 v213, s62, v4
    s_lshl_b32 s62, s55, 10
    s_add_u32 s62, s62, 7929856
    s_cmp_lt_u32 s2, 200
    s_cselect_b32 s97, s62, 2146435072
    s_lshl_b32 s62, s55, 2
    s_add_u32 s62, s62, 9076736
    v_mov_b32 v217, s62
    v_mov_b32 v4, v9
    v_mul_u32_u24 v5, 52, v4
    v_lshrrev_b32 v5, 8, v5
    v_mad_u32_u24 v4, v5, 35, v4
    s_mul_i32 s62, s101, 40
    s_mul_i32 s63, s59, 5
    s_add_u32 s62, s62, s63
    v_add_u32 v4, s62, v4
    v_lshlrev_b32 v4, 2, v4
    v_add_u32 v196, 9076736, v4
    s_lshl_b32 s62, s45, 1
    s_add_u32 s62, s62, s42
    s_lshl_b32 s62, s62, 8
    s_add_u32 s62, s62, 9076736
    v_lshlrev_b32 v4, 2, v1
    v_add_u32 v197, s62, v4
    v_lshlrev_b32 v218, 4, v1
    v_add_u32 v219, 0x1000, v218
    s_cmp_eq_u32 s43, 0
    s_cbranch_scc0 LsetFQ
    s_lshl_b32 s62, s42, 13
    s_mul_i32 s63, s41, 1792
    s_add_u32 s62, s62, s63
    s_add_u32 s62, s62, 0
    v_lshlrev_b32 v4, 2, v1
    v_add_u32 v208, s62, v4
    s_lshl_b32 s62, s45, 1
    s_add_u32 s62, s62, s42
    s_lshl_b32 s62, s62, 12
    s_add_u32 s62, s62, s63
    s_add_u32 s62, s62, 7864320
    v_add_u32 v209, s62, v4
    s_cmp_eq_u32 s41, 0
    s_cselect_b32 s63, 64, 8
    v_cmp_gt_u32 vcc, s63, v1
    s_nop 1
    v_cndmask_b32 v210, v210, v209, vcc
    s_lshl_b32 s62, s45, 2
    s_add_u32 s62, s62, s40
    s_lshl_b32 s62, s62, 4
    s_add_u32 s62, s62, s44
    s_lshl_b32 s62, s62, 7
    s_add_u32 s62, s62, 8953856
    v_mov_b32 v211, s62
    s_branch Lsetdone
LsetFQ:
    s_cmp_eq_u32 s42, 0
    s_cbranch_scc0 Lsetdone
    s_lshl_b32 s62, s44, 1
    s_add_u32 s62, s62, s41
    s_mul_i32 s62, s62, 5120
    s_mul_i32 s63, s45, 640
    s_add_u32 s62, s62, s63
    s_mov_b32 s63, 163840
    v_lshlrev_b32 v4, 3, v2
    v_mad_u32_u24 v4, v3, s63, v4
    v_add_u32 v208, s62, v4
    s_lshl_b32 s62, s45, 1
    s_add_u32 s62, s62, s41
    s_lshl_b32 s62, s62, 4
    s_add_u32 s62, s62, s44
    s_lshl_b32 s62, s62, 7
    s_add_u32 s62, s62, 8921088
    v_mov_b32 v211, s62
Lsetdone:
    s_and_b32 s62, s43, s42
    s_or_b32 s62, s62, s56
    s_cmp_eq_u32 s62, 0
    s_cbranch_scc0 Lnotb
    s_mov_b32 s62, 819200
    buffer_load_dwordx4 a[192:195], v218, s[24:27], s62 offen offset:0
    buffer_load_dwordx4 a[196:199], v218, s[24:27], s62 offen offset:1024
    buffer_load_dwordx4 a[200:203], v218, s[24:27], s62 offen offset:2048
    buffer_load_dwordx4 a[204:207], v218, s[24:27], s62 offen offset:3072
    s_mov_b32 s62, 823296
    buffer_load_dwordx4 a[208:211], v218, s[24:27], s62 offen offset:0
    buffer_load_dwordx4 a[212:215], v218, s[24:27], s62 offen offset:1024
    buffer_load_dwordx4 a[216:219], v218, s[24:27], s62 offen offset:2048
    buffer_load_dwordx4 a[220:223], v218, s[24:27], s62 offen offset:3072
    s_mov_b32 s62, 827392
    buffer_load_dwordx4 a[224:227], v218, s[24:27], s62 offen offset:0
    buffer_load_dwordx4 a[228:231], v218, s[24:27], s62 offen offset:1024
    buffer_load_dwordx4 a[232:235], v218, s[24:27], s62 offen offset:2048
    buffer_load_dwordx4 a[236:239], v218, s[24:27], s62 offen offset:3072
    s_mov_b32 s62, 831488
    buffer_load_dwordx4 a[240:243], v218, s[24:27], s62 offen offset:0
    buffer_load_dwordx4 a[244:247], v218, s[24:27], s62 offen offset:1024
    buffer_load_dwordx4 a[248:251], v218, s[24:27], s62 offen offset:2048
    buffer_load_dwordx4 a[252:255], v218, s[24:27], s62 offen offset:3072
Lnotb:
    s_mul_i32 s62, s42, 160
    s_add_u32 s62, s62, s41
    v_lshlrev_b32 v123, 3, v3
    v_add_u32 v123, s62, v123
    s_mul_i32 s63, s59, 40
    v_add_u32 v124, 0, v2
    v_add_u32 v124, s63, v124
    v_mul_u32_u24 v125, v124, v123
    v_cvt_f32_u32 v125, v125
    v_cvt_f32_u32 v124, v124
    v_mul_f32 v120, 0x3acccccd, v125
    v_cos_f32 v100, v120
    v_sin_f32 v101, v120
    v_mul_f32 v121, 0x3b4ccccd, v124
    v_cos_f32 v106, v121
    v_sin_f32 v107, v121
    v_mul_f32 v122, 0x3d4ccccd, v124
    v_cos_f32 v112, v122
    v_sin_f32 v113, v122
    v_add_u32 v124, 16, v2
    v_add_u32 v124, s63, v124
    v_mul_u32_u24 v125, v124, v123
    v_cvt_f32_u32 v125, v125
    v_cvt_f32_u32 v124, v124
    v_mul_f32 v120, 0x3acccccd, v125
    v_cos_f32 v102, v120
    v_sin_f32 v103, v120
    v_mul_f32 v121, 0x3b4ccccd, v124
    v_cos_f32 v108, v121
    v_sin_f32 v109, v121
    v_mul_f32 v122, 0x3d4ccccd, v124
    v_cos_f32 v114, v122
    v_sin_f32 v115, v122
    v_and_b32 v124, 7, v2
    v_add_u32 v124, 32, v124
    v_add_u32 v124, s63, v124
    v_mul_u32_u24 v125, v124, v123
    v_cvt_f32_u32 v125, v125
    v_cvt_f32_u32 v124, v124
    v_mul_f32 v120, 0x3acccccd, v125
    v_cos_f32 v104, v120
    v_sin_f32 v105, v120
    v_mul_f32 v121, 0x3b4ccccd, v124
    v_cos_f32 v110, v121
    v_sin_f32 v111, v121
    v_mul_f32 v122, 0x3d4ccccd, v124
    v_cos_f32 v116, v122
    v_sin_f32 v117, v122
    v_and_b32 v119, 1, v2
    v_lshlrev_b32 v119, 31, v119
    v_xor_b32 v119, 0xbf800000, v119
    s_cmp_eq_u32 s40, 0
    s_cselect_b32 s88, 0xffff, 0
    s_mov_b32 s89, 0
    s_mul_i32 s62, s41, 30720
    s_mul_i32 s63, s42, 15360
    s_add_u32 s62, s62, s63
    s_add_u32 s62, s62, 90144
    v_add_u32 v118, s62, v218
    s_mov_b32 s47, 5
Lgg:
    v_pk_mul_f32 v[120:121], v[100:101], v[106:107] op_sel_hi:[1,0]
    v_pk_fma_f32 v[120:121], v[100:101], v[106:107], v[120:121] op_sel:[1,1,0] op_sel_hi:[0,1,1] neg_lo:[0,1,0]
    v_pk_mul_f32 v[122:123], v[120:121], v[106:107] op_sel_hi:[1,0]
    v_pk_fma_f32 v[122:123], v[120:121], v[106:107], v[122:123] op_sel:[1,1,0] op_sel_hi:[0,1,1] neg_lo:[0,1,0]
    v_pk_mul_f32 v[124:125], v[122:123], v[106:107] op_sel_hi:[1,0]
    v_pk_fma_f32 v[124:125], v[122:123], v[106:107], v[124:125] op_sel:[1,1,0] op_sel_hi:[0,1,1] neg_lo:[0,1,0]
    v_cndmask_b32 v126, v101, v119, s[88:89]
    v_cvt_pk_bf16_f32 v128, v100, v120
    v_cvt_pk_bf16_f32 v129, v122, v124
    v_cvt_pk_bf16_f32 v130, -v126, -v121
    v_cvt_pk_bf16_f32 v131, -v123, -v125
    ds_write_b128 v118, v[128:131] offset:0
    v_pk_mul_f32 v[120:121], v[100:101], v[112:113] op_sel_hi:[1,0]
    v_pk_fma_f32 v[100:101], v[100:101], v[112:113], v[120:121] op_sel:[1,1,0] op_sel_hi:[0,1,1] neg_lo:[0,1,0]
    v_pk_mul_f32 v[132:133], v[102:103], v[108:109] op_sel_hi:[1,0]
    v_pk_fma_f32 v[132:133], v[102:103], v[108:109], v[132:133] op_sel:[1,1,0] op_sel_hi:[0,1,1] neg_lo:[0,1,0]
    v_pk_mul_f32 v[134:135], v[132:133], v[108:109] op_sel_hi:[1,0]
    v_pk_fma_f32 v[134:135], v[132:133], v[108:109], v[134:135] op_sel:[1,1,0] op_sel_hi:[0,1,1] neg_lo:[0,1,0]
    v_pk_mul_f32 v[136:137], v[134:135], v[108:109] op_sel_hi:[1,0]
    v_pk_fma_f32 v[136:137], v[134:135], v[108:109], v[136:137] op_sel:[1,1,0] op_sel_hi:[0,1,1] neg_lo:[0,1,0]
    v_cndmask_b32 v138, v103, v119, s[88:89]
    v_cvt_pk_bf16_f32 v140, v102, v132
    v_cvt_pk_bf16_f32 v141, v134, v136
    v_cvt_pk_bf16_f32 v142, -v138, -v133
    v_cvt_pk_bf16_f32 v143, -v135, -v137
    ds_write_b128 v118, v[140:143] offset:1024
    v_pk_mul_f32 v[132:133], v[102:103], v[114:115] op_sel_hi:[1,0]
    v_pk_fma_f32 v[102:103], v[102:103], v[114:115], v[132:133] op_sel:[1,1,0] op_sel_hi:[0,1,1] neg_lo:[0,1,0]
    v_pk_mul_f32 v[144:145], v[104:105], v[110:111] op_sel_hi:[1,0]
    v_pk_fma_f32 v[144:145], v[104:105], v[110:111], v[144:145] op_sel:[1,1,0] op_sel_hi:[0,1,1] neg_lo:[0,1,0]
    v_pk_mul_f32 v[146:147], v[144:145], v[110:111] op_sel_hi:[1,0]
    v_pk_fma_f32 v[146:147], v[144:145], v[110:111], v[146:147] op_sel:[1,1,0] op_sel_hi:[0,1,1] neg_lo:[0,1,0]
    v_pk_mul_f32 v[148:149], v[146:147], v[110:111] op_sel_hi:[1,0]
    v_pk_fma_f32 v[148:149], v[146:147], v[110:111], v[148:149] op_sel:[1,1,0] op_sel_hi:[0,1,1] neg_lo:[0,1,0]
    v_cndmask_b32 v150, v105, v119, s[88:89]
    v_cvt_pk_bf16_f32 v152, v104, v144
    v_cvt_pk_bf16_f32 v153, v146, v148
    v_cvt_pk_bf16_f32 v154, -v150, -v145
    v_cvt_pk_bf16_f32 v155, -v147, -v149
    ds_write_b128 v118, v[152:155] offset:2048
    v_pk_mul_f32 v[144:145], v[104:105], v[116:117] op_sel_hi:[1,0]
    v_pk_fma_f32 v[104:105], v[104:105], v[116:117], v[144:145] op_sel:[1,1,0] op_sel_hi:[0,1,1] neg_lo:[0,1,0]
    v_add_u32 v118, 0xc00, v118
    s_mov_b32 s88, 0
    s_cmp_eq_u32 s47, 4
    s_cbranch_scc0 Lgga
    s_add_u32 m0, s51, 0
    s_add_u32 s65, s48, 0
    buffer_load_dwordx4 v180, s[4:7], s65 offen  lds
    s_add_u32 m0, s51, 1024
    s_add_u32 s65, s48, 327680
    buffer_load_dwordx4 v181, s[4:7], s65 offen  lds
    s_add_u32 m0, s51, 2048
    s_add_u32 s65, s48, 655360
    buffer_load_dwordx4 v180, s[4:7], s65 offen  lds
    s_add_u32 m0, s51, 3072
    s_add_u32 s65, s48, 983040
    buffer_load_dwordx4 v181, s[4:7], s65 offen  lds
    s_add_u32 s54, s54, 1
    s_cmp_eq_u32 s54, 10
    s_cselect_b32 s54, 0, s54
    s_lshl_b32 s48, s54, 7
    s_add_u32 s48, s48, s98
    s_add_u32 s51, s51, 36880
Lgga:
    s_cmp_eq_u32 s47, 3
    s_cbranch_scc0 Lggp
    s_lshl_b32 s62, s40, 10
    s_add_u32 m0, s62, 155712
    s_nop 0
    buffer_load_dwordx4 v176, s[28:31], s92 offen lds
    s_mov_b64 exec, 0xffff
    buffer_store_dword v212, v177, s[12:15], s93 offen sc1
    s_mov_b64 exec, -1
Lggp:
    s_sub_u32 s47, s47, 1
    s_cmp_lg_u32 s47, 0
    s_cbranch_scc1 Lgg
Lnotg:
    s_add_u32 m0, s52, 0
    s_nop 0
    buffer_load_dwordx4 v184, s[8:11], s49 offen  lds
    s_add_u32 m0, s52, 1024
    s_nop 0
    buffer_load_dwordx4 v185, s[8:11], s49 offen  lds
    s_add_u32 m0, s52, 2048
    s_nop 0
    buffer_load_dwordx4 v186, s[8:11], s49 offen  lds
    s_add_u32 m0, s52, 3072
    s_nop 0
    buffer_load_dwordx4 v187, s[8:11], s49 offen  lds
    s_add_u32 m0, s52, 4096
    s_nop 0
    buffer_load_dwordx4 v188, s[8:11], s49 offen  lds
    s_mul_i32 s49, s54, s50
    s_add_u32 s52, s52, 36880
    s_mov_b32 s47, 0
    v_mov_b32 v179, 9207808
    buffer_load_dword v179, v179, s[12:15], 0 offen sc1
    s_waitcnt vmcnt(12) lgkmcnt(0)
    s_barrier
    ds_read_b128 v[100:103], v189 offset:0
    ds_read_b128 v[104:107], v189 offset:2048
    ds_read_b128 v[108:111], v189 offset:4096
    ds_read_b128 v[112:115], v189 offset:6144
    ds_read_b64_tr_b16 v[116:117], v191 offset:0
    ds_read_b64_tr_b16 v[118:119], v191 offset:2560
    ds_read_b64_tr_b16 v[120:121], v192 offset:0
    ds_read_b64_tr_b16 v[122:123], v192 offset:2560
    ds_read_b64_tr_b16 v[124:125], v193 offset:0
    ds_read_b64_tr_b16 v[126:127], v193 offset:2560
    ds_read_b64_tr_b16 v[128:129], v194 offset:0
    ds_read_b64_tr_b16 v[130:131], v194 offset:2560
    ds_read_b64_tr_b16 v[132:133], v195 offset:0
    ds_read_b64_tr_b16 v[134:135], v195 offset:2560
    s_mul_i32 s62, s41, 30720
    s_add_u32 s62, s62, 90144
    v_add_u32 v8, s62, v218
    s_cmp_eq_u32 s42, 0
    s_cbranch_scc0 Lit0b
    s_waitcnt lgkmcnt(0)
    v_mfma_f32_16x16x32_bf16 v[16:19], v[100:103], v[116:119], 0
    ds_read_b128 v[140:143], v190 offset:0
    ds_read_b128 v[144:147], v190 offset:2048
    ds_read_b128 v[148:151], v190 offset:4096
    v_mov_b32 v220, 0
    v_mov_b32 v221, 0
    v_mfma_f32_16x16x32_bf16 v[36:39], v[104:107], v[116:119], 0
    ds_read_b128 v[152:155], v190 offset:6144
    ds_read_b64_tr_b16 v[156:157], v191 offset:5120
    v_mov_b32 v222, 0
    v_mov_b32 v223, 0
    s_add_u32 m0, s51, 0
    s_add_u32 s65, s48, 0
    buffer_load_dwordx4 v180, s[4:7], s65 offen  lds
    v_mfma_f32_16x16x32_bf16 v[56:59], v[108:111], v[116:119], 0
    ds_read_b64_tr_b16 v[158:159], v191 offset:7680
    ds_read_b64_tr_b16 v[160:161], v192 offset:5120
    v_mov_b32 v224, 0
    v_mfma_f32_16x16x32_bf16 v[76:79], v[112:115], v[116:119], 0
    ds_read_b64_tr_b16 v[162:163], v192 offset:7680
    ds_read_b64_tr_b16 v[164:165], v193 offset:5120
    v_mov_b32 v225, 0
    v_mov_b32 v226, 0
    v_mfma_f32_16x16x32_bf16 v[20:23], v[100:103], v[120:123], 0
    ds_read_b64_tr_b16 v[166:167], v193 offset:7680
    ds_read_b64_tr_b16 v[168:169], v194 offset:5120
    v_mov_b32 v227, 0
    v_mfma_f32_16x16x32_bf16 v[40:43], v[104:107], v[120:123], 0
    ds_read_b64_tr_b16 v[170:171], v194 offset:7680
    ds_read_b64_tr_b16 v[172:173], v195 offset:5120
    ds_read_b64_tr_b16 v[174:175], v195 offset:7680
    v_mov_b32 v228, 0
    v_mov_b32 v229, 0
    v_mfma_f32_16x16x32_bf16 v[60:63], v[108:111], v[120:123], 0
    ds_read_b128 a[0:3], v8 offset:0
    ds_read_b128 a[4:7], v8 offset:1024
    v_mov_b32 v230, 0
    v_mov_b32 v231, 0
    s_add_u32 m0, s51, 1024
    s_add_u32 s65, s48, 327680
    buffer_load_dwordx4 v181, s[4:7], s65 offen  lds
    v_mfma_f32_16x16x32_bf16 v[80:83], v[112:115], v[120:123], 0
    ds_read_b128 a[8:11], v8 offset:2048
    ds_read_b128 a[12:15], v8 offset:3072
    v_mov_b32 v232, 0
    v_mfma_f32_16x16x32_bf16 v[24:27], v[100:103], v[124:127], 0
    ds_read_b128 a[16:19], v8 offset:4096
    ds_read_b128 a[20:23], v8 offset:5120
    v_mov_b32 v233, 0
    v_mov_b32 v234, 0
    v_mfma_f32_16x16x32_bf16 v[44:47], v[104:107], v[124:127], 0
    ds_read_b128 a[24:27], v8 offset:6144
    ds_read_b128 a[28:31], v8 offset:7168
    v_mov_b32 v235, 0
    v_mfma_f32_16x16x32_bf16 v[64:67], v[108:111], v[124:127], 0
    ds_read_b128 a[32:35], v8 offset:8192
    ds_read_b128 a[36:39], v8 offset:9216
    ds_read_b128 a[40:43], v8 offset:10240
    v_mov_b32 v236, 0
    v_mov_b32 v237, 0
    v_mfma_f32_16x16x32_bf16 v[84:87], v[112:115], v[124:127], 0
    ds_read_b128 a[44:47], v8 offset:11264
    ds_read_b128 a[48:51], v8 offset:12288
    v_mov_b32 v238, 0
    v_mov_b32 v239, 0
    s_add_u32 m0, s51, 2048
    s_add_u32 s65, s48, 655360
    buffer_load_dwordx4 v180, s[4:7], s65 offen  lds
    v_mfma_f32_16x16x32_bf16 v[28:31], v[100:103], v[128:131], 0
    ds_read_b128 a[52:55], v8 offset:13312
    ds_read_b128 a[56:59], v8 offset:14336
    v_mov_b32 v240, 0
    v_mfma_f32_16x16x32_bf16 v[48:51], v[104:107], v[128:131], 0
    ds_read_b128 a[60:63], v8 offset:15360
    ds_read_b128 a[64:67], v8 offset:16384
    v_mov_b32 v241, 0
    v_mov_b32 v242, 0
    v_mfma_f32_16x16x32_bf16 v[68:71], v[108:111], v[128:131], 0
    ds_read_b128 a[68:71], v8 offset:17408
    ds_read_b128 a[72:75], v8 offset:18432
    v_mov_b32 v243, 0
    v_mfma_f32_16x16x32_bf16 v[88:91], v[112:115], v[128:131], 0
    ds_read_b128 a[76:79], v8 offset:19456
    ds_read_b128 a[80:83], v8 offset:20480
    ds_read_b128 a[84:87], v8 offset:21504
    v_mov_b32 v244, 0
    v_mov_b32 v245, 0
    v_mfma_f32_16x16x32_bf16 v[32:35], v[100:103], v[132:135], 0
    ds_read_b128 a[88:91], v8 offset:22528
    ds_read_b128 a[92:95], v8 offset:23552
    v_mov_b32 v246, 0
    v_mov_b32 v247, 0
    s_add_u32 m0, s51, 3072
    s_add_u32 s65, s48, 983040
    buffer_load_dwordx4 v181, s[4:7], s65 offen  lds
    v_mfma_f32_16x16x32_bf16 v[52:55], v[104:107], v[132:135], 0
    ds_read_b128 a[96:99], v8 offset:24576
    ds_read_b128 a[100:103], v8 offset:25600
    v_mov_b32 v248, 0
    s_add_u32 s54, s54, 1
    s_cmp_eq_u32 s54, 10
    s_cselect_b32 s54, 0, s54
    s_lshl_b32 s48, s54, 7
    s_add_u32 s48, s48, s98
    s_add_u32 s51, s51, 36880
    v_mfma_f32_16x16x32_bf16 v[72:75], v[108:111], v[132:135], 0
    ds_read_b128 a[104:107], v8 offset:26624
    ds_read_b128 a[108:111], v8 offset:27648
    v_mov_b32 v249, 0
    v_mov_b32 v250, 0
    v_mfma_f32_16x16x32_bf16 v[92:95], v[112:115], v[132:135], 0
    ds_read_b128 a[112:115], v8 offset:28672
    ds_read_b128 a[116:119], v8 offset:29696
    v_mov_b32 v251, 0
    s_branch Lit0c
Lit0b:
    s_waitcnt lgkmcnt(0)
    v_mfma_f32_16x16x32_bf16 v[16:19], v[100:103], v[116:119], 0
    ds_read_b128 v[140:143], v190 offset:0
    v_mov_b32 v220, 0
    v_mov_b32 v221, 0
    v_mfma_f32_16x16x32_bf16 v[36:39], v[104:107], v[116:119], 0
    ds_read_b128 v[144:147], v190 offset:2048
    v_mov_b32 v222, 0
    v_mov_b32 v223, 0
    s_add_u32 m0, s51, 0
    s_add_u32 s65, s48, 0
    buffer_load_dwordx4 v180, s[4:7], s65 offen  lds
    v_mfma_f32_16x16x32_bf16 v[56:59], v[108:111], v[116:119], 0
    ds_read_b128 v[148:151], v190 offset:4096
    v_mov_b32 v224, 0
    v_mfma_f32_16x16x32_bf16 v[76:79], v[112:115], v[116:119], 0
    ds_read_b128 v[152:155], v190 offset:6144
    v_mov_b32 v225, 0
    v_mov_b32 v226, 0
    v_mfma_f32_16x16x32_bf16 v[20:23], v[100:103], v[120:123], 0
    ds_read_b64_tr_b16 v[156:157], v191 offset:5120
    v_mov_b32 v227, 0
    v_mfma_f32_16x16x32_bf16 v[40:43], v[104:107], v[120:123], 0
    ds_read_b64_tr_b16 v[158:159], v191 offset:7680
    v_mov_b32 v228, 0
    v_mov_b32 v229, 0
    v_mfma_f32_16x16x32_bf16 v[60:63], v[108:111], v[120:123], 0
    ds_read_b64_tr_b16 v[160:161], v192 offset:5120
    v_mov_b32 v230, 0
    v_mov_b32 v231, 0
    s_add_u32 m0, s51, 1024
    s_add_u32 s65, s48, 327680
    buffer_load_dwordx4 v181, s[4:7], s65 offen  lds
    v_mfma_f32_16x16x32_bf16 v[80:83], v[112:115], v[120:123], 0
    ds_read_b64_tr_b16 v[162:163], v192 offset:7680
    v_mov_b32 v232, 0
    v_mfma_f32_16x16x32_bf16 v[24:27], v[100:103], v[124:127], 0
    ds_read_b64_tr_b16 v[164:165], v193 offset:5120
    v_mov_b32 v233, 0
    v_mov_b32 v234, 0
    v_mfma_f32_16x16x32_bf16 v[44:47], v[104:107], v[124:127], 0
    ds_read_b64_tr_b16 v[166:167], v193 offset:7680
    v_mov_b32 v235, 0
    v_mfma_f32_16x16x32_bf16 v[64:67], v[108:111], v[124:127], 0
    ds_read_b64_tr_b16 v[168:169], v194 offset:5120
    v_mov_b32 v236, 0
    v_mov_b32 v237, 0
    v_mfma_f32_16x16x32_bf16 v[84:87], v[112:115], v[124:127], 0
    ds_read_b64_tr_b16 v[170:171], v194 offset:7680
    v_mov_b32 v238, 0
    v_mov_b32 v239, 0
    s_add_u32 m0, s51, 2048
    s_add_u32 s65, s48, 655360
    buffer_load_dwordx4 v180, s[4:7], s65 offen  lds
    v_mfma_f32_16x16x32_bf16 v[28:31], v[100:103], v[128:131], 0
    ds_read_b64_tr_b16 v[172:173], v195 offset:5120
    v_mov_b32 v240, 0
    v_mfma_f32_16x16x32_bf16 v[48:51], v[104:107], v[128:131], 0
    ds_read_b64_tr_b16 v[174:175], v195 offset:7680
    v_mov_b32 v241, 0
    v_mov_b32 v242, 0
    v_mfma_f32_16x16x32_bf16 v[68:71], v[108:111], v[128:131], 0
    v_mov_b32 v243, 0
    v_mfma_f32_16x16x32_bf16 v[88:91], v[112:115], v[128:131], 0
    v_mov_b32 v244, 0
    v_mov_b32 v245, 0
    v_mfma_f32_16x16x32_bf16 v[32:35], v[100:103], v[132:135], 0
    v_mov_b32 v246, 0
    v_mov_b32 v247, 0
    s_add_u32 m0, s51, 3072
    s_add_u32 s65, s48, 983040
    buffer_load_dwordx4 v181, s[4:7], s65 offen  lds
    v_mfma_f32_16x16x32_bf16 v[52:55], v[104:107], v[132:135], 0
    v_mov_b32 v248, 0
    s_add_u32 s54, s54, 1
    s_cmp_eq_u32 s54, 10
    s_cselect_b32 s54, 0, s54
    s_lshl_b32 s48, s54, 7
    s_add_u32 s48, s48, s98
    s_add_u32 s51, s51, 36880
    v_mfma_f32_16x16x32_bf16 v[72:75], v[108:111], v[132:135], 0
    v_mov_b32 v249, 0
    v_mov_b32 v250, 0
    v_mfma_f32_16x16x32_bf16 v[92:95], v[112:115], v[132:135], 0
    v_mov_b32 v251, 0
Lit0c:
    s_waitcnt vmcnt(4) lgkmcnt(0)
    s_barrier
    ds_read_b64_tr_b16 v[4:5], v213
    ds_read_b64_tr_b16 v[6:7], v213 offset:512
    v_add_u32 v212, 0x9e3779b9, v179
    s_nop 0
    v_readfirstlane_b32 s46, v212
    v_mfma_f32_16x16x32_bf16 v[16:19], v[140:143], v[156:159], v[16:19]
    v_add_u32 v189, 36880, v189
    v_add_u32 v191, 36880, v191
    s_add_u32 m0, s52, 0
    s_nop 0
    buffer_load_dwordx4 v184, s[8:11], s49 offen  lds
    v_mfma_f32_16x16x32_bf16 v[36:39], v[144:147], v[156:159], v[36:39]
    v_add_u32 v192, 36880, v192
    v_add_u32 v193, 36880, v193
    v_mfma_f32_16x16x32_bf16 v[56:59], v[148:151], v[156:159], v[56:59]
    v_add_u32 v194, 36880, v194
    v_add_u32 v195, 36880, v195
    ds_read_b128 v[100:103], v189 offset:0
    s_add_u32 m0, s52, 1024
    s_nop 0
    buffer_load_dwordx4 v185, s[8:11], s49 offen  lds
    v_mfma_f32_16x16x32_bf16 v[76:79], v[152:155], v[156:159], v[76:79]
    v_add_u32 v190, 36880, v190
    ds_read_b128 v[104:107], v189 offset:2048
    v_mfma_f32_16x16x32_bf16 v[20:23], v[140:143], v[160:163], v[20:23]
    ds_read_b128 v[108:111], v189 offset:4096
    s_add_u32 m0, s52, 2048
    s_nop 0
    buffer_load_dwordx4 v186, s[8:11], s49 offen  lds
    v_mfma_f32_16x16x32_bf16 v[40:43], v[144:147], v[160:163], v[40:43]
    ds_read_b128 v[112:115], v189 offset:6144
    v_mfma_f32_16x16x32_bf16 v[60:63], v[148:151], v[160:163], v[60:63]
    ds_read_b64_tr_b16 v[116:117], v191 offset:0
    s_add_u32 m0, s52, 3072
    s_nop 0
    buffer_load_dwordx4 v187, s[8:11], s49 offen  lds
    v_mfma_f32_16x16x32_bf16 v[80:83], v[152:155], v[160:163], v[80:83]
    ds_read_b64_tr_b16 v[118:119], v191 offset:2560
    v_mfma_f32_16x16x32_bf16 v[24:27], v[140:143], v[164:167], v[24:27]
    ds_read_b64_tr_b16 v[120:121], v192 offset:0
    s_add_u32 m0, s52, 4096
    s_nop 0
    buffer_load_dwordx4 v188, s[8:11], s49 offen  lds
    v_mfma_f32_16x16x32_bf16 v[44:47], v[144:147], v[164:167], v[44:47]
    ds_read_b64_tr_b16 v[122:123], v192 offset:2560
    s_mul_i32 s49, s54, s50
    s_add_u32 s52, s52, 36880
    s_waitcnt lgkmcnt(8)
    buffer_store_dwordx4 v[4:7], v218, s[12:15], s97 offen sc1
    v_mfma_f32_16x16x32_bf16 v[64:67], v[148:151], v[164:167], v[64:67]
    ds_read_b64_tr_b16 v[124:125], v193 offset:0
    s_add_u32 m0, s51, 0
    s_add_u32 s65, s48, 0
    buffer_load_dwordx4 v180, s[4:7], s65 offen  lds
    v_mfma_f32_16x16x32_bf16 v[84:87], v[152:155], v[164:167], v[84:87]
    ds_read_b64_tr_b16 v[126:127], v193 offset:2560
    v_mfma_f32_16x16x32_bf16 v[28:31], v[140:143], v[168:171], v[28:31]
    ds_read_b64_tr_b16 v[128:129], v194 offset:0
    s_add_u32 m0, s51, 1024
    s_add_u32 s65, s48, 327680
    buffer_load_dwordx4 v181, s[4:7], s65 offen  lds
    v_mfma_f32_16x16x32_bf16 v[48:51], v[144:147], v[168:171], v[48:51]
    ds_read_b64_tr_b16 v[130:131], v194 offset:2560
    v_mfma_f32_16x16x32_bf16 v[68:71], v[148:151], v[168:171], v[68:71]
    ds_read_b64_tr_b16 v[132:133], v195 offset:0
    s_add_u32 m0, s51, 2048
    s_add_u32 s65, s48, 655360
    buffer_load_dwordx4 v180, s[4:7], s65 offen  lds
    v_mfma_f32_16x16x32_bf16 v[88:91], v[152:155], v[168:171], v[88:91]
    ds_read_b64_tr_b16 v[134:135], v195 offset:2560
    v_mfma_f32_16x16x32_bf16 v[32:35], v[140:143], v[172:175], v[32:35]
    s_add_u32 m0, s51, 3072
    s_add_u32 s65, s48, 983040
    buffer_load_dwordx4 v181, s[4:7], s65 offen  lds
    v_mfma_f32_16x16x32_bf16 v[52:55], v[144:147], v[172:175], v[52:55]
    s_add_u32 s54, s54, 1
    s_cmp_eq_u32 s54, 10
    s_cselect_b32 s54, 0, s54
    s_lshl_b32 s48, s54, 7
    s_add_u32 s48, s48, s98
    s_add_u32 s51, s51, -110640
    v_mfma_f32_16x16x32_bf16 v[72:75], v[148:151], v[172:175], v[72:75]
    v_mfma_f32_16x16x32_bf16 v[92:95], v[152:155], v[172:175], v[92:95]
    s_mov_b32 s47, 1
Lmain:
    s_waitcnt lgkmcnt(0)
    v_mfma_f32_16x16x32_bf16 v[16:19], v[100:103], v[116:119], v[16:19]
    ds_read_b128 v[140:143], v190 offset:0
    v_mfma_f32_16x16x32_bf16 v[36:39], v[104:107], v[116:119], v[36:39]
    ds_read_b128 v[144:147], v190 offset:2048
    s_add_u32 m0, s52, 0
    s_nop 0
    buffer_load_dwordx4 v184, s[8:11], s49 offen  lds
    v_mfma_f32_16x16x32_bf16 v[56:59], v[108:111], v[116:119], v[56:59]
    ds_read_b128 v[148:151], v190 offset:4096
    v_mfma_f32_16x16x32_bf16 v[76:79], v[112:115], v[116:119], v[76:79]
    ds_read_b128 v[152:155], v190 offset:6144
    v_mfma_f32_16x16x32_bf16 v[20:23], v[100:103], v[120:123], v[20:23]
    ds_read_b64_tr_b16 v[156:157], v191 offset:5120
    v_mfma_f32_16x16x32_bf16 v[40:43], v[104:107], v[120:123], v[40:43]
    ds_read_b64_tr_b16 v[158:159], v191 offset:7680
    s_add_u32 m0, s52, 1024
    s_nop 0
    buffer_load_dwordx4 v185, s[8:11], s49 offen  lds
    v_mfma_f32_16x16x32_bf16 v[60:63], v[108:111], v[120:123], v[60:63]
    ds_read_b64_tr_b16 v[160:161], v192 offset:5120
    v_mfma_f32_16x16x32_bf16 v[80:83], v[112:115], v[120:123], v[80:83]
    ds_read_b64_tr_b16 v[162:163], v192 offset:7680
    v_mfma_f32_16x16x32_bf16 v[24:27], v[100:103], v[124:127], v[24:27]
    ds_read_b64_tr_b16 v[164:165], v193 offset:5120
    v_mfma_f32_16x16x32_bf16 v[44:47], v[104:107], v[124:127], v[44:47]
    ds_read_b64_tr_b16 v[166:167], v193 offset:7680
    s_add_u32 m0, s52, 2048
    s_nop 0
    buffer_load_dwordx4 v186, s[8:11], s49 offen  lds
    v_mfma_f32_16x16x32_bf16 v[64:67], v[108:111], v[124:127], v[64:67]
    ds_read_b64_tr_b16 v[168:169], v194 offset:5120
    v_mfma_f32_16x16x32_bf16 v[84:87], v[112:115], v[124:127], v[84:87]
    ds_read_b64_tr_b16 v[170:171], v194 offset:7680
    v_mfma_f32_16x16x32_bf16 v[28:31], v[100:103], v[128:131], v[28:31]
    ds_read_b64_tr_b16 v[172:173], v195 offset:5120
    v_mfma_f32_16x16x32_bf16 v[48:51], v[104:107], v[128:131], v[48:51]
    ds_read_b64_tr_b16 v[174:175], v195 offset:7680
    s_add_u32 m0, s52, 3072
    s_nop 0
    buffer_load_dwordx4 v187, s[8:11], s49 offen  lds
    v_mfma_f32_16x16x32_bf16 v[68:71], v[108:111], v[128:131], v[68:71]
    v_mfma_f32_16x16x32_bf16 v[88:91], v[112:115], v[128:131], v[88:91]
    v_mfma_f32_16x16x32_bf16 v[32:35], v[100:103], v[132:135], v[32:35]
    s_add_u32 m0, s52, 4096
    s_nop 0
    buffer_load_dwordx4 v188, s[8:11], s49 offen  lds
    v_mfma_f32_16x16x32_bf16 v[52:55], v[104:107], v[132:135], v[52:55]
    s_add_u32 s47, s47, 1
    s_mov_b32 s53, 36880
    s_mov_b32 s55, 36880
    s_and_b32 s62, s47, 3
    s_cselect_b32 s53, s53, -110640
    s_cmp_eq_u32 s62, 1
    s_cselect_b32 s55, -110640, s55
    s_mov_b32 s63, 36880
    s_cmp_eq_u32 s62, 2
    s_cselect_b32 s63, -110640, s63
    s_mul_i32 s49, s54, s50
    s_add_u32 s52, s52, s63
    v_mfma_f32_16x16x32_bf16 v[72:75], v[108:111], v[132:135], v[72:75]
    v_mfma_f32_16x16x32_bf16 v[92:95], v[112:115], v[132:135], v[92:95]
    s_waitcnt vmcnt(9) lgkmcnt(0)
    s_barrier
    v_mfma_f32_16x16x32_bf16 v[16:19], v[140:143], v[156:159], v[16:19]
    v_add_u32 v189, s53, v189
    v_add_u32 v191, s53, v191
    v_mfma_f32_16x16x32_bf16 v[36:39], v[144:147], v[156:159], v[36:39]
    v_add_u32 v192, s53, v192
    v_add_u32 v193, s53, v193
    s_add_u32 m0, s51, 0
    s_add_u32 s65, s48, 0
    buffer_load_dwordx4 v180, s[4:7], s65 offen  lds
    v_mfma_f32_16x16x32_bf16 v[56:59], v[148:151], v[156:159], v[56:59]
    v_add_u32 v194, s53, v194
    v_add_u32 v195, s53, v195
    ds_read_b128 v[100:103], v189 offset:0
    v_mfma_f32_16x16x32_bf16 v[76:79], v[152:155], v[156:159], v[76:79]
    v_add_u32 v190, s53, v190
    ds_read_b128 v[104:107], v189 offset:2048
    v_mfma_f32_16x16x32_bf16 v[20:23], v[140:143], v[160:163], v[20:23]
    ds_read_b128 v[108:111], v189 offset:4096
    v_mfma_f32_16x16x32_bf16 v[40:43], v[144:147], v[160:163], v[40:43]
    ds_read_b128 v[112:115], v189 offset:6144
    v_mfma_f32_16x16x32_bf16 v[60:63], v[148:151], v[160:163], v[60:63]
    ds_read_b64_tr_b16 v[116:117], v191 offset:0
    s_add_u32 m0, s51, 1024
    s_add_u32 s65, s48, 327680
    buffer_load_dwordx4 v181, s[4:7], s65 offen  lds
    v_mfma_f32_16x16x32_bf16 v[80:83], v[152:155], v[160:163], v[80:83]
    ds_read_b64_tr_b16 v[118:119], v191 offset:2560
    v_mfma_f32_16x16x32_bf16 v[24:27], v[140:143], v[164:167], v[24:27]
    ds_read_b64_tr_b16 v[120:121], v192 offset:0
    v_mfma_f32_16x16x32_bf16 v[44:47], v[144:147], v[164:167], v[44:47]
    ds_read_b64_tr_b16 v[122:123], v192 offset:2560
    v_mfma_f32_16x16x32_bf16 v[64:67], v[148:151], v[164:167], v[64:67]
    ds_read_b64_tr_b16 v[124:125], v193 offset:0
    v_mfma_f32_16x16x32_bf16 v[84:87], v[152:155], v[164:167], v[84:87]
    ds_read_b64_tr_b16 v[126:127], v193 offset:2560
    s_add_u32 m0, s51, 2048
    s_add_u32 s65, s48, 655360
    buffer_load_dwordx4 v180, s[4:7], s65 offen  lds
    v_mfma_f32_16x16x32_bf16 v[28:31], v[140:143], v[168:171], v[28:31]
    ds_read_b64_tr_b16 v[128:129], v194 offset:0
    v_mfma_f32_16x16x32_bf16 v[48:51], v[144:147], v[168:171], v[48:51]
    ds_read_b64_tr_b16 v[130:131], v194 offset:2560
    v_mfma_f32_16x16x32_bf16 v[68:71], v[148:151], v[168:171], v[68:71]
    ds_read_b64_tr_b16 v[132:133], v195 offset:0
    v_mfma_f32_16x16x32_bf16 v[88:91], v[152:155], v[168:171], v[88:91]
    ds_read_b64_tr_b16 v[134:135], v195 offset:2560
    v_mfma_f32_16x16x32_bf16 v[32:35], v[140:143], v[172:175], v[32:35]
    s_add_u32 m0, s51, 3072
    s_add_u32 s65, s48, 983040
    buffer_load_dwordx4 v181, s[4:7], s65 offen  lds
    v_mfma_f32_16x16x32_bf16 v[52:55], v[144:147], v[172:175], v[52:55]
    v_mfma_f32_16x16x32_bf16 v[72:75], v[148:151], v[172:175], v[72:75]
    s_add_u32 s54, s54, 1
    s_cmp_eq_u32 s54, 10
    s_cselect_b32 s54, 0, s54
    s_lshl_b32 s48, s54, 7
    s_add_u32 s48, s48, s98
    s_add_u32 s51, s51, s55
    v_mfma_f32_16x16x32_bf16 v[92:95], v[152:155], v[172:175], v[92:95]
    s_cmp_eq_u32 s47, 3
    s_cbranch_scc0 Lnoef
    s_mov_b64 exec, 1
    buffer_store_dword v212, v217, s[12:15], 0 offen sc1
    s_mov_b64 exec, -1
Lnoef:
    s_cmp_lt_u32 s47, 7
    s_cbranch_scc1 Lmain
    s_waitcnt lgkmcnt(0)
    v_mfma_f32_16x16x32_bf16 v[16:19], v[100:103], v[116:119], v[16:19]
    ds_read_b128 v[140:143], v190 offset:0
    v_mfma_f32_16x16x32_bf16 v[36:39], v[104:107], v[116:119], v[36:39]
    ds_read_b128 v[144:147], v190 offset:2048
    v_mfma_f32_16x16x32_bf16 v[56:59], v[108:111], v[116:119], v[56:59]
    ds_read_b128 v[148:151], v190 offset:4096
    s_add_u32 m0, s52, 0
    s_nop 0
    buffer_load_dwordx4 v184, s[8:11], s49 offen  lds
    v_mfma_f32_16x16x32_bf16 v[76:79], v[112:115], v[116:119], v[76:79]
    ds_read_b128 v[152:155], v190 offset:6144
    v_mfma_f32_16x16x32_bf16 v[20:23], v[100:103], v[120:123], v[20:23]
    ds_read_b64_tr_b16 v[156:157], v191 offset:5120
    v_mfma_f32_16x16x32_bf16 v[40:43], v[104:107], v[120:123], v[40:43]
    ds_read_b64_tr_b16 v[158:159], v191 offset:7680
    s_add_u32 m0, s52, 1024
    s_nop 0
    buffer_load_dwordx4 v185, s[8:11], s49 offen  lds
    v_mfma_f32_16x16x32_bf16 v[60:63], v[108:111], v[120:123], v[60:63]
    ds_read_b64_tr_b16 v[160:161], v192 offset:5120
    v_mfma_f32_16x16x32_bf16 v[80:83], v[112:115], v[120:123], v[80:83]
    ds_read_b64_tr_b16 v[162:163], v192 offset:7680
    v_mfma_f32_16x16x32_bf16 v[24:27], v[100:103], v[124:127], v[24:27]
    ds_read_b64_tr_b16 v[164:165], v193 offset:5120
    s_add_u32 m0, s52, 2048
    s_nop 0
    buffer_load_dwordx4 v186, s[8:11], s49 offen  lds
    v_mfma_f32_16x16x32_bf16 v[44:47], v[104:107], v[124:127], v[44:47]
    ds_read_b64_tr_b16 v[166:167], v193 offset:7680
    v_mfma_f32_16x16x32_bf16 v[64:67], v[108:111], v[124:127], v[64:67]
    ds_read_b64_tr_b16 v[168:169], v194 offset:5120
    v_mfma_f32_16x16x32_bf16 v[84:87], v[112:115], v[124:127], v[84:87]
    ds_read_b64_tr_b16 v[170:171], v194 offset:7680
    s_add_u32 m0, s52, 3072
    s_nop 0
    buffer_load_dwordx4 v187, s[8:11], s49 offen  lds
    v_mfma_f32_16x16x32_bf16 v[28:31], v[100:103], v[128:131], v[28:31]
    ds_read_b64_tr_b16 v[172:173], v195 offset:5120
    v_mfma_f32_16x16x32_bf16 v[48:51], v[104:107], v[128:131], v[48:51]
    ds_read_b64_tr_b16 v[174:175], v195 offset:7680
    v_mfma_f32_16x16x32_bf16 v[68:71], v[108:111], v[128:131], v[68:71]
    s_add_u32 m0, s52, 4096
    s_nop 0
    buffer_load_dwordx4 v188, s[8:11], s49 offen  lds
    v_mfma_f32_16x16x32_bf16 v[88:91], v[112:115], v[128:131], v[88:91]
    v_mfma_f32_16x16x32_bf16 v[32:35], v[100:103], v[132:135], v[32:35]
    v_mfma_f32_16x16x32_bf16 v[52:55], v[104:107], v[132:135], v[52:55]
    buffer_load_dword v198, v196, s[12:15], 0 offen sc1
    buffer_load_dword v199, v197, s[12:15], 0 offen sc1
    v_mfma_f32_16x16x32_bf16 v[72:75], v[108:111], v[132:135], v[72:75]
    v_mfma_f32_16x16x32_bf16 v[92:95], v[112:115], v[132:135], v[92:95]
    s_waitcnt vmcnt(11) lgkmcnt(0)
    s_barrier
    v_mfma_f32_16x16x32_bf16 v[16:19], v[140:143], v[156:159], v[16:19]
    v_add_u32 v189, -110640, v189
    v_add_u32 v191, -110640, v191
    v_mfma_f32_16x16x32_bf16 v[36:39], v[144:147], v[156:159], v[36:39]
    v_add_u32 v192, -110640, v192
    v_add_u32 v193, -110640, v193
    v_mfma_f32_16x16x32_bf16 v[56:59], v[148:151], v[156:159], v[56:59]
    v_add_u32 v194, -110640, v194
    v_add_u32 v195, -110640, v195
    ds_read_b128 v[100:103], v189 offset:0
    v_mfma_f32_16x16x32_bf16 v[76:79], v[152:155], v[156:159], v[76:79]
    v_add_u32 v190, -110640, v190
    ds_read_b128 v[104:107], v189 offset:2048
    s_add_u32 s64, s94, 0
    buffer_load_short_d16_hi v220, v214, s[16:19], s64 offen
    buffer_load_short_d16_hi v228, v214, s[20:23], s64 offen
    v_mfma_f32_16x16x32_bf16 v[20:23], v[140:143], v[160:163], v[20:23]
    ds_read_b128 v[108:111], v189 offset:4096
    v_mfma_f32_16x16x32_bf16 v[40:43], v[144:147], v[160:163], v[40:43]
    ds_read_b128 v[112:115], v189 offset:6144
    v_mfma_f32_16x16x32_bf16 v[60:63], v[148:151], v[160:163], v[60:63]
    ds_read_b64_tr_b16 v[116:117], v191 offset:0
    v_mfma_f32_16x16x32_bf16 v[80:83], v[152:155], v[160:163], v[80:83]
    ds_read_b64_tr_b16 v[118:119], v191 offset:2560
    v_mfma_f32_16x16x32_bf16 v[24:27], v[140:143], v[164:167], v[24:27]
    ds_read_b64_tr_b16 v[120:121], v192 offset:0
    v_mfma_f32_16x16x32_bf16 v[44:47], v[144:147], v[164:167], v[44:47]
    ds_read_b64_tr_b16 v[122:123], v192 offset:2560
    s_sub_u32 s64, 657408, s94
    buffer_load_short_d16_hi v236, v216, s[16:19], s64 offen
    buffer_load_short_d16_hi v244, v216, s[20:23], s64 offen
    v_mfma_f32_16x16x32_bf16 v[64:67], v[148:151], v[164:167], v[64:67]
    ds_read_b64_tr_b16 v[124:125], v193 offset:0
    v_mfma_f32_16x16x32_bf16 v[84:87], v[152:155], v[164:167], v[84:87]
    ds_read_b64_tr_b16 v[126:127], v193 offset:2560
    v_mfma_f32_16x16x32_bf16 v[28:31], v[140:143], v[168:171], v[28:31]
    ds_read_b64_tr_b16 v[128:129], v194 offset:0
    v_mfma_f32_16x16x32_bf16 v[48:51], v[144:147], v[168:171], v[48:51]
    ds_read_b64_tr_b16 v[130:131], v194 offset:2560
    v_mfma_f32_16x16x32_bf16 v[68:71], v[148:151], v[168:171], v[68:71]
    ds_read_b64_tr_b16 v[132:133], v195 offset:0
    v_mfma_f32_16x16x32_bf16 v[88:91], v[152:155], v[168:171], v[88:91]
    ds_read_b64_tr_b16 v[134:135], v195 offset:2560
    v_mfma_f32_16x16x32_bf16 v[32:35], v[140:143], v[172:175], v[32:35]
    s_add_u32 s64, s94, 41088
    buffer_load_short_d16_hi v221, v214, s[16:19], s64 offen
    buffer_load_short_d16_hi v229, v214, s[20:23], s64 offen
    v_mfma_f32_16x16x32_bf16 v[52:55], v[144:147], v[172:175], v[52:55]
    v_mfma_f32_16x16x32_bf16 v[72:75], v[148:151], v[172:175], v[72:75]
    v_mfma_f32_16x16x32_bf16 v[92:95], v[152:155], v[172:175], v[92:95]
    s_waitcnt lgkmcnt(0)
    v_mfma_f32_16x16x32_bf16 v[16:19], v[100:103], v[116:119], v[16:19]
    ds_read_b128 v[140:143], v190 offset:0
    v_mfma_f32_16x16x32_bf16 v[36:39], v[104:107], v[116:119], v[36:39]
    ds_read_b128 v[144:147], v190 offset:2048
    v_mfma_f32_16x16x32_bf16 v[56:59], v[108:111], v[116:119], v[56:59]
    ds_read_b128 v[148:151], v190 offset:4096
    s_sub_u32 s64, 780672, s94
    buffer_load_short_d16_hi v237, v215, s[16:19], s64 offen
    buffer_load_short_d16_hi v245, v215, s[20:23], s64 offen
    v_mfma_f32_16x16x32_bf16 v[76:79], v[112:115], v[116:119], v[76:79]
    ds_read_b128 v[152:155], v190 offset:6144
    v_mfma_f32_16x16x32_bf16 v[20:23], v[100:103], v[120:123], v[20:23]
    ds_read_b64_tr_b16 v[156:157], v191 offset:5120
    v_mfma_f32_16x16x32_bf16 v[40:43], v[104:107], v[120:123], v[40:43]
    ds_read_b64_tr_b16 v[158:159], v191 offset:7680
    v_mfma_f32_16x16x32_bf16 v[60:63], v[108:111], v[120:123], v[60:63]
    ds_read_b64_tr_b16 v[160:161], v192 offset:5120
    v_mfma_f32_16x16x32_bf16 v[80:83], v[112:115], v[120:123], v[80:83]
    ds_read_b64_tr_b16 v[162:163], v192 offset:7680
    s_add_u32 s64, s94, 82176
    buffer_load_short_d16_hi v222, v214, s[16:19], s64 offen
    buffer_load_short_d16_hi v230, v214, s[20:23], s64 offen
    v_mfma_f32_16x16x32_bf16 v[24:27], v[100:103], v[124:127], v[24:27]
    ds_read_b64_tr_b16 v[164:165], v193 offset:5120
    v_mfma_f32_16x16x32_bf16 v[44:47], v[104:107], v[124:127], v[44:47]
    ds_read_b64_tr_b16 v[166:167], v193 offset:7680
    v_mfma_f32_16x16x32_bf16 v[64:67], v[108:111], v[124:127], v[64:67]
    ds_read_b64_tr_b16 v[168:169], v194 offset:5120
    v_mfma_f32_16x16x32_bf16 v[84:87], v[112:115], v[124:127], v[84:87]
    ds_read_b64_tr_b16 v[170:171], v194 offset:7680
    v_mfma_f32_16x16x32_bf16 v[28:31], v[100:103], v[128:131], v[28:31]
    ds_read_b64_tr_b16 v[172:173], v195 offset:5120
    s_sub_u32 s64, 739584, s94
    buffer_load_short_d16_hi v238, v215, s[16:19], s64 offen
    buffer_load_short_d16_hi v246, v215, s[20:23], s64 offen
    v_mfma_f32_16x16x32_bf16 v[48:51], v[104:107], v[128:131], v[48:51]
    ds_read_b64_tr_b16 v[174:175], v195 offset:7680
    v_mfma_f32_16x16x32_bf16 v[68:71], v[108:111], v[128:131], v[68:71]
    v_mfma_f32_16x16x32_bf16 v[88:91], v[112:115], v[128:131], v[88:91]
    v_mfma_f32_16x16x32_bf16 v[32:35], v[100:103], v[132:135], v[32:35]
    v_mfma_f32_16x16x32_bf16 v[52:55], v[104:107], v[132:135], v[52:55]
    s_add_u32 s64, s94, 123264
    buffer_load_short_d16_hi v223, v214, s[16:19], s64 offen
    buffer_load_short_d16_hi v231, v214, s[20:23], s64 offen
    v_mfma_f32_16x16x32_bf16 v[72:75], v[108:111], v[132:135], v[72:75]
    v_mfma_f32_16x16x32_bf16 v[92:95], v[112:115], v[132:135], v[92:95]
    s_waitcnt vmcnt(14) lgkmcnt(0)
    s_barrier
    v_mfma_f32_16x16x32_bf16 v[16:19], v[140:143], v[156:159], v[16:19]
    v_add_u32 v189, 36880, v189
    v_add_u32 v191, 36880, v191
    v_mfma_f32_16x16x32_bf16 v[36:39], v[144:147], v[156:159], v[36:39]
    v_add_u32 v192, 36880, v192
    v_add_u32 v193, 36880, v193
    v_mfma_f32_16x16x32_bf16 v[56:59], v[148:151], v[156:159], v[56:59]
    v_add_u32 v194, 36880, v194
    v_add_u32 v195, 36880, v195
    ds_read_b128 v[100:103], v189 offset:0
    v_mfma_f32_16x16x32_bf16 v[76:79], v[152:155], v[156:159], v[76:79]
    v_add_u32 v190, 36880, v190
    ds_read_b128 v[104:107], v189 offset:2048
    s_sub_u32 s64, 698496, s94
    buffer_load_short_d16_hi v239, v215, s[16:19], s64 offen
    buffer_load_short_d16_hi v247, v215, s[20:23], s64 offen
    v_mfma_f32_16x16x32_bf16 v[20:23], v[140:143], v[160:163], v[20:23]
    ds_read_b128 v[108:111], v189 offset:4096
    v_mfma_f32_16x16x32_bf16 v[40:43], v[144:147], v[160:163], v[40:43]
    ds_read_b128 v[112:115], v189 offset:6144
    v_mfma_f32_16x16x32_bf16 v[60:63], v[148:151], v[160:163], v[60:63]
    ds_read_b64_tr_b16 v[116:117], v191 offset:0
    v_mfma_f32_16x16x32_bf16 v[80:83], v[152:155], v[160:163], v[80:83]
    ds_read_b64_tr_b16 v[118:119], v191 offset:2560
    s_add_u32 s64, s95, 0
    buffer_load_short_d16_hi v224, v214, s[16:19], s64 offen
    buffer_load_short_d16_hi v232, v214, s[20:23], s64 offen
    v_mfma_f32_16x16x32_bf16 v[24:27], v[140:143], v[164:167], v[24:27]
    ds_read_b64_tr_b16 v[120:121], v192 offset:0
    v_mfma_f32_16x16x32_bf16 v[44:47], v[144:147], v[164:167], v[44:47]
    ds_read_b64_tr_b16 v[122:123], v192 offset:2560
    v_mfma_f32_16x16x32_bf16 v[64:67], v[148:151], v[164:167], v[64:67]
    ds_read_b64_tr_b16 v[124:125], v193 offset:0
    v_mfma_f32_16x16x32_bf16 v[84:87], v[152:155], v[164:167], v[84:87]
    ds_read_b64_tr_b16 v[126:127], v193 offset:2560
    s_sub_u32 s64, 821760, s95
    buffer_load_short_d16_hi v240, v215, s[16:19], s64 offen
    buffer_load_short_d16_hi v248, v215, s[20:23], s64 offen
    v_mfma_f32_16x16x32_bf16 v[28:31], v[140:143], v[168:171], v[28:31]
    ds_read_b64_tr_b16 v[128:129], v194 offset:0
    v_mfma_f32_16x16x32_bf16 v[48:51], v[144:147], v[168:171], v[48:51]
    ds_read_b64_tr_b16 v[130:131], v194 offset:2560
    v_mfma_f32_16x16x32_bf16 v[68:71], v[148:151], v[168:171], v[68:71]
    ds_read_b64_tr_b16 v[132:133], v195 offset:0
    v_mfma_f32_16x16x32_bf16 v[88:91], v[152:155], v[168:171], v[88:91]
    ds_read_b64_tr_b16 v[134:135], v195 offset:2560
    v_mfma_f32_16x16x32_bf16 v[32:35], v[140:143], v[172:175], v[32:35]
    s_add_u32 s64, s95, 41088
    buffer_load_short_d16_hi v225, v214, s[16:19], s64 offen
    buffer_load_short_d16_hi v233, v214, s[20:23], s64 offen
    v_mfma_f32_16x16x32_bf16 v[52:55], v[144:147], v[172:175], v[52:55]
    v_mfma_f32_16x16x32_bf16 v[72:75], v[148:151], v[172:175], v[72:75]
    v_mfma_f32_16x16x32_bf16 v[92:95], v[152:155], v[172:175], v[92:95]
    s_waitcnt lgkmcnt(0)
    v_mfma_f32_16x16x32_bf16 v[16:19], v[100:103], v[116:119], v[16:19]
    ds_read_b128 v[140:143], v190 offset:0
    v_mfma_f32_16x16x32_bf16 v[36:39], v[104:107], v[116:119], v[36:39]
    ds_read_b128 v[144:147], v190 offset:2048
    v_mfma_f32_16x16x32_bf16 v[56:59], v[108:111], v[116:119], v[56:59]
    ds_read_b128 v[148:151], v190 offset:4096
    s_sub_u32 s64, 780672, s95
    buffer_load_short_d16_hi v241, v215, s[16:19], s64 offen
    buffer_load_short_d16_hi v249, v215, s[20:23], s64 offen
    v_mfma_f32_16x16x32_bf16 v[76:79], v[112:115], v[116:119], v[76:79]
    ds_read_b128 v[152:155], v190 offset:6144
    v_mfma_f32_16x16x32_bf16 v[20:23], v[100:103], v[120:123], v[20:23]
    ds_read_b64_tr_b16 v[156:157], v191 offset:5120
    v_mfma_f32_16x16x32_bf16 v[40:43], v[104:107], v[120:123], v[40:43]
    ds_read_b64_tr_b16 v[158:159], v191 offset:7680
    v_mfma_f32_16x16x32_bf16 v[60:63], v[108:111], v[120:123], v[60:63]
    ds_read_b64_tr_b16 v[160:161], v192 offset:5120
    v_mfma_f32_16x16x32_bf16 v[80:83], v[112:115], v[120:123], v[80:83]
    ds_read_b64_tr_b16 v[162:163], v192 offset:7680
    v_mfma_f32_16x16x32_bf16 v[24:27], v[100:103], v[124:127], v[24:27]
    ds_read_b64_tr_b16 v[164:165], v193 offset:5120
    v_mfma_f32_16x16x32_bf16 v[44:47], v[104:107], v[124:127], v[44:47]
    ds_read_b64_tr_b16 v[166:167], v193 offset:7680
    s_add_u32 s64, s95, 82176
    buffer_load_short_d16_hi v226, v214, s[16:19], s64 offen
    buffer_load_short_d16_hi v234, v214, s[20:23], s64 offen
    v_mfma_f32_16x16x32_bf16 v[64:67], v[108:111], v[124:127], v[64:67]
    ds_read_b64_tr_b16 v[168:169], v194 offset:5120
    v_mfma_f32_16x16x32_bf16 v[84:87], v[112:115], v[124:127], v[84:87]
    ds_read_b64_tr_b16 v[170:171], v194 offset:7680
    v_mfma_f32_16x16x32_bf16 v[28:31], v[100:103], v[128:131], v[28:31]
    ds_read_b64_tr_b16 v[172:173], v195 offset:5120
    v_mfma_f32_16x16x32_bf16 v[48:51], v[104:107], v[128:131], v[48:51]
    ds_read_b64_tr_b16 v[174:175], v195 offset:7680
    v_mfma_f32_16x16x32_bf16 v[68:71], v[108:111], v[128:131], v[68:71]
    v_mfma_f32_16x16x32_bf16 v[88:91], v[112:115], v[128:131], v[88:91]
    v_mfma_f32_16x16x32_bf16 v[32:35], v[100:103], v[132:135], v[32:35]
    v_mfma_f32_16x16x32_bf16 v[52:55], v[104:107], v[132:135], v[52:55]
    s_sub_u32 s64, 739584, s95
    buffer_load_short_d16_hi v242, v215, s[16:19], s64 offen
    buffer_load_short_d16_hi v250, v215, s[20:23], s64 offen
    v_mfma_f32_16x16x32_bf16 v[72:75], v[108:111], v[132:135], v[72:75]
    v_mfma_f32_16x16x32_bf16 v[92:95], v[112:115], v[132:135], v[92:95]
    s_waitcnt lgkmcnt(0)
    s_barrier
    v_mfma_f32_16x16x32_bf16 v[16:19], v[140:143], v[156:159], v[16:19]
    v_mfma_f32_16x16x32_bf16 v[36:39], v[144:147], v[156:159], v[36:39]
    v_mfma_f32_16x16x32_bf16 v[56:59], v[148:151], v[156:159], v[56:59]
    v_mfma_f32_16x16x32_bf16 v[76:79], v[152:155], v[156:159], v[76:79]
    s_add_u32 s64, s95, 123264
    buffer_load_short_d16_hi v227, v214, s[16:19], s64 offen
    buffer_load_short_d16_hi v235, v214, s[20:23], s64 offen
    v_mfma_f32_16x16x32_bf16 v[20:23], v[140:143], v[160:163], v[20:23]
    v_mfma_f32_16x16x32_bf16 v[40:43], v[144:147], v[160:163], v[40:43]
    v_mfma_f32_16x16x32_bf16 v[60:63], v[148:151], v[160:163], v[60:63]
    v_mfma_f32_16x16x32_bf16 v[80:83], v[152:155], v[160:163], v[80:83]
    v_mfma_f32_16x16x32_bf16 v[24:27], v[140:143], v[164:167], v[24:27]
    v_mfma_f32_16x16x32_bf16 v[44:47], v[144:147], v[164:167], v[44:47]
    v_mfma_f32_16x16x32_bf16 v[64:67], v[148:151], v[164:167], v[64:67]
    s_sub_u32 s64, 698496, s95
    buffer_load_short_d16_hi v243, v215, s[16:19], s64 offen
    buffer_load_short_d16_hi v251, v215, s[20:23], s64 offen
    v_mfma_f32_16x16x32_bf16 v[84:87], v[152:155], v[164:167], v[84:87]
    v_mfma_f32_16x16x32_bf16 v[28:31], v[140:143], v[168:171], v[28:31]
    v_mfma_f32_16x16x32_bf16 v[48:51], v[144:147], v[168:171], v[48:51]
    v_mfma_f32_16x16x32_bf16 v[68:71], v[148:151], v[168:171], v[68:71]
    v_mfma_f32_16x16x32_bf16 v[88:91], v[152:155], v[168:171], v[88:91]
    v_mfma_f32_16x16x32_bf16 v[32:35], v[140:143], v[172:175], v[32:35]
    v_mfma_f32_16x16x32_bf16 v[52:55], v[144:147], v[172:175], v[52:55]
    v_mfma_f32_16x16x32_bf16 v[72:75], v[148:151], v[172:175], v[72:75]
    v_mov_b32 v252, 0
    v_mov_b32 v253, 0
    buffer_load_short_d16_hi v252, v254, s[16:19], 0 offen offset:640
    buffer_load_short_d16_hi v253, v254, s[20:23], 0 offen offset:640
    v_mfma_f32_16x16x32_bf16 v[92:95], v[152:155], v[172:175], v[92:95]
    s_mov_b32 s48, 0x3fb8aa3b
    s_mov_b32 s49, 0x358637bd
    v_cmp_ne_u32 vcc, s46, v198
    v_cmp_ne_u32 s[66:67], s46, v199
    s_nop 0
    s_or_b64 vcc, vcc, s[66:67]
    s_cbranch_vccz Leok
    s_mov_b32 s61, 0x40000
    buffer_load_dword v198, v196, s[12:15], 0 offen sc1
    buffer_load_dword v199, v197, s[12:15], 0 offen sc1
    s_waitcnt vmcnt(1)
Lpoll1:
    v_cmp_ne_u32 vcc, s46, v198
    s_cbranch_vccz Lpoll1d
    s_mov_b64 exec, vcc
    s_sleep 6
    buffer_load_dword v198, v196, s[12:15], 0 offen sc1
    s_sub_u32 s61, s61, 1
    s_waitcnt vmcnt(0)
    s_cbranch_scc0 Lpoll1
Lpoll1d:
    s_mov_b64 exec, -1
    s_waitcnt vmcnt(0)
Lpoll2:
    v_cmp_ne_u32 vcc, s46, v199
    s_cbranch_vccz Lpoll2d
    s_mov_b64 exec, vcc
    s_sleep 6
    buffer_load_dword v199, v197, s[12:15], 0 offen sc1
    s_sub_u32 s61, s61, 1
    s_waitcnt vmcnt(0)
    s_cbranch_scc0 Lpoll2
Lpoll2d:
    s_mov_b64 exec, -1
Leok:
    s_nop 3
    s_cmp_eq_u32 s43, 0
    s_cbranch_scc0 LepiFQ
    v_cvt_pk_bf16_f32 v124, v24, v25
    v_cvt_pk_bf16_f32 v125, v26, v27
    v_cvt_pk_bf16_f32 v126, v44, v45
    v_cvt_pk_bf16_f32 v127, v46, v47
    v_cvt_pk_bf16_f32 v128, v64, v65
    v_cvt_pk_bf16_f32 v129, v66, v67
    v_cvt_pk_bf16_f32 v130, v84, v85
    v_cvt_pk_bf16_f32 v131, v86, v87
    v_cvt_pk_bf16_f32 v132, v28, v29
    v_cvt_pk_bf16_f32 v133, v30, v31
    v_cvt_pk_bf16_f32 v134, v48, v49
    v_cvt_pk_bf16_f32 v135, v50, v51
    v_cvt_pk_bf16_f32 v136, v68, v69
    v_cvt_pk_bf16_f32 v137, v70, v71
    v_cvt_pk_bf16_f32 v138, v88, v89
    v_cvt_pk_bf16_f32 v139, v90, v91
    v_cvt_pk_bf16_f32 v140, v32, v33
    v_cvt_pk_bf16_f32 v141, v34, v35
    v_cvt_pk_bf16_f32 v142, v52, v53
    v_cvt_pk_bf16_f32 v143, v54, v55
    v_cvt_pk_bf16_f32 v144, v72, v73
    v_cvt_pk_bf16_f32 v145, v74, v75
    v_cvt_pk_bf16_f32 v146, v92, v93
    v_cvt_pk_bf16_f32 v147, v94, v95
    v_cmp_gt_u32 vcc, 8, v2
    v_mov_b32 v4, 1065369472
    s_lshl_b32 s62, s40, 12
    s_add_u32 s62, s62, 0
    v_cndmask_b32 v124, v124, v4, vcc
    v_cndmask_b32 v125, v125, v4, vcc
    v_cndmask_b32 v126, v126, v4, vcc
    v_cndmask_b32 v127, v127, v4, vcc
    v_cndmask_b32 v128, v128, v4, vcc
    v_cndmask_b32 v129, v129, v4, vcc
    v_cndmask_b32 v130, v130, v4, vcc
    v_cndmask_b32 v131, v131, v4, vcc
    v_add_u32 v200, s62, v200
    v_add_u32 v201, s62, v201
    v_add_u32 v202, s62, v202
    v_add_u32 v203, s62, v203
    v_add_u32 v204, s62, v204
    v_add_u32 v205, s62, v205
    v_add_u32 v206, s62, v206
    v_add_u32 v207, s62, v207
    v_pk_mul_f32 v[4:5], v[16:17], s[48:49] op_sel_hi:[1,0]
    v_exp_f32 v4, v4 clamp
    v_exp_f32 v5, v5 clamp
    v_max_f32 v16, s49, v16
    v_max_f32 v17, s49, v17
    v_pk_add_f32 v[16:17], v[16:17], v[4:5]
    v_cvt_pk_bf16_f32 v100, v16, v17
    v_pk_mul_f32 v[6:7], v[18:19], s[48:49] op_sel_hi:[1,0]
    v_exp_f32 v6, v6 clamp
    v_exp_f32 v7, v7 clamp
    v_max_f32 v18, s49, v18
    v_max_f32 v19, s49, v19
    v_pk_add_f32 v[18:19], v[18:19], v[6:7]
    v_cvt_pk_bf16_f32 v101, v18, v19
    v_pk_mul_f32 v[4:5], v[36:37], s[48:49] op_sel_hi:[1,0]
    v_exp_f32 v4, v4 clamp
    v_exp_f32 v5, v5 clamp
    v_max_f32 v36, s49, v36
    v_max_f32 v37, s49, v37
    v_pk_add_f32 v[36:37], v[36:37], v[4:5]
    v_cvt_pk_bf16_f32 v102, v36, v37
    v_pk_mul_f32 v[6:7], v[38:39], s[48:49] op_sel_hi:[1,0]
    v_exp_f32 v6, v6 clamp
    v_exp_f32 v7, v7 clamp
    v_max_f32 v38, s49, v38
    v_max_f32 v39, s49, v39
    v_pk_add_f32 v[38:39], v[38:39], v[6:7]
    v_cvt_pk_bf16_f32 v103, v38, v39
    v_pk_mul_f32 v[4:5], v[56:57], s[48:49] op_sel_hi:[1,0]
    v_exp_f32 v4, v4 clamp
    v_exp_f32 v5, v5 clamp
    v_max_f32 v56, s49, v56
    v_max_f32 v57, s49, v57
    v_pk_add_f32 v[56:57], v[56:57], v[4:5]
    v_cvt_pk_bf16_f32 v104, v56, v57
    v_pk_mul_f32 v[6:7], v[58:59], s[48:49] op_sel_hi:[1,0]
    v_exp_f32 v6, v6 clamp
    v_exp_f32 v7, v7 clamp
    v_max_f32 v58, s49, v58
    v_max_f32 v59, s49, v59
    v_pk_add_f32 v[58:59], v[58:59], v[6:7]
    v_cvt_pk_bf16_f32 v105, v58, v59
    v_pk_mul_f32 v[4:5], v[76:77], s[48:49] op_sel_hi:[1,0]
    v_exp_f32 v4, v4 clamp
    v_exp_f32 v5, v5 clamp
    v_max_f32 v76, s49, v76
    v_max_f32 v77, s49, v77
    v_pk_add_f32 v[76:77], v[76:77], v[4:5]
    v_cvt_pk_bf16_f32 v106, v76, v77
    v_pk_mul_f32 v[6:7], v[78:79], s[48:49] op_sel_hi:[1,0]
    v_exp_f32 v6, v6 clamp
    v_exp_f32 v7, v7 clamp
    v_max_f32 v78, s49, v78
    v_max_f32 v79, s49, v79
    v_pk_add_f32 v[78:79], v[78:79], v[6:7]
    v_cvt_pk_bf16_f32 v107, v78, v79
    v_mfma_f32_16x16x32_bf16 v[148:151], v[100:103], v[124:127], 0
    v_mfma_f32_16x16x32_bf16 v[152:155], v[100:103], v[132:135], 0
    v_mfma_f32_16x16x32_bf16 v[148:151], v[104:107], v[128:131], v[148:151]
    v_mfma_f32_16x16x32_bf16 v[152:155], v[104:107], v[136:139], v[152:155]
    v_pk_mul_f32 v[4:5], v[20:21], s[48:49] op_sel_hi:[1,0]
    v_exp_f32 v4, v4 clamp
    v_exp_f32 v5, v5 clamp
    v_max_f32 v20, s49, v20
    v_max_f32 v21, s49, v21
    v_pk_add_f32 v[20:21], v[20:21], v[4:5]
    v_cvt_pk_bf16_f32 v108, v20, v21
    v_pk_mul_f32 v[6:7], v[22:23], s[48:49] op_sel_hi:[1,0]
    v_exp_f32 v6, v6 clamp
    v_exp_f32 v7, v7 clamp
    v_max_f32 v22, s49, v22
    v_max_f32 v23, s49, v23
    v_pk_add_f32 v[22:23], v[22:23], v[6:7]
    v_cvt_pk_bf16_f32 v109, v22, v23
    v_pk_mul_f32 v[4:5], v[40:41], s[48:49] op_sel_hi:[1,0]
    v_exp_f32 v4, v4 clamp
    v_exp_f32 v5, v5 clamp
    v_max_f32 v40, s49, v40
    v_max_f32 v41, s49, v41
    v_pk_add_f32 v[40:41], v[40:41], v[4:5]
    v_cvt_pk_bf16_f32 v110, v40, v41
    v_pk_mul_f32 v[6:7], v[42:43], s[48:49] op_sel_hi:[1,0]
    v_exp_f32 v6, v6 clamp
    v_exp_f32 v7, v7 clamp
    v_max_f32 v42, s49, v42
    v_max_f32 v43, s49, v43
    v_pk_add_f32 v[42:43], v[42:43], v[6:7]
    v_cvt_pk_bf16_f32 v111, v42, v43
    v_pk_mul_f32 v[4:5], v[60:61], s[48:49] op_sel_hi:[1,0]
    v_exp_f32 v4, v4 clamp
    v_exp_f32 v5, v5 clamp
    v_max_f32 v60, s49, v60
    v_max_f32 v61, s49, v61
    v_pk_add_f32 v[60:61], v[60:61], v[4:5]
    v_cvt_pk_bf16_f32 v112, v60, v61
    v_pk_mul_f32 v[6:7], v[62:63], s[48:49] op_sel_hi:[1,0]
    v_exp_f32 v6, v6 clamp
    v_exp_f32 v7, v7 clamp
    v_max_f32 v62, s49, v62
    v_max_f32 v63, s49, v63
    v_pk_add_f32 v[62:63], v[62:63], v[6:7]
    v_cvt_pk_bf16_f32 v113, v62, v63
    v_pk_mul_f32 v[4:5], v[80:81], s[48:49] op_sel_hi:[1,0]
    v_exp_f32 v4, v4 clamp
    v_exp_f32 v5, v5 clamp
    v_max_f32 v80, s49, v80
    v_max_f32 v81, s49, v81
    v_pk_add_f32 v[80:81], v[80:81], v[4:5]
    v_cvt_pk_bf16_f32 v114, v80, v81
    v_pk_mul_f32 v[6:7], v[82:83], s[48:49] op_sel_hi:[1,0]
    v_exp_f32 v6, v6 clamp
    v_exp_f32 v7, v7 clamp
    v_max_f32 v82, s49, v82
    v_max_f32 v83, s49, v83
    v_pk_add_f32 v[82:83], v[82:83], v[6:7]
    v_cvt_pk_bf16_f32 v115, v82, v83
    v_mfma_f32_16x16x32_bf16 v[156:159], v[108:111], v[124:127], 0
    v_mfma_f32_16x16x32_bf16 v[160:163], v[108:111], v[132:135], 0
    v_mfma_f32_16x16x32_bf16 v[164:167], v[108:111], v[140:143], 0
    v_mfma_f32_16x16x32_bf16 v[156:159], v[112:115], v[128:131], v[156:159]
    v_mfma_f32_16x16x32_bf16 v[160:163], v[112:115], v[136:139], v[160:163]
    v_mfma_f32_16x16x32_bf16 v[164:167], v[112:115], v[144:147], v[164:167]
    ds_write_b128 v200, v[148:151]
    ds_write_b128 v201, v[152:155]
    v_pk_mul_f32 v[4:5], v[24:25], s[48:49] op_sel_hi:[1,0]
    v_exp_f32 v4, v4 clamp
    v_exp_f32 v5, v5 clamp
    v_max_f32 v24, s49, v24
    v_max_f32 v25, s49, v25
    v_pk_add_f32 v[24:25], v[24:25], v[4:5]
    v_cvt_pk_bf16_f32 v116, v24, v25
    v_pk_mul_f32 v[6:7], v[26:27], s[48:49] op_sel_hi:[1,0]
    v_exp_f32 v6, v6 clamp
    v_exp_f32 v7, v7 clamp
    v_max_f32 v26, s49, v26
    v_max_f32 v27, s49, v27
    v_pk_add_f32 v[26:27], v[26:27], v[6:7]
    v_cvt_pk_bf16_f32 v117, v26, v27
    v_pk_mul_f32 v[4:5], v[44:45], s[48:49] op_sel_hi:[1,0]
    v_exp_f32 v4, v4 clamp
    v_exp_f32 v5, v5 clamp
    v_max_f32 v44, s49, v44
    v_max_f32 v45, s49, v45
    v_pk_add_f32 v[44:45], v[44:45], v[4:5]
    v_cvt_pk_bf16_f32 v118, v44, v45
    v_pk_mul_f32 v[6:7], v[46:47], s[48:49] op_sel_hi:[1,0]
    v_exp_f32 v6, v6 clamp
    v_exp_f32 v7, v7 clamp
    v_max_f32 v46, s49, v46
    v_max_f32 v47, s49, v47
    v_pk_add_f32 v[46:47], v[46:47], v[6:7]
    v_cvt_pk_bf16_f32 v119, v46, v47
    v_pk_mul_f32 v[4:5], v[64:65], s[48:49] op_sel_hi:[1,0]
    v_exp_f32 v4, v4 clamp
    v_exp_f32 v5, v5 clamp
    v_max_f32 v64, s49, v64
    v_max_f32 v65, s49, v65
    v_pk_add_f32 v[64:65], v[64:65], v[4:5]
    v_cvt_pk_bf16_f32 v120, v64, v65
    v_pk_mul_f32 v[6:7], v[66:67], s[48:49] op_sel_hi:[1,0]
    v_exp_f32 v6, v6 clamp
    v_exp_f32 v7, v7 clamp
    v_max_f32 v66, s49, v66
    v_max_f32 v67, s49, v67
    v_pk_add_f32 v[66:67], v[66:67], v[6:7]
    v_cvt_pk_bf16_f32 v121, v66, v67
    v_pk_mul_f32 v[4:5], v[84:85], s[48:49] op_sel_hi:[1,0]
    v_exp_f32 v4, v4 clamp
    v_exp_f32 v5, v5 clamp
    v_max_f32 v84, s49, v84
    v_max_f32 v85, s49, v85
    v_pk_add_f32 v[84:85], v[84:85], v[4:5]
    v_cvt_pk_bf16_f32 v122, v84, v85
    v_pk_mul_f32 v[6:7], v[86:87], s[48:49] op_sel_hi:[1,0]
    v_exp_f32 v6, v6 clamp
    v_exp_f32 v7, v7 clamp
    v_max_f32 v86, s49, v86
    v_max_f32 v87, s49, v87
    v_pk_add_f32 v[86:87], v[86:87], v[6:7]
    v_cvt_pk_bf16_f32 v123, v86, v87
    v_mfma_f32_16x16x32_bf16 v[168:171], v[116:119], v[124:127], 0
    v_mfma_f32_16x16x32_bf16 v[172:175], v[116:119], v[132:135], 0
    v_mfma_f32_16x16x32_bf16 v[176:179], v[116:119], v[140:143], 0
    v_mfma_f32_16x16x32_bf16 v[168:171], v[120:123], v[128:131], v[168:171]
    v_mfma_f32_16x16x32_bf16 v[172:175], v[120:123], v[136:139], v[172:175]
    v_mfma_f32_16x16x32_bf16 v[176:179], v[120:123], v[144:147], v[176:179]
    ds_write_b128 v202, v[156:159]
    ds_write_b128 v203, v[160:163]
    ds_write_b128 v204, v[164:167]
    s_nop 2
    ds_write_b128 v205, v[168:171]
    ds_write_b128 v206, v[172:175]
    ds_write_b128 v207, v[176:179]
    s_waitcnt lgkmcnt(0)
    s_barrier
    ds_read2st64_b32 v[16:17], v208 offset0:0 offset1:16
    ds_read2st64_b32 v[18:19], v208 offset0:1 offset1:17
    ds_read2st64_b32 v[20:21], v208 offset0:2 offset1:18
    ds_read2st64_b32 v[22:23], v208 offset0:3 offset1:19
    ds_read2st64_b32 v[24:25], v208 offset0:4 offset1:20
    ds_read2st64_b32 v[26:27], v208 offset0:5 offset1:21
    ds_read2st64_b32 v[28:29], v208 offset0:6 offset1:22
    s_waitcnt lgkmcnt(6)
    v_add_f32 v16, v16, v17
    buffer_atomic_add_f32 v16, v209, s[12:15], 0 offen offset:0
    s_waitcnt lgkmcnt(5)
    v_add_f32 v18, v18, v19
    buffer_atomic_add_f32 v18, v209, s[12:15], 0 offen offset:256
    s_waitcnt lgkmcnt(4)
    v_add_f32 v20, v20, v21
    buffer_atomic_add_f32 v20, v209, s[12:15], 0 offen offset:512
    s_waitcnt lgkmcnt(3)
    v_add_f32 v22, v22, v23
    buffer_atomic_add_f32 v22, v209, s[12:15], 0 offen offset:768
    s_waitcnt lgkmcnt(2)
    v_add_f32 v24, v24, v25
    buffer_atomic_add_f32 v24, v209, s[12:15], 0 offen offset:1024
    s_waitcnt lgkmcnt(1)
    v_add_f32 v26, v26, v27
    buffer_atomic_add_f32 v26, v209, s[12:15], 0 offen offset:1280
    s_waitcnt lgkmcnt(0)
    v_add_f32 v28, v28, v29
    buffer_atomic_add_f32 v28, v210, s[12:15], 0 offen offset:1536
    s_branch Lp2a
LepiFQ:
    s_cmp_eq_u32 s42, 0
    s_cbranch_scc0 LepiQ
    s_mov_b32 s62, 0
    s_mov_b32 s63, 655360
    s_mov_b32 s64, 1310720
    s_mov_b32 s65, 1966080
    v_cvt_pk_bf16_f32 v100, v16, v17
    v_cvt_pk_bf16_f32 v101, v18, v19
    v_cvt_pk_bf16_f32 v102, v36, v37
    v_cvt_pk_bf16_f32 v103, v38, v39
    v_cvt_pk_bf16_f32 v104, v56, v57
    v_cvt_pk_bf16_f32 v105, v58, v59
    v_cvt_pk_bf16_f32 v106, v76, v77
    v_cvt_pk_bf16_f32 v107, v78, v79
    v_mfma_f32_16x16x32_bf16 v[140:143], a[120:123], v[100:103], 0
    v_cvt_pk_bf16_f32 v108, v20, v21
    v_mfma_f32_16x16x32_bf16 v[144:147], a[128:131], v[100:103], 0
    v_cvt_pk_bf16_f32 v109, v22, v23
    v_mfma_f32_16x16x32_bf16 v[148:151], a[136:139], v[100:103], 0
    v_cvt_pk_bf16_f32 v110, v40, v41
    v_mfma_f32_16x16x32_bf16 v[152:155], a[144:147], v[100:103], 0
    v_cvt_pk_bf16_f32 v111, v42, v43
    v_mfma_f32_16x16x32_bf16 v[140:143], a[124:127], v[104:107], v[140:143]
    v_cvt_pk_bf16_f32 v112, v60, v61
    v_mfma_f32_16x16x32_bf16 v[144:147], a[132:135], v[104:107], v[144:147]
    v_cvt_pk_bf16_f32 v113, v62, v63
    v_mfma_f32_16x16x32_bf16 v[148:151], a[140:143], v[104:107], v[148:151]
    v_cvt_pk_bf16_f32 v114, v80, v81
    v_mfma_f32_16x16x32_bf16 v[152:155], a[148:151], v[104:107], v[152:155]
    v_cvt_pk_bf16_f32 v115, v82, v83
    v_mfma_f32_16x16x32_bf16 v[156:159], a[120:123], v[108:111], 0
    v_cvt_pk_bf16_f32 v116, v24, v25
    v_cvt_pk_bf16_f32 v117, v26, v27
    v_mfma_f32_16x16x32_bf16 v[160:163], a[128:131], v[108:111], 0
    v_cvt_pk_bf16_f32 v118, v44, v45
    v_cvt_pk_bf16_f32 v119, v46, v47
    v_mfma_f32_16x16x32_bf16 v[164:167], a[136:139], v[108:111], 0
    v_cvt_pk_bf16_f32 v120, v64, v65
    v_cvt_pk_bf16_f32 v121, v66, v67
    v_mfma_f32_16x16x32_bf16 v[168:171], a[144:147], v[108:111], 0
    v_cvt_pk_bf16_f32 v122, v84, v85
    v_cvt_pk_bf16_f32 v123, v86, v87
    v_mfma_f32_16x16x32_bf16 v[156:159], a[124:127], v[112:115], v[156:159]
    v_cvt_pk_bf16_f32 v172, v140, v141
    v_cvt_pk_bf16_f32 v173, v142, v143
    buffer_store_dwordx2 v[172:173], v208, s[12:15], s62 offen offset:0 sc1
    v_mfma_f32_16x16x32_bf16 v[160:163], a[132:135], v[112:115], v[160:163]
    v_cvt_pk_bf16_f32 v174, v144, v145
    v_cvt_pk_bf16_f32 v175, v146, v147
    buffer_store_dwordx2 v[174:175], v208, s[12:15], s63 offen offset:0 sc1
    v_mfma_f32_16x16x32_bf16 v[164:167], a[140:143], v[112:115], v[164:167]
    v_cvt_pk_bf16_f32 v176, v148, v149
    v_cvt_pk_bf16_f32 v177, v150, v151
    buffer_store_dwordx2 v[176:177], v208, s[12:15], s64 offen offset:0 sc1
    v_mfma_f32_16x16x32_bf16 v[168:171], a[148:151], v[112:115], v[168:171]
    v_cvt_pk_bf16_f32 v178, v152, v153
    v_cvt_pk_bf16_f32 v179, v154, v155
    buffer_store_dwordx2 v[178:179], v208, s[12:15], s65 offen offset:0 sc1
    v_mfma_f32_16x16x32_bf16 v[140:143], a[120:123], v[116:119], 0
    v_cvt_pk_bf16_f32 v124, v28, v29
    v_cvt_pk_bf16_f32 v125, v30, v31
    v_mfma_f32_16x16x32_bf16 v[144:147], a[128:131], v[116:119], 0
    v_cvt_pk_bf16_f32 v126, v48, v49
    v_cvt_pk_bf16_f32 v127, v50, v51
    v_mfma_f32_16x16x32_bf16 v[148:151], a[136:139], v[116:119], 0
    v_cvt_pk_bf16_f32 v128, v68, v69
    v_cvt_pk_bf16_f32 v129, v70, v71
    v_mfma_f32_16x16x32_bf16 v[152:155], a[144:147], v[116:119], 0
    v_cvt_pk_bf16_f32 v130, v88, v89
    v_cvt_pk_bf16_f32 v131, v90, v91
    v_mfma_f32_16x16x32_bf16 v[140:143], a[124:127], v[120:123], v[140:143]
    v_cvt_pk_bf16_f32 v172, v156, v157
    v_cvt_pk_bf16_f32 v173, v158, v159
    buffer_store_dwordx2 v[172:173], v208, s[12:15], s62 offen offset:128 sc1
    v_mfma_f32_16x16x32_bf16 v[144:147], a[132:135], v[120:123], v[144:147]
    v_cvt_pk_bf16_f32 v174, v160, v161
    v_cvt_pk_bf16_f32 v175, v162, v163
    buffer_store_dwordx2 v[174:175], v208, s[12:15], s63 offen offset:128 sc1
    v_mfma_f32_16x16x32_bf16 v[148:151], a[140:143], v[120:123], v[148:151]
    v_cvt_pk_bf16_f32 v176, v164, v165
    v_cvt_pk_bf16_f32 v177, v166, v167
    buffer_store_dwordx2 v[176:177], v208, s[12:15], s64 offen offset:128 sc1
    v_mfma_f32_16x16x32_bf16 v[152:155], a[148:151], v[120:123], v[152:155]
    v_cvt_pk_bf16_f32 v178, v168, v169
    v_cvt_pk_bf16_f32 v179, v170, v171
    buffer_store_dwordx2 v[178:179], v208, s[12:15], s65 offen offset:128 sc1
    v_mfma_f32_16x16x32_bf16 v[156:159], a[120:123], v[124:127], 0
    v_cvt_pk_bf16_f32 v132, v32, v33
    v_cvt_pk_bf16_f32 v133, v34, v35
    v_mfma_f32_16x16x32_bf16 v[160:163], a[128:131], v[124:127], 0
    v_cvt_pk_bf16_f32 v134, v52, v53
    v_cvt_pk_bf16_f32 v135, v54, v55
    v_mfma_f32_16x16x32_bf16 v[164:167], a[136:139], v[124:127], 0
    v_cvt_pk_bf16_f32 v136, v72, v73
    v_cvt_pk_bf16_f32 v137, v74, v75
    v_mfma_f32_16x16x32_bf16 v[168:171], a[144:147], v[124:127], 0
    v_cvt_pk_bf16_f32 v138, v92, v93
    v_cvt_pk_bf16_f32 v139, v94, v95
    v_mfma_f32_16x16x32_bf16 v[156:159], a[124:127], v[128:131], v[156:159]
    v_cvt_pk_bf16_f32 v172, v140, v141
    v_cvt_pk_bf16_f32 v173, v142, v143
    buffer_store_dwordx2 v[172:173], v208, s[12:15], s62 offen offset:256 sc1
    v_mfma_f32_16x16x32_bf16 v[160:163], a[132:135], v[128:131], v[160:163]
    v_cvt_pk_bf16_f32 v174, v144, v145
    v_cvt_pk_bf16_f32 v175, v146, v147
    buffer_store_dwordx2 v[174:175], v208, s[12:15], s63 offen offset:256 sc1
    v_mfma_f32_16x16x32_bf16 v[164:167], a[140:143], v[128:131], v[164:167]
    v_cvt_pk_bf16_f32 v176, v148, v149
    v_cvt_pk_bf16_f32 v177, v150, v151
    buffer_store_dwordx2 v[176:177], v208, s[12:15], s64 offen offset:256 sc1
    v_mfma_f32_16x16x32_bf16 v[168:171], a[148:151], v[128:131], v[168:171]
    v_cvt_pk_bf16_f32 v178, v152, v153
    v_cvt_pk_bf16_f32 v179, v154, v155
    buffer_store_dwordx2 v[178:179], v208, s[12:15], s65 offen offset:256 sc1
    v_mfma_f32_16x16x32_bf16 v[140:143], a[120:123], v[132:135], 0
    v_mfma_f32_16x16x32_bf16 v[144:147], a[128:131], v[132:135], 0
    v_mfma_f32_16x16x32_bf16 v[148:151], a[136:139], v[132:135], 0
    v_mfma_f32_16x16x32_bf16 v[152:155], a[144:147], v[132:135], 0
    v_mfma_f32_16x16x32_bf16 v[140:143], a[124:127], v[136:139], v[140:143]
    v_cvt_pk_bf16_f32 v172, v156, v157
    v_cvt_pk_bf16_f32 v173, v158, v159
    buffer_store_dwordx2 v[172:173], v208, s[12:15], s62 offen offset:384 sc1
    v_mfma_f32_16x16x32_bf16 v[144:147], a[132:135], v[136:139], v[144:147]
    v_cvt_pk_bf16_f32 v174, v160, v161
    v_cvt_pk_bf16_f32 v175, v162, v163
    buffer_store_dwordx2 v[174:175], v208, s[12:15], s63 offen offset:384 sc1
    v_mfma_f32_16x16x32_bf16 v[148:151], a[140:143], v[136:139], v[148:151]
    v_cvt_pk_bf16_f32 v176, v164, v165
    v_cvt_pk_bf16_f32 v177, v166, v167
    buffer_store_dwordx2 v[176:177], v208, s[12:15], s64 offen offset:384 sc1
    v_mfma_f32_16x16x32_bf16 v[152:155], a[148:151], v[136:139], v[152:155]
    v_cvt_pk_bf16_f32 v178, v168, v169
    v_cvt_pk_bf16_f32 v179, v170, v171
    buffer_store_dwordx2 v[178:179], v208, s[12:15], s65 offen offset:384 sc1
    v_cvt_pk_bf16_f32 v172, v140, v141
    v_cvt_pk_bf16_f32 v173, v142, v143
    buffer_store_dwordx2 v[172:173], v208, s[12:15], s62 offen offset:512 sc1
    v_cvt_pk_bf16_f32 v174, v144, v145
    v_cvt_pk_bf16_f32 v175, v146, v147
    buffer_store_dwordx2 v[174:175], v208, s[12:15], s63 offen offset:512 sc1
    v_cvt_pk_bf16_f32 v176, v148, v149
    v_cvt_pk_bf16_f32 v177, v150, v151
    buffer_store_dwordx2 v[176:177], v208, s[12:15], s64 offen offset:512 sc1
    v_cvt_pk_bf16_f32 v178, v152, v153
    v_cvt_pk_bf16_f32 v179, v154, v155
    buffer_store_dwordx2 v[178:179], v208, s[12:15], s65 offen offset:512 sc1
    s_waitcnt vmcnt(0)
    v_mov_b32 v4, s46
    s_mov_b64 exec, 1
    buffer_store_dword v4, v211, s[12:15], 0 offen sc1
    s_mov_b64 exec, -1
    s_cmp_eq_u32 s60, 0
    s_cbranch_scc1 Lp3
Lp2a:
    s_cmp_eq_u32 s56, 0
    s_cbranch_scc0 Ldotg
    s_cmp_eq_u32 s43, 0
    s_cbranch_scc0 Lnp0
    s_waitcnt vmcnt(0)
    v_mov_b32 v8, s46
    s_mov_b64 exec, 1
    buffer_store_dword v8, v211, s[12:15], 0 offen sc1
    s_mov_b64 exec, -1
Lnp0:
    s_branch Lskiptg
Ldotg:
    v_lshlrev_b32 v4, 6, v2
    v_add_u32 v4, s56, v4
    v_cvt_f32_u32 v4, v4
    v_mul_f32 v4, 0x3a000000, v4
    v_add_f32 v5, 0.5, v4
    v_lshlrev_b32 v6, 2, v3
    v_cvt_f32_u32 v6, v6
    v_mul_f32 v121, v4, v6
    v_cos_f32 v120, v121
    v_sin_f32 v121, v121
    v_mul_f32 v125, v5, v6
    v_cos_f32 v124, v125
    v_sin_f32 v125, v125
    v_cvt_pk_bf16_f32 v156, v120, -v121
    v_accvgpr_write_b32 a192, v156
    v_cvt_pk_bf16_f32 v157, v121, v120
    v_accvgpr_write_b32 a208, v157
    v_cvt_pk_bf16_f32 v158, v124, -v125
    v_accvgpr_write_b32 a200, v158
    v_cvt_pk_bf16_f32 v159, v125, v124
    v_accvgpr_write_b32 a216, v159
    v_add_f32 v7, 0x3f800000, v6
    v_mul_f32 v121, v4, v7
    v_cos_f32 v120, v121
    v_sin_f32 v121, v121
    v_mul_f32 v125, v5, v7
    v_cos_f32 v124, v125
    v_sin_f32 v125, v125
    v_cvt_pk_bf16_f32 v156, v120, -v121
    v_accvgpr_write_b32 a193, v156
    v_cvt_pk_bf16_f32 v157, v121, v120
    v_accvgpr_write_b32 a209, v157
    v_cvt_pk_bf16_f32 v158, v124, -v125
    v_accvgpr_write_b32 a201, v158
    v_cvt_pk_bf16_f32 v159, v125, v124
    v_accvgpr_write_b32 a217, v159
    v_add_f32 v7, 0x40000000, v6
    v_mul_f32 v121, v4, v7
    v_cos_f32 v120, v121
    v_sin_f32 v121, v121
    v_mul_f32 v125, v5, v7
    v_cos_f32 v124, v125
    v_sin_f32 v125, v125
    v_cvt_pk_bf16_f32 v156, v120, -v121
    v_accvgpr_write_b32 a194, v156
    v_cvt_pk_bf16_f32 v157, v121, v120
    v_accvgpr_write_b32 a210, v157
    v_cvt_pk_bf16_f32 v158, v124, -v125
    v_accvgpr_write_b32 a202, v158
    v_cvt_pk_bf16_f32 v159, v125, v124
    v_accvgpr_write_b32 a218, v159
    v_add_f32 v7, 0x40400000, v6
    v_mul_f32 v121, v4, v7
    v_cos_f32 v120, v121
    v_sin_f32 v121, v121
    v_mul_f32 v125, v5, v7
    v_cos_f32 v124, v125
    v_sin_f32 v125, v125
    v_cvt_pk_bf16_f32 v156, v120, -v121
    v_accvgpr_write_b32 a195, v156
    v_cvt_pk_bf16_f32 v157, v121, v120
    v_accvgpr_write_b32 a211, v157
    v_cvt_pk_bf16_f32 v158, v124, -v125
    v_accvgpr_write_b32 a203, v158
    v_cvt_pk_bf16_f32 v159, v125, v124
    v_accvgpr_write_b32 a219, v159
    v_add_f32 v7, 0x41800000, v6
    v_mul_f32 v121, v4, v7
    v_cos_f32 v120, v121
    v_sin_f32 v121, v121
    v_mul_f32 v125, v5, v7
    v_cos_f32 v124, v125
    v_sin_f32 v125, v125
    v_cvt_pk_bf16_f32 v156, v120, -v121
    v_accvgpr_write_b32 a196, v156
    v_cvt_pk_bf16_f32 v157, v121, v120
    v_accvgpr_write_b32 a212, v157
    v_cvt_pk_bf16_f32 v158, v124, -v125
    v_accvgpr_write_b32 a204, v158
    v_cvt_pk_bf16_f32 v159, v125, v124
    v_accvgpr_write_b32 a220, v159
    v_add_f32 v7, 0x41880000, v6
    v_mul_f32 v121, v4, v7
    v_cos_f32 v120, v121
    v_sin_f32 v121, v121
    v_mul_f32 v125, v5, v7
    v_cos_f32 v124, v125
    v_sin_f32 v125, v125
    v_cvt_pk_bf16_f32 v156, v120, -v121
    v_accvgpr_write_b32 a197, v156
    v_cvt_pk_bf16_f32 v157, v121, v120
    v_accvgpr_write_b32 a213, v157
    v_cvt_pk_bf16_f32 v158, v124, -v125
    v_accvgpr_write_b32 a205, v158
    v_cvt_pk_bf16_f32 v159, v125, v124
    v_accvgpr_write_b32 a221, v159
    v_add_f32 v7, 0x41900000, v6
    v_mul_f32 v121, v4, v7
    v_cos_f32 v120, v121
    v_sin_f32 v121, v121
    v_mul_f32 v125, v5, v7
    v_cos_f32 v124, v125
    v_sin_f32 v125, v125
    v_cvt_pk_bf16_f32 v156, v120, -v121
    v_accvgpr_write_b32 a198, v156
    v_cvt_pk_bf16_f32 v157, v121, v120
    v_accvgpr_write_b32 a214, v157
    v_cvt_pk_bf16_f32 v158, v124, -v125
    v_accvgpr_write_b32 a206, v158
    v_cvt_pk_bf16_f32 v159, v125, v124
    v_accvgpr_write_b32 a222, v159
    v_add_f32 v7, 0x41980000, v6
    v_mul_f32 v121, v4, v7
    v_cos_f32 v120, v121
    v_sin_f32 v121, v121
    v_mul_f32 v125, v5, v7
    v_cos_f32 v124, v125
    v_sin_f32 v125, v125
    v_cvt_pk_bf16_f32 v156, v120, -v121
    v_accvgpr_write_b32 a199, v156
    v_cvt_pk_bf16_f32 v157, v121, v120
    v_accvgpr_write_b32 a215, v157
    v_cvt_pk_bf16_f32 v158, v124, -v125
    v_accvgpr_write_b32 a207, v158
    v_cvt_pk_bf16_f32 v159, v125, v124
    v_accvgpr_write_b32 a223, v159
    v_lshlrev_b32 v4, 8, v3
    v_add_u32 v4, s56, v4
    v_cvt_f32_u32 v4, v4
    v_mul_f32 v4, 0x3a000000, v4
    v_cvt_f32_u32 v6, v2
    v_add_f32 v7, 0x41800000, v6
    v_mul_f32 v124, v4, v6
    v_cos_f32 v120, v124
    v_sin_f32 v124, v124
    v_mul_f32 v132, v4, v7
    v_cos_f32 v128, v132
    v_sin_f32 v132, v132
    v_add_f32 v5, 0x3d000000, v4
    v_mul_f32 v125, v5, v6
    v_cos_f32 v121, v125
    v_sin_f32 v125, v125
    v_mul_f32 v133, v5, v7
    v_cos_f32 v129, v133
    v_sin_f32 v133, v133
    v_add_f32 v5, 0x3d800000, v4
    v_mul_f32 v126, v5, v6
    v_cos_f32 v122, v126
    v_sin_f32 v126, v126
    v_mul_f32 v134, v5, v7
    v_cos_f32 v130, v134
    v_sin_f32 v134, v134
    v_add_f32 v5, 0x3dc00000, v4
    v_mul_f32 v127, v5, v6
    v_cos_f32 v123, v127
    v_sin_f32 v127, v127
    v_mul_f32 v135, v5, v7
    v_cos_f32 v131, v135
    v_sin_f32 v135, v135
    v_cvt_pk_bf16_f32 v156, v120, v121
    v_accvgpr_write_b32 a224, v156
    v_accvgpr_write_b32 a242, v156
    v_cvt_pk_bf16_f32 v157, v124, v125
    v_accvgpr_write_b32 a226, v157
    v_cvt_pk_bf16_f32 v158, -v124, -v125
    v_accvgpr_write_b32 a240, v158
    v_cvt_pk_bf16_f32 v159, v122, v123
    v_accvgpr_write_b32 a225, v159
    v_accvgpr_write_b32 a243, v159
    v_cvt_pk_bf16_f32 v156, v126, v127
    v_accvgpr_write_b32 a227, v156
    v_cvt_pk_bf16_f32 v157, -v126, -v127
    v_accvgpr_write_b32 a241, v157
    v_cvt_pk_bf16_f32 v158, v128, v129
    v_accvgpr_write_b32 a232, v158
    v_accvgpr_write_b32 a250, v158
    v_cvt_pk_bf16_f32 v159, v132, v133
    v_accvgpr_write_b32 a234, v159
    v_cvt_pk_bf16_f32 v156, -v132, -v133
    v_accvgpr_write_b32 a248, v156
    v_cvt_pk_bf16_f32 v157, v130, v131
    v_accvgpr_write_b32 a233, v157
    v_accvgpr_write_b32 a251, v157
    v_cvt_pk_bf16_f32 v158, v134, v135
    v_accvgpr_write_b32 a235, v158
    v_cvt_pk_bf16_f32 v159, -v134, -v135
    v_accvgpr_write_b32 a249, v159
    v_add_f32 v5, 0x3f000000, v4
    v_mul_f32 v124, v5, v6
    v_cos_f32 v120, v124
    v_sin_f32 v124, v124
    v_mul_f32 v132, v5, v7
    v_cos_f32 v128, v132
    v_sin_f32 v132, v132
    s_cmp_eq_u32 s43, 0
    s_cbranch_scc0 Lnp1
    s_waitcnt vmcnt(0)
    v_mov_b32 v8, s46
    s_mov_b64 exec, 1
    buffer_store_dword v8, v211, s[12:15], 0 offen sc1
    s_mov_b64 exec, -1
Lnp1:
    v_add_f32 v5, 0x3f080000, v4
    v_mul_f32 v125, v5, v6
    v_cos_f32 v121, v125
    v_sin_f32 v125, v125
    v_mul_f32 v133, v5, v7
    v_cos_f32 v129, v133
    v_sin_f32 v133, v133
    v_add_f32 v5, 0x3f100000, v4
    v_mul_f32 v126, v5, v6
    v_cos_f32 v122, v126
    v_sin_f32 v126, v126
    v_mul_f32 v134, v5, v7
    v_cos_f32 v130, v134
    v_sin_f32 v134, v134
    v_add_f32 v5, 0x3f180000, v4
    v_mul_f32 v127, v5, v6
    v_cos_f32 v123, v127
    v_sin_f32 v127, v127
    v_mul_f32 v135, v5, v7
    v_cos_f32 v131, v135
    v_sin_f32 v135, v135
    v_cvt_pk_bf16_f32 v156, v120, v121
    v_accvgpr_write_b32 a228, v156
    v_accvgpr_write_b32 a246, v156
    v_cvt_pk_bf16_f32 v157, v124, v125
    v_accvgpr_write_b32 a230, v157
    v_cvt_pk_bf16_f32 v158, -v124, -v125
    v_accvgpr_write_b32 a244, v158
    v_cvt_pk_bf16_f32 v159, v122, v123
    v_accvgpr_write_b32 a229, v159
    v_accvgpr_write_b32 a247, v159
    v_cvt_pk_bf16_f32 v156, v126, v127
    v_accvgpr_write_b32 a231, v156
    v_cvt_pk_bf16_f32 v157, -v126, -v127
    v_accvgpr_write_b32 a245, v157
    v_cvt_pk_bf16_f32 v158, v128, v129
    v_accvgpr_write_b32 a236, v158
    v_accvgpr_write_b32 a254, v158
    v_cvt_pk_bf16_f32 v159, v132, v133
    v_accvgpr_write_b32 a238, v159
    v_cvt_pk_bf16_f32 v156, -v132, -v133
    v_accvgpr_write_b32 a252, v156
    v_cvt_pk_bf16_f32 v157, v130, v131
    v_accvgpr_write_b32 a237, v157
    v_accvgpr_write_b32 a255, v157
    v_cvt_pk_bf16_f32 v158, v134, v135
    v_accvgpr_write_b32 a239, v158
    v_cvt_pk_bf16_f32 v159, -v134, -v135
    v_accvgpr_write_b32 a253, v159
Lskiptg:
    s_mul_i32 s62, s57, 26240
    s_add_u32 s63, s62, 25420
    s_lshr_b32 s62, s62, 16
    s_lshr_b32 s63, s63, 16
    v_mov_b32 v4, s62
    v_mov_b32 v5, s63
    v_cmp_gt_u32 vcc, 32, v1
    s_nop 1
    v_cndmask_b32 v4, v5, v4, vcc
    v_and_b32 v5, 31, v1
    v_lshl_add_u32 v4, v4, 5, v5
    v_lshlrev_b32 v4, 7, v4
    v_add_u32 v9, 8921088, v4
    s_lshr_b32 s62, s56, 1
    s_mul_i32 s62, s62, 163840
    s_lshl_b32 s63, s57, 8
    s_add_u32 s62, s62, s63
    s_lshl_b32 s63, s41, 2
    s_add_u32 s62, s62, s63
    v_mul_u32_u24 v4, 20480, v3
    v_lshl_add_u32 v4, v2, 3, v4
    v_add_u32 v8, s62, v4
    s_mul_i32 s62, s42, 8704
    s_add_u32 s62, s62, 24576
    s_lshl_b32 s63, s41, 5
    s_add_u32 s63, s63, s62
    v_mul_u32_u24 v10, 272, v2
    v_lshl_add_u32 v10, v3, 6, v10
    v_add_u32 v10, s63, v10
    s_mul_i32 s63, s41, 4352
    s_add_u32 s63, s63, s62
    v_mul_u32_u24 v11, 272, v3
    v_lshl_add_u32 v11, v2, 4, v11
    v_add_u32 v11, s63, v11
    s_mul_i32 s62, s41, 1310720
    s_lshl_b32 s63, s57, 12
    s_add_u32 s62, s62, s63
    s_lshr_b32 s63, s56, 1
    s_lshl_b32 s63, s63, 8
    s_add_u32 s62, s62, s63
    s_add_u32 s62, s62, 2621440
    s_mov_b32 s63, 81920
    v_lshlrev_b32 v12, 4, v2
    v_mad_u32_u24 v12, v3, s63, v12
    v_add_u32 v12, s62, v12
    s_lshl_b32 s62, s42, 2
    s_add_u32 s62, s62, 155648
    v_mov_b32 v13, s62
    s_cmp_ge_u32 s57, 10
    s_cselect_b32 s65, 10, 0
    s_cselect_b32 s66, 96, 0
    s_sub_u32 s65, s57, s65
    s_lshl_b32 s62, s65, 3
    s_add_u32 s62, s62, s45
    s_add_u32 s62, s62, s66
    s_lshl_b32 s63, s65, 4
    s_lshr_b32 s64, s56, 1
    s_add_u32 s63, s63, s64
    s_sub_u32 s63, s63, 64
    s_add_u32 s63, s63, s66
    s_cmp_eq_u32 s43, 0
    s_cselect_b32 s62, s62, s63
    s_cselect_b32 s60, 3, 1
    s_and_b32 s63, s62, 1
    s_lshl_b32 s63, s63, 2
    s_lshr_b32 s62, s62, 1
    s_lshl_b32 s62, s62, 7
    s_add_u32 s62, s62, s63
    s_add_u32 s62, s62, 9019392
    v_mov_b32 v15, s62
Lp2b:
    s_cmp_eq_u32 s57, 0
    s_cbranch_scc0 Lnosp1
    s_lshl_b32 s62, s40, 9
    s_add_u32 s62, s62, 155712
    v_lshlrev_b32 v4, 2, v1
    v_add_u32 v4, s62, v4
    v_lshlrev_b32 v5, 4, v3
    v_add_u32 v5, s62, v5
    ds_write_b32 v4, v252
    ds_write_b32 v4, v253 offset:256
    ds_read_b128 v[112:115], v5 offset:0
    ds_read_b128 v[116:119], v5 offset:64
    ds_read_b128 v[120:123], v5 offset:256
    ds_read_b128 v[124:127], v5 offset:320
    ds_read_b128 v[128:131], v5 offset:128
    ds_read_b128 v[132:135], v5 offset:192
    ds_read_b128 v[136:139], v5 offset:384
    ds_read_b128 v[140:143], v5 offset:448
Lnosp1:
    s_waitcnt lgkmcnt(0)
    s_mov_b32 s61, 0x40000
    buffer_load_dword v14, v9, s[12:15], 0 offen sc1
    s_waitcnt vmcnt(0)
Lpoll3:
    v_cmp_ne_u32 vcc, s46, v14
    s_cbranch_vccz Lpoll3d
    s_mov_b64 exec, vcc
    s_sleep 6
    buffer_load_dword v14, v9, s[12:15], 0 offen sc1
    s_sub_u32 s61, s61, 1
    s_waitcnt vmcnt(0)
    s_cbranch_scc0 Lpoll3
Lpoll3d:
    s_mov_b64 exec, -1
    s_mov_b32 s62, 0
    buffer_load_dword v144, v8, s[12:15], s62 offen offset:0 sc1
    buffer_load_dword v152, v8, s[12:15], s62 offen offset:128 sc1
    s_mov_b32 s62, 5120
    buffer_load_dword v145, v8, s[12:15], s62 offen offset:0 sc1
    buffer_load_dword v153, v8, s[12:15], s62 offen offset:128 sc1
    s_mov_b32 s62, 10240
    buffer_load_dword v146, v8, s[12:15], s62 offen offset:0 sc1
    buffer_load_dword v154, v8, s[12:15], s62 offen offset:128 sc1
    s_mov_b32 s62, 15360
    buffer_load_dword v147, v8, s[12:15], s62 offen offset:0 sc1
    buffer_load_dword v155, v8, s[12:15], s62 offen offset:128 sc1
    s_mov_b32 s62, 81920
    buffer_load_dword v148, v8, s[12:15], s62 offen offset:0 sc1
    buffer_load_dword v156, v8, s[12:15], s62 offen offset:128 sc1
    s_mov_b32 s62, 87040
    buffer_load_dword v149, v8, s[12:15], s62 offen offset:0 sc1
    buffer_load_dword v157, v8, s[12:15], s62 offen offset:128 sc1
    s_mov_b32 s62, 92160
    buffer_load_dword v150, v8, s[12:15], s62 offen offset:0 sc1
    buffer_load_dword v158, v8, s[12:15], s62 offen offset:128 sc1
    s_mov_b32 s62, 97280
    buffer_load_dword v151, v8, s[12:15], s62 offen offset:0 sc1
    buffer_load_dword v159, v8, s[12:15], s62 offen offset:128 sc1
    s_waitcnt vmcnt(8)
    v_mfma_f32_16x16x32_bf16 v[160:163], a[192:195], v[144:147], 0
    v_mfma_f32_16x16x32_bf16 v[164:167], a[192:195], v[152:155], 0
    v_mfma_f32_16x16x32_bf16 v[176:179], a[208:211], v[144:147], 0
    v_mfma_f32_16x16x32_bf16 v[180:183], a[208:211], v[152:155], 0
    v_mfma_f32_16x16x32_bf16 v[168:171], a[200:203], v[144:147], 0
    v_mfma_f32_16x16x32_bf16 v[172:175], a[200:203], v[152:155], 0
    v_mfma_f32_16x16x32_bf16 v[184:187], a[216:219], v[144:147], 0
    v_mfma_f32_16x16x32_bf16 v[188:191], a[216:219], v[152:155], 0
    s_waitcnt vmcnt(0)
    v_mfma_f32_16x16x32_bf16 v[160:163], a[196:199], v[148:151], v[160:163]
    v_mfma_f32_16x16x32_bf16 v[164:167], a[196:199], v[156:159], v[164:167]
    v_mfma_f32_16x16x32_bf16 v[176:179], a[212:215], v[148:151], v[176:179]
    v_mfma_f32_16x16x32_bf16 v[180:183], a[212:215], v[156:159], v[180:183]
    v_mfma_f32_16x16x32_bf16 v[168:171], a[204:207], v[148:151], v[168:171]
    v_mfma_f32_16x16x32_bf16 v[172:175], a[204:207], v[156:159], v[172:175]
    v_mfma_f32_16x16x32_bf16 v[184:187], a[220:223], v[148:151], v[184:187]
    v_mfma_f32_16x16x32_bf16 v[188:191], a[220:223], v[156:159], v[188:191]
    s_nop 3
    v_pk_add_f32 v[80:81], v[160:161], v[180:181]
    v_pk_add_f32 v[82:83], v[164:165], v[176:177] neg_lo:[0,1] neg_hi:[0,1]
    v_pk_add_f32 v[84:85], v[160:161], v[180:181] neg_lo:[0,1] neg_hi:[0,1]
    v_pk_add_f32 v[86:87], v[164:165], v[176:177]
    v_pk_mul_f32 v[88:89], v[80:81], v[220:221]
    v_pk_mul_f32 v[90:91], v[80:81], v[228:229]
    v_pk_mul_f32 v[92:93], v[84:85], v[236:237]
    v_pk_mul_f32 v[94:95], v[84:85], v[244:245]
    v_pk_fma_f32 v[88:89], v[82:83], v[228:229], v[88:89] neg_lo:[1,0,0] neg_hi:[1,0,0]
    v_pk_fma_f32 v[90:91], v[82:83], v[220:221], v[90:91]
    v_pk_fma_f32 v[92:93], v[86:87], v[244:245], v[92:93] neg_lo:[1,0,0] neg_hi:[1,0,0]
    v_pk_fma_f32 v[94:95], v[86:87], v[236:237], v[94:95]
    v_pk_add_f32 v[16:17], v[88:89], v[92:93]
    v_pk_add_f32 v[24:25], v[90:91], v[94:95]
    v_pk_add_f32 v[32:33], v[94:95], v[90:91] neg_lo:[0,1] neg_hi:[0,1]
    v_pk_add_f32 v[40:41], v[88:89], v[92:93] neg_lo:[0,1] neg_hi:[0,1]
    v_pk_add_f32 v[96:97], v[162:163], v[182:183]
    v_pk_add_f32 v[98:99], v[166:167], v[178:179] neg_lo:[0,1] neg_hi:[0,1]
    v_pk_add_f32 v[100:101], v[162:163], v[182:183] neg_lo:[0,1] neg_hi:[0,1]
    v_pk_add_f32 v[102:103], v[166:167], v[178:179]
    v_pk_mul_f32 v[104:105], v[96:97], v[222:223]
    v_pk_mul_f32 v[106:107], v[96:97], v[230:231]
    v_pk_mul_f32 v[108:109], v[100:101], v[238:239]
    v_pk_mul_f32 v[110:111], v[100:101], v[246:247]
    v_pk_fma_f32 v[104:105], v[98:99], v[230:231], v[104:105] neg_lo:[1,0,0] neg_hi:[1,0,0]
    v_pk_fma_f32 v[106:107], v[98:99], v[222:223], v[106:107]
    v_pk_fma_f32 v[108:109], v[102:103], v[246:247], v[108:109] neg_lo:[1,0,0] neg_hi:[1,0,0]
    v_pk_fma_f32 v[110:111], v[102:103], v[238:239], v[110:111]
    v_pk_add_f32 v[18:19], v[104:105], v[108:109]
    v_pk_add_f32 v[26:27], v[106:107], v[110:111]
    v_pk_add_f32 v[34:35], v[110:111], v[106:107] neg_lo:[0,1] neg_hi:[0,1]
    v_pk_add_f32 v[42:43], v[104:105], v[108:109] neg_lo:[0,1] neg_hi:[0,1]
    v_pk_add_f32 v[80:81], v[168:169], v[188:189]
    v_pk_add_f32 v[82:83], v[172:173], v[184:185] neg_lo:[0,1] neg_hi:[0,1]
    v_pk_add_f32 v[84:85], v[168:169], v[188:189] neg_lo:[0,1] neg_hi:[0,1]
    v_pk_add_f32 v[86:87], v[172:173], v[184:185]
    v_pk_mul_f32 v[88:89], v[80:81], v[224:225]
    v_pk_mul_f32 v[90:91], v[80:81], v[232:233]
    v_pk_mul_f32 v[92:93], v[84:85], v[240:241]
    v_pk_mul_f32 v[94:95], v[84:85], v[248:249]
    v_pk_fma_f32 v[88:89], v[82:83], v[232:233], v[88:89] neg_lo:[1,0,0] neg_hi:[1,0,0]
    v_pk_fma_f32 v[90:91], v[82:83], v[224:225], v[90:91]
    v_pk_fma_f32 v[92:93], v[86:87], v[248:249], v[92:93] neg_lo:[1,0,0] neg_hi:[1,0,0]
    v_pk_fma_f32 v[94:95], v[86:87], v[240:241], v[94:95]
    v_pk_add_f32 v[20:21], v[88:89], v[92:93]
    v_pk_add_f32 v[28:29], v[90:91], v[94:95]
    v_pk_add_f32 v[36:37], v[94:95], v[90:91] neg_lo:[0,1] neg_hi:[0,1]
    v_pk_add_f32 v[44:45], v[88:89], v[92:93] neg_lo:[0,1] neg_hi:[0,1]
    v_pk_add_f32 v[96:97], v[170:171], v[190:191]
    v_pk_add_f32 v[98:99], v[174:175], v[186:187] neg_lo:[0,1] neg_hi:[0,1]
    v_pk_add_f32 v[100:101], v[170:171], v[190:191] neg_lo:[0,1] neg_hi:[0,1]
    v_pk_add_f32 v[102:103], v[174:175], v[186:187]
    v_pk_mul_f32 v[104:105], v[96:97], v[226:227]
    v_pk_mul_f32 v[106:107], v[96:97], v[234:235]
    v_pk_mul_f32 v[108:109], v[100:101], v[242:243]
    v_pk_mul_f32 v[110:111], v[100:101], v[250:251]
    v_pk_fma_f32 v[104:105], v[98:99], v[234:235], v[104:105] neg_lo:[1,0,0] neg_hi:[1,0,0]
    v_pk_fma_f32 v[106:107], v[98:99], v[226:227], v[106:107]
    v_pk_fma_f32 v[108:109], v[102:103], v[250:251], v[108:109] neg_lo:[1,0,0] neg_hi:[1,0,0]
    v_pk_fma_f32 v[110:111], v[102:103], v[242:243], v[110:111]
    v_pk_add_f32 v[22:23], v[104:105], v[108:109]
    v_pk_add_f32 v[30:31], v[106:107], v[110:111]
    v_pk_add_f32 v[38:39], v[110:111], v[106:107] neg_lo:[0,1] neg_hi:[0,1]
    v_pk_add_f32 v[46:47], v[104:105], v[108:109] neg_lo:[0,1] neg_hi:[0,1]
    s_cmp_eq_u32 s56, 0
    s_cbranch_scc0 Lnot0
    s_mov_b64 exec, 0xffff
    v_mul_f32 v16, v160, v220
    v_fma_f32 v16, -v164, v228, v16
    v_mul_f32 v24, v160, v228
    v_fma_f32 v24, v164, v220, v24
    v_mul_f32 v32, v176, v236
    v_fma_f32 v32, -v180, v244, v32
    v_mul_f32 v40, v176, v244
    v_fma_f32 v40, v180, v236, v40
    s_mov_b64 exec, -1
Lnot0:
    s_cmp_eq_u32 s57, 0
    s_cbranch_scc0 Lnosp2
    s_mov_b32 exec_lo, 0x10001
    s_mov_b32 exec_hi, 0x10001
    v_pk_add_f32 v[80:81], v[220:221], v[236:237]
    v_pk_add_f32 v[82:83], v[228:229], v[244:245] neg_lo:[0,1] neg_hi:[0,1]
    v_pk_add_f32 v[84:85], v[112:113], v[128:129]
    v_pk_add_f32 v[86:87], v[120:121], v[136:137] neg_lo:[0,1] neg_hi:[0,1]
    v_pk_mul_f32 v[80:81], v[80:81], 0.5
    v_pk_mul_f32 v[82:83], v[82:83], 0.5
    v_pk_mul_f32 v[84:85], v[84:85], 0.5
    v_pk_mul_f32 v[86:87], v[86:87], 0.5
    v_pk_mul_f32 v[16:17], v[160:161], v[80:81]
    v_pk_mul_f32 v[32:33], v[176:177], v[80:81]
    v_pk_mul_f32 v[24:25], v[164:165], v[84:85]
    v_pk_mul_f32 v[40:41], v[180:181], v[84:85]
    v_pk_fma_f32 v[16:17], v[176:177], v[82:83], v[16:17]
    v_pk_fma_f32 v[32:33], v[160:161], v[82:83], v[32:33] neg_lo:[1,0,0] neg_hi:[1,0,0]
    v_pk_fma_f32 v[24:25], v[180:181], v[86:87], v[24:25]
    v_pk_fma_f32 v[40:41], v[164:165], v[86:87], v[40:41] neg_lo:[1,0,0] neg_hi:[1,0,0]
    v_pk_add_f32 v[80:81], v[222:223], v[238:239]
    v_pk_add_f32 v[82:83], v[230:231], v[246:247] neg_lo:[0,1] neg_hi:[0,1]
    v_pk_add_f32 v[84:85], v[114:115], v[130:131]
    v_pk_add_f32 v[86:87], v[122:123], v[138:139] neg_lo:[0,1] neg_hi:[0,1]
    v_pk_mul_f32 v[80:81], v[80:81], 0.5
    v_pk_mul_f32 v[82:83], v[82:83], 0.5
    v_pk_mul_f32 v[84:85], v[84:85], 0.5
    v_pk_mul_f32 v[86:87], v[86:87], 0.5
    v_pk_mul_f32 v[18:19], v[162:163], v[80:81]
    v_pk_mul_f32 v[34:35], v[178:179], v[80:81]
    v_pk_mul_f32 v[26:27], v[166:167], v[84:85]
    v_pk_mul_f32 v[42:43], v[182:183], v[84:85]
    v_pk_fma_f32 v[18:19], v[178:179], v[82:83], v[18:19]
    v_pk_fma_f32 v[34:35], v[162:163], v[82:83], v[34:35] neg_lo:[1,0,0] neg_hi:[1,0,0]
    v_pk_fma_f32 v[26:27], v[182:183], v[86:87], v[26:27]
    v_pk_fma_f32 v[42:43], v[166:167], v[86:87], v[42:43] neg_lo:[1,0,0] neg_hi:[1,0,0]
    v_pk_add_f32 v[80:81], v[224:225], v[240:241]
    v_pk_add_f32 v[82:83], v[232:233], v[248:249] neg_lo:[0,1] neg_hi:[0,1]
    v_pk_add_f32 v[84:85], v[116:117], v[132:133]
    v_pk_add_f32 v[86:87], v[124:125], v[140:141] neg_lo:[0,1] neg_hi:[0,1]
    v_pk_mul_f32 v[80:81], v[80:81], 0.5
    v_pk_mul_f32 v[82:83], v[82:83], 0.5
    v_pk_mul_f32 v[84:85], v[84:85], 0.5
    v_pk_mul_f32 v[86:87], v[86:87], 0.5
    v_pk_mul_f32 v[20:21], v[168:169], v[80:81]
    v_pk_mul_f32 v[36:37], v[184:185], v[80:81]
    v_pk_mul_f32 v[28:29], v[172:173], v[84:85]
    v_pk_mul_f32 v[44:45], v[188:189], v[84:85]
    v_pk_fma_f32 v[20:21], v[184:185], v[82:83], v[20:21]
    v_pk_fma_f32 v[36:37], v[168:169], v[82:83], v[36:37] neg_lo:[1,0,0] neg_hi:[1,0,0]
    v_pk_fma_f32 v[28:29], v[188:189], v[86:87], v[28:29]
    v_pk_fma_f32 v[44:45], v[172:173], v[86:87], v[44:45] neg_lo:[1,0,0] neg_hi:[1,0,0]
    v_pk_add_f32 v[80:81], v[226:227], v[242:243]
    v_pk_add_f32 v[82:83], v[234:235], v[250:251] neg_lo:[0,1] neg_hi:[0,1]
    v_pk_add_f32 v[84:85], v[118:119], v[134:135]
    v_pk_add_f32 v[86:87], v[126:127], v[142:143] neg_lo:[0,1] neg_hi:[0,1]
    v_pk_mul_f32 v[80:81], v[80:81], 0.5
    v_pk_mul_f32 v[82:83], v[82:83], 0.5
    v_pk_mul_f32 v[84:85], v[84:85], 0.5
    v_pk_mul_f32 v[86:87], v[86:87], 0.5
    v_pk_mul_f32 v[22:23], v[170:171], v[80:81]
    v_pk_mul_f32 v[38:39], v[186:187], v[80:81]
    v_pk_mul_f32 v[30:31], v[174:175], v[84:85]
    v_pk_mul_f32 v[46:47], v[190:191], v[84:85]
    v_pk_fma_f32 v[22:23], v[186:187], v[82:83], v[22:23]
    v_pk_fma_f32 v[38:39], v[170:171], v[82:83], v[38:39] neg_lo:[1,0,0] neg_hi:[1,0,0]
    v_pk_fma_f32 v[30:31], v[190:191], v[86:87], v[30:31]
    v_pk_fma_f32 v[46:47], v[174:175], v[86:87], v[46:47] neg_lo:[1,0,0] neg_hi:[1,0,0]
    s_cmp_eq_u32 s56, 0
    s_cbranch_scc0 Lnocorner
    s_mov_b64 exec, 1
    v_mul_f32 v16, v160, v220
    v_mul_f32 v16, 0.5, v16
    v_mul_f32 v24, v164, v112
    v_mul_f32 v24, 0.5, v24
    v_mul_f32 v32, v176, v236
    v_mul_f32 v32, 0.5, v32
    v_mul_f32 v40, v180, v128
    v_mul_f32 v40, 0.5, v40
Lnocorner:
    s_mov_b64 exec, -1
Lnosp2:
    v_cvt_pk_bf16_f32 v144, v16, v17
    v_cvt_pk_bf16_f32 v145, v18, v19
    v_cvt_pk_bf16_f32 v146, v32, v33
    v_cvt_pk_bf16_f32 v147, v34, v35
    v_cvt_pk_bf16_f32 v152, v24, v25
    v_cvt_pk_bf16_f32 v153, v26, v27
    v_cvt_pk_bf16_f32 v154, v40, v41
    v_cvt_pk_bf16_f32 v155, v42, v43
    v_cvt_pk_bf16_f32 v148, v20, v21
    v_cvt_pk_bf16_f32 v149, v22, v23
    v_cvt_pk_bf16_f32 v150, v36, v37
    v_cvt_pk_bf16_f32 v151, v38, v39
    v_cvt_pk_bf16_f32 v156, v28, v29
    v_cvt_pk_bf16_f32 v157, v30, v31
    v_cvt_pk_bf16_f32 v158, v44, v45
    v_cvt_pk_bf16_f32 v159, v46, v47
    v_mfma_f32_16x16x32_bf16 v[160:163], v[144:147], a[224:227], 0
    v_mfma_f32_16x16x32_bf16 v[164:167], v[152:155], a[224:227], 0
    v_mfma_f32_16x16x32_bf16 v[168:171], v[144:147], a[232:235], 0
    v_mfma_f32_16x16x32_bf16 v[172:175], v[152:155], a[232:235], 0
    v_mfma_f32_16x16x32_bf16 v[176:179], v[144:147], a[240:243], 0
    v_mfma_f32_16x16x32_bf16 v[180:183], v[152:155], a[240:243], 0
    v_mfma_f32_16x16x32_bf16 v[184:187], v[144:147], a[248:251], 0
    v_mfma_f32_16x16x32_bf16 v[188:191], v[152:155], a[248:251], 0
    v_mfma_f32_16x16x32_bf16 v[160:163], v[148:151], a[228:231], v[160:163]
    v_mfma_f32_16x16x32_bf16 v[164:167], v[156:159], a[228:231], v[164:167]
    v_mfma_f32_16x16x32_bf16 v[168:171], v[148:151], a[236:239], v[168:171]
    v_mfma_f32_16x16x32_bf16 v[172:175], v[156:159], a[236:239], v[172:175]
    v_mfma_f32_16x16x32_bf16 v[176:179], v[148:151], a[244:247], v[176:179]
    v_mfma_f32_16x16x32_bf16 v[180:183], v[156:159], a[244:247], v[180:183]
    v_mfma_f32_16x16x32_bf16 v[184:187], v[148:151], a[252:255], v[184:187]
    v_mfma_f32_16x16x32_bf16 v[188:191], v[156:159], a[252:255], v[188:191]
    s_nop 0
    v_cvt_pk_bf16_f32 v80, v160, v161
    v_cvt_pk_bf16_f32 v81, v162, v163
    v_cvt_pk_bf16_f32 v82, v164, v165
    v_cvt_pk_bf16_f32 v83, v166, v167
    ds_write_b128 v10, v[80:83] offset:0
    v_cvt_pk_bf16_f32 v84, v168, v169
    v_cvt_pk_bf16_f32 v85, v170, v171
    v_cvt_pk_bf16_f32 v86, v172, v173
    v_cvt_pk_bf16_f32 v87, v174, v175
    ds_write_b128 v10, v[84:87] offset:4352
    v_cvt_pk_bf16_f32 v88, v176, v177
    v_cvt_pk_bf16_f32 v89, v178, v179
    v_cvt_pk_bf16_f32 v90, v180, v181
    v_cvt_pk_bf16_f32 v91, v182, v183
    ds_write_b128 v10, v[88:91] offset:16
    v_cvt_pk_bf16_f32 v92, v184, v185
    v_cvt_pk_bf16_f32 v93, v186, v187
    v_cvt_pk_bf16_f32 v94, v188, v189
    v_cvt_pk_bf16_f32 v95, v190, v191
    ds_write_b128 v10, v[92:95] offset:4368
    v_mov_b32 v14, 1
    s_waitcnt lgkmcnt(0)
    s_mov_b64 exec, 1
    ds_add_u32 v13, v14
    s_mov_b64 exec, -1
    s_mov_b32 s61, 0x400000
Llp4:
    ds_read_b32 v14, v13
    s_waitcnt lgkmcnt(0)
    v_cmp_gt_u32 vcc, 2, v14
    s_cbranch_vccz Llp4d
    s_sub_u32 s61, s61, 1
    s_cbranch_scc0 Llp4
Llp4d:
    ds_read_b128 v[96:99], v11 offset:0
    ds_read_b128 v[100:103], v11 offset:1088
    ds_read_b128 v[104:107], v11 offset:2176
    ds_read_b128 v[108:111], v11 offset:3264
    s_mov_b32 s62, 0
    s_waitcnt lgkmcnt(3)
    buffer_store_dwordx4 v[96:99], v12, s[12:15], s62 offen sc1
    s_mov_b32 s62, 327680
    s_waitcnt lgkmcnt(2)
    buffer_store_dwordx4 v[100:103], v12, s[12:15], s62 offen sc1
    s_mov_b32 s62, 655360
    s_waitcnt lgkmcnt(1)
    buffer_store_dwordx4 v[104:107], v12, s[12:15], s62 offen sc1
    s_mov_b32 s62, 983040
    s_waitcnt lgkmcnt(0)
    buffer_store_dwordx4 v[108:111], v12, s[12:15], s62 offen sc1
    v_mov_b32 v10, 155656
    v_mov_b32 v11, 1
    s_waitcnt vmcnt(0)
    s_mov_b64 exec, 1
    ds_add_rtn_u32 v11, v10, v11
    s_mov_b64 exec, -1
    s_waitcnt lgkmcnt(0)
    v_readfirstlane_b32 s62, v11
    s_nop 0
    s_cmp_eq_u32 s62, s60
    s_cbranch_scc0 Lnopub
    v_mov_b32 v12, s46
    s_mov_b64 exec, 1
    buffer_store_dword v12, v15, s[12:15], 0 offen sc1
    s_mov_b64 exec, -1
Lnopub:
    s_cmp_eq_u32 s42, 0
    s_cbranch_scc1 Lp3
    s_mov_b32 s61, 0x400000
Lwgw:
    ds_read_b32 v11, v10
    s_waitcnt lgkmcnt(0)
    v_cmp_ge_u32 vcc, s60, v11
    s_cbranch_vccz Lwb
    s_sub_u32 s61, s61, 1
    s_cbranch_scc0 Lwgw
Lwb:
    buffer_load_dwordx4 a[0:3], v218, s[12:15], s96 offen offset:0 sc1
    buffer_load_dwordx4 a[4:7], v218, s[12:15], s96 offen offset:1024 sc1
    buffer_load_dwordx4 a[8:11], v218, s[12:15], s96 offen offset:2048 sc1
    buffer_load_dwordx4 a[12:15], v218, s[12:15], s96 offen offset:3072 sc1
    buffer_load_dwordx4 a[16:19], v219, s[12:15], s96 offen offset:0 sc1
    s_add_u32 s96, s96, 40960
    s_cmp_eq_u32 s96, s100
    s_cselect_b32 s96, s99, s96
    buffer_load_dwordx4 a[20:23], v218, s[12:15], s96 offen offset:0 sc1
    buffer_load_dwordx4 a[24:27], v218, s[12:15], s96 offen offset:1024 sc1
    buffer_load_dwordx4 a[28:31], v218, s[12:15], s96 offen offset:2048 sc1
    buffer_load_dwordx4 a[32:35], v218, s[12:15], s96 offen offset:3072 sc1
    buffer_load_dwordx4 a[36:39], v219, s[12:15], s96 offen offset:0 sc1
    s_add_u32 s96, s96, 40960
    s_cmp_eq_u32 s96, s100
    s_cselect_b32 s96, s99, s96
    buffer_load_dwordx4 a[40:43], v218, s[12:15], s96 offen offset:0 sc1
    buffer_load_dwordx4 a[44:47], v218, s[12:15], s96 offen offset:1024 sc1
    buffer_load_dwordx4 a[48:51], v218, s[12:15], s96 offen offset:2048 sc1
    buffer_load_dwordx4 a[52:55], v218, s[12:15], s96 offen offset:3072 sc1
    buffer_load_dwordx4 a[56:59], v219, s[12:15], s96 offen offset:0 sc1
    s_add_u32 s96, s96, 40960
    s_cmp_eq_u32 s96, s100
    s_cselect_b32 s96, s99, s96
    buffer_load_dwordx4 a[60:63], v218, s[12:15], s96 offen offset:0 sc1
    buffer_load_dwordx4 a[64:67], v218, s[12:15], s96 offen offset:1024 sc1
    buffer_load_dwordx4 a[68:71], v218, s[12:15], s96 offen offset:2048 sc1
    buffer_load_dwordx4 a[72:75], v218, s[12:15], s96 offen offset:3072 sc1
    buffer_load_dwordx4 a[76:79], v219, s[12:15], s96 offen offset:0 sc1
    s_add_u32 s96, s96, 40960
    s_cmp_eq_u32 s96, s100
    s_cselect_b32 s96, s99, s96
    buffer_load_dwordx4 a[80:83], v218, s[12:15], s96 offen offset:0 sc1
    buffer_load_dwordx4 a[84:87], v218, s[12:15], s96 offen offset:1024 sc1
    buffer_load_dwordx4 a[88:91], v218, s[12:15], s96 offen offset:2048 sc1
    buffer_load_dwordx4 a[92:95], v218, s[12:15], s96 offen offset:3072 sc1
    buffer_load_dwordx4 a[96:99], v219, s[12:15], s96 offen offset:0 sc1
    s_add_u32 s96, s96, 40960
    s_cmp_eq_u32 s96, s100
    s_cselect_b32 s96, s99, s96
    buffer_load_dwordx4 a[100:103], v218, s[12:15], s96 offen offset:0 sc1
    buffer_load_dwordx4 a[104:107], v218, s[12:15], s96 offen offset:1024 sc1
    buffer_load_dwordx4 a[108:111], v218, s[12:15], s96 offen offset:2048 sc1
    buffer_load_dwordx4 a[112:115], v218, s[12:15], s96 offen offset:3072 sc1
    buffer_load_dwordx4 a[116:119], v219, s[12:15], s96 offen offset:0 sc1
    s_add_u32 s96, s96, 40960
    s_cmp_eq_u32 s96, s100
    s_cselect_b32 s96, s99, s96
    buffer_load_dwordx4 a[120:123], v218, s[12:15], s96 offen offset:0 sc1
    buffer_load_dwordx4 a[124:127], v218, s[12:15], s96 offen offset:1024 sc1
    buffer_load_dwordx4 a[128:131], v218, s[12:15], s96 offen offset:2048 sc1
    buffer_load_dwordx4 a[132:135], v218, s[12:15], s96 offen offset:3072 sc1
    buffer_load_dwordx4 a[136:139], v219, s[12:15], s96 offen offset:0 sc1
    s_add_u32 s96, s96, 40960
    s_cmp_eq_u32 s96, s100
    s_cselect_b32 s96, s99, s96
    buffer_load_dwordx4 a[140:143], v218, s[12:15], s96 offen offset:0 sc1
    buffer_load_dwordx4 a[144:147], v218, s[12:15], s96 offen offset:1024 sc1
    buffer_load_dwordx4 a[148:151], v218, s[12:15], s96 offen offset:2048 sc1
    buffer_load_dwordx4 a[152:155], v218, s[12:15], s96 offen offset:3072 sc1
    buffer_load_dwordx4 a[156:159], v219, s[12:15], s96 offen offset:0 sc1
    s_add_u32 s96, s96, 40960
    s_cmp_eq_u32 s96, s100
    s_cselect_b32 s96, s99, s96
    buffer_load_dwordx4 a[160:163], v218, s[12:15], s96 offen offset:0 sc1
    buffer_load_dwordx4 a[164:167], v218, s[12:15], s96 offen offset:1024 sc1
    buffer_load_dwordx4 a[168:171], v218, s[12:15], s96 offen offset:2048 sc1
    buffer_load_dwordx4 a[172:175], v218, s[12:15], s96 offen offset:3072 sc1
    buffer_load_dwordx4 a[176:179], v219, s[12:15], s96 offen offset:0 sc1
    s_add_u32 s96, s96, 40960
    s_cmp_eq_u32 s96, s100
    s_cselect_b32 s96, s99, s96
    s_branch Lp3
LepiQ:
    s_lshl_b32 s63, s44, 1
    s_add_u32 s63, s63, s41
    s_mul_i32 s64, s63, 1280
    s_mul_i32 s65, s45, 327680
    s_add_u32 s64, s64, s65
    v_and_b32 v8, 7, v1
    v_lshlrev_b32 v8, 4, v8
    v_lshrrev_b32 v9, 3, v1
    v_mul_u32_u24 v10, 40960, v9
    v_add_u32 v10, v10, v8
    v_mov_b32 v115, v10
    v_mov_b32 v116, v8
    s_mov_b32 s47, s64
    s_lshl_b32 s64, s63, 8
    s_lshl_b32 s65, s45, 5
    s_add_u32 s64, s64, s65
    s_add_u32 s64, s64, 8912896
    v_lshlrev_b32 v9, 2, v9
    v_add_u32 v9, s64, v9
    v_mov_b32 v10, 2146435072
    v_cmp_eq_u32 vcc, 0, v8
    s_nop 1
    v_cndmask_b32 v114, v10, v9, vcc
    s_mul_i32 s62, s41, 10880
    s_add_u32 s62, s62, 0
    v_mul_u32_u24 v4, 136, v2
    v_lshl_add_u32 v4, v3, 3, v4
    v_add_u32 v4, s62, v4
    v_pk_mul_f32 v[8:9], v[16:17], s[48:49] op_sel_hi:[1,0]
    v_exp_f32 v8, v8 clamp
    v_exp_f32 v9, v9 clamp
    v_max_f32 v16, s49, v16
    v_max_f32 v17, s49, v17
    v_pk_add_f32 v[16:17], v[16:17], v[8:9]
    v_pk_mul_f32 v[10:11], v[18:19], s[48:49] op_sel_hi:[1,0]
    v_exp_f32 v10, v10 clamp
    v_exp_f32 v11, v11 clamp
    v_max_f32 v18, s49, v18
    v_max_f32 v19, s49, v19
    v_pk_add_f32 v[18:19], v[18:19], v[10:11]
    v_cvt_pk_bf16_f32 v16, v16, v17
    v_cvt_pk_bf16_f32 v17, v18, v19
    ds_write_b64 v4, v[16:17] offset:0
    v_pk_mul_f32 v[8:9], v[36:37], s[48:49] op_sel_hi:[1,0]
    v_exp_f32 v8, v8 clamp
    v_exp_f32 v9, v9 clamp
    v_max_f32 v36, s49, v36
    v_max_f32 v37, s49, v37
    v_pk_add_f32 v[36:37], v[36:37], v[8:9]
    v_pk_mul_f32 v[10:11], v[38:39], s[48:49] op_sel_hi:[1,0]
    v_exp_f32 v10, v10 clamp
    v_exp_f32 v11, v11 clamp
    v_max_f32 v38, s49, v38
    v_max_f32 v39, s49, v39
    v_pk_add_f32 v[38:39], v[38:39], v[10:11]
    v_cvt_pk_bf16_f32 v36, v36, v37
    v_cvt_pk_bf16_f32 v37, v38, v39
    ds_write_b64 v4, v[36:37] offset:32
    v_pk_mul_f32 v[8:9], v[56:57], s[48:49] op_sel_hi:[1,0]
    v_exp_f32 v8, v8 clamp
    v_exp_f32 v9, v9 clamp
    v_max_f32 v56, s49, v56
    v_max_f32 v57, s49, v57
    v_pk_add_f32 v[56:57], v[56:57], v[8:9]
    v_pk_mul_f32 v[10:11], v[58:59], s[48:49] op_sel_hi:[1,0]
    v_exp_f32 v10, v10 clamp
    v_exp_f32 v11, v11 clamp
    v_max_f32 v58, s49, v58
    v_max_f32 v59, s49, v59
    v_pk_add_f32 v[58:59], v[58:59], v[10:11]
    v_cvt_pk_bf16_f32 v56, v56, v57
    v_cvt_pk_bf16_f32 v57, v58, v59
    ds_write_b64 v4, v[56:57] offset:64
    v_pk_mul_f32 v[8:9], v[76:77], s[48:49] op_sel_hi:[1,0]
    v_exp_f32 v8, v8 clamp
    v_exp_f32 v9, v9 clamp
    v_max_f32 v76, s49, v76
    v_max_f32 v77, s49, v77
    v_pk_add_f32 v[76:77], v[76:77], v[8:9]
    v_pk_mul_f32 v[10:11], v[78:79], s[48:49] op_sel_hi:[1,0]
    v_exp_f32 v10, v10 clamp
    v_exp_f32 v11, v11 clamp
    v_max_f32 v78, s49, v78
    v_max_f32 v79, s49, v79
    v_pk_add_f32 v[78:79], v[78:79], v[10:11]
    v_cvt_pk_bf16_f32 v76, v76, v77
    v_cvt_pk_bf16_f32 v77, v78, v79
    ds_write_b64 v4, v[76:77] offset:96
    v_pk_mul_f32 v[8:9], v[20:21], s[48:49] op_sel_hi:[1,0]
    v_exp_f32 v8, v8 clamp
    v_exp_f32 v9, v9 clamp
    v_max_f32 v20, s49, v20
    v_max_f32 v21, s49, v21
    v_pk_add_f32 v[20:21], v[20:21], v[8:9]
    v_pk_mul_f32 v[10:11], v[22:23], s[48:49] op_sel_hi:[1,0]
    v_exp_f32 v10, v10 clamp
    v_exp_f32 v11, v11 clamp
    v_max_f32 v22, s49, v22
    v_max_f32 v23, s49, v23
    v_pk_add_f32 v[22:23], v[22:23], v[10:11]
    v_cvt_pk_bf16_f32 v20, v20, v21
    v_cvt_pk_bf16_f32 v21, v22, v23
    ds_write_b64 v4, v[20:21] offset:2176
    v_pk_mul_f32 v[8:9], v[40:41], s[48:49] op_sel_hi:[1,0]
    v_exp_f32 v8, v8 clamp
    v_exp_f32 v9, v9 clamp
    v_max_f32 v40, s49, v40
    v_max_f32 v41, s49, v41
    v_pk_add_f32 v[40:41], v[40:41], v[8:9]
    v_pk_mul_f32 v[10:11], v[42:43], s[48:49] op_sel_hi:[1,0]
    v_exp_f32 v10, v10 clamp
    v_exp_f32 v11, v11 clamp
    v_max_f32 v42, s49, v42
    v_max_f32 v43, s49, v43
    v_pk_add_f32 v[42:43], v[42:43], v[10:11]
    v_cvt_pk_bf16_f32 v40, v40, v41
    v_cvt_pk_bf16_f32 v41, v42, v43
    ds_write_b64 v4, v[40:41] offset:2208
    v_pk_mul_f32 v[8:9], v[60:61], s[48:49] op_sel_hi:[1,0]
    v_exp_f32 v8, v8 clamp
    v_exp_f32 v9, v9 clamp
    v_max_f32 v60, s49, v60
    v_max_f32 v61, s49, v61
    v_pk_add_f32 v[60:61], v[60:61], v[8:9]
    v_pk_mul_f32 v[10:11], v[62:63], s[48:49] op_sel_hi:[1,0]
    buffer_load_dwordx4 v[120:123], v115, s[4:7], s47 offen offset:0
    buffer_load_dwordx4 v[160:163], v116, s[36:39], 0 offen offset:0
    v_exp_f32 v10, v10 clamp
    v_exp_f32 v11, v11 clamp
    v_max_f32 v62, s49, v62
    v_max_f32 v63, s49, v63
    v_pk_add_f32 v[62:63], v[62:63], v[10:11]
    v_cvt_pk_bf16_f32 v60, v60, v61
    v_cvt_pk_bf16_f32 v61, v62, v63
    buffer_load_dwordx4 v[124:127], v115, s[4:7], s47 offen offset:128
    buffer_load_dwordx4 v[164:167], v116, s[36:39], 0 offen offset:128
    ds_write_b64 v4, v[60:61] offset:2240
    v_pk_mul_f32 v[8:9], v[80:81], s[48:49] op_sel_hi:[1,0]
    v_exp_f32 v8, v8 clamp
    v_exp_f32 v9, v9 clamp
    v_max_f32 v80, s49, v80
    v_max_f32 v81, s49, v81
    v_pk_add_f32 v[80:81], v[80:81], v[8:9]
    buffer_load_dwordx4 v[128:131], v115, s[4:7], s47 offen offset:256
    buffer_load_dwordx4 v[168:171], v116, s[36:39], 0 offen offset:256
    v_pk_mul_f32 v[10:11], v[82:83], s[48:49] op_sel_hi:[1,0]
    v_exp_f32 v10, v10 clamp
    v_exp_f32 v11, v11 clamp
    v_max_f32 v82, s49, v82
    v_max_f32 v83, s49, v83
    v_pk_add_f32 v[82:83], v[82:83], v[10:11]
    v_cvt_pk_bf16_f32 v80, v80, v81
    buffer_load_dwordx4 v[132:135], v115, s[4:7], s47 offen offset:384
    buffer_load_dwordx4 v[172:175], v116, s[36:39], 0 offen offset:384
    v_cvt_pk_bf16_f32 v81, v82, v83
    ds_write_b64 v4, v[80:81] offset:2272
    v_pk_mul_f32 v[8:9], v[24:25], s[48:49] op_sel_hi:[1,0]
    v_exp_f32 v8, v8 clamp
    v_exp_f32 v9, v9 clamp
    v_max_f32 v24, s49, v24
    v_max_f32 v25, s49, v25
    buffer_load_dwordx4 v[136:139], v115, s[4:7], s47 offen offset:512
    buffer_load_dwordx4 v[176:179], v116, s[36:39], 0 offen offset:512
    v_pk_add_f32 v[24:25], v[24:25], v[8:9]
    v_pk_mul_f32 v[10:11], v[26:27], s[48:49] op_sel_hi:[1,0]
    v_exp_f32 v10, v10 clamp
    v_exp_f32 v11, v11 clamp
    v_max_f32 v26, s49, v26
    v_max_f32 v27, s49, v27
    v_pk_add_f32 v[26:27], v[26:27], v[10:11]
    buffer_load_dwordx4 v[140:143], v115, s[4:7], s47 offen offset:640
    buffer_load_dwordx4 v[180:183], v116, s[36:39], 0 offen offset:640
    v_cvt_pk_bf16_f32 v24, v24, v25
    v_cvt_pk_bf16_f32 v25, v26, v27
    ds_write_b64 v4, v[24:25] offset:4352
    v_pk_mul_f32 v[8:9], v[44:45], s[48:49] op_sel_hi:[1,0]
    v_exp_f32 v8, v8 clamp
    v_exp_f32 v9, v9 clamp
    v_max_f32 v44, s49, v44
    buffer_load_dwordx4 v[144:147], v115, s[4:7], s47 offen offset:768
    buffer_load_dwordx4 v[184:187], v116, s[36:39], 0 offen offset:768
    v_max_f32 v45, s49, v45
    v_pk_add_f32 v[44:45], v[44:45], v[8:9]
    v_pk_mul_f32 v[10:11], v[46:47], s[48:49] op_sel_hi:[1,0]
    v_exp_f32 v10, v10 clamp
    v_exp_f32 v11, v11 clamp
    v_max_f32 v46, s49, v46
    v_max_f32 v47, s49, v47
    buffer_load_dwordx4 v[148:151], v115, s[4:7], s47 offen offset:896
    buffer_load_dwordx4 v[188:191], v116, s[36:39], 0 offen offset:896
    v_pk_add_f32 v[46:47], v[46:47], v[10:11]
    v_cvt_pk_bf16_f32 v44, v44, v45
    v_cvt_pk_bf16_f32 v45, v46, v47
    ds_write_b64 v4, v[44:45] offset:4384
    v_pk_mul_f32 v[8:9], v[64:65], s[48:49] op_sel_hi:[1,0]
    v_exp_f32 v8, v8 clamp
    v_exp_f32 v9, v9 clamp
    buffer_load_dwordx4 v[152:155], v115, s[4:7], s47 offen offset:1024
    buffer_load_dwordx4 v[192:195], v116, s[36:39], 0 offen offset:1024
    v_max_f32 v64, s49, v64
    v_max_f32 v65, s49, v65
    v_pk_add_f32 v[64:65], v[64:65], v[8:9]
    v_pk_mul_f32 v[10:11], v[66:67], s[48:49] op_sel_hi:[1,0]
    v_exp_f32 v10, v10 clamp
    v_exp_f32 v11, v11 clamp
    v_max_f32 v66, s49, v66
    buffer_load_dwordx4 v[156:159], v115, s[4:7], s47 offen offset:1152
    buffer_load_dwordx4 v[196:199], v116, s[36:39], 0 offen offset:1152
    v_max_f32 v67, s49, v67
    v_pk_add_f32 v[66:67], v[66:67], v[10:11]
    v_cvt_pk_bf16_f32 v64, v64, v65
    v_cvt_pk_bf16_f32 v65, v66, v67
    ds_write_b64 v4, v[64:65] offset:4416
    v_pk_mul_f32 v[8:9], v[84:85], s[48:49] op_sel_hi:[1,0]
    v_exp_f32 v8, v8 clamp
    buffer_load_dwordx4 a[0:3], v218, s[12:15], s96 offen offset:0 sc1
    v_exp_f32 v9, v9 clamp
    v_max_f32 v84, s49, v84
    v_max_f32 v85, s49, v85
    v_pk_add_f32 v[84:85], v[84:85], v[8:9]
    v_pk_mul_f32 v[10:11], v[86:87], s[48:49] op_sel_hi:[1,0]
    v_exp_f32 v10, v10 clamp
    v_exp_f32 v11, v11 clamp
    buffer_load_dwordx4 a[4:7], v218, s[12:15], s96 offen offset:1024 sc1
    v_max_f32 v86, s49, v86
    v_max_f32 v87, s49, v87
    v_pk_add_f32 v[86:87], v[86:87], v[10:11]
    v_cvt_pk_bf16_f32 v84, v84, v85
    v_cvt_pk_bf16_f32 v85, v86, v87
    ds_write_b64 v4, v[84:85] offset:4448
    v_pk_mul_f32 v[8:9], v[28:29], s[48:49] op_sel_hi:[1,0]
    buffer_load_dwordx4 a[8:11], v218, s[12:15], s96 offen offset:2048 sc1
    v_exp_f32 v8, v8 clamp
    v_exp_f32 v9, v9 clamp
    v_max_f32 v28, s49, v28
    v_max_f32 v29, s49, v29
    v_pk_add_f32 v[28:29], v[28:29], v[8:9]
    v_pk_mul_f32 v[10:11], v[30:31], s[48:49] op_sel_hi:[1,0]
    v_exp_f32 v10, v10 clamp
    buffer_load_dwordx4 a[12:15], v218, s[12:15], s96 offen offset:3072 sc1
    v_exp_f32 v11, v11 clamp
    v_max_f32 v30, s49, v30
    v_max_f32 v31, s49, v31
    v_pk_add_f32 v[30:31], v[30:31], v[10:11]
    v_cvt_pk_bf16_f32 v28, v28, v29
    v_cvt_pk_bf16_f32 v29, v30, v31
    ds_write_b64 v4, v[28:29] offset:6528
    buffer_load_dwordx4 a[16:19], v219, s[12:15], s96 offen offset:0 sc1
    s_add_u32 s96, s96, 40960
    s_cmp_eq_u32 s96, s100
    s_cselect_b32 s96, s99, s96
    v_pk_mul_f32 v[8:9], v[48:49], s[48:49] op_sel_hi:[1,0]
    v_exp_f32 v8, v8 clamp
    v_exp_f32 v9, v9 clamp
    v_max_f32 v48, s49, v48
    v_max_f32 v49, s49, v49
    v_pk_add_f32 v[48:49], v[48:49], v[8:9]
    v_pk_mul_f32 v[10:11], v[50:51], s[48:49] op_sel_hi:[1,0]
    buffer_load_dwordx4 a[20:23], v218, s[12:15], s96 offen offset:0 sc1
    v_exp_f32 v10, v10 clamp
    v_exp_f32 v11, v11 clamp
    v_max_f32 v50, s49, v50
    v_max_f32 v51, s49, v51
    v_pk_add_f32 v[50:51], v[50:51], v[10:11]
    v_cvt_pk_bf16_f32 v48, v48, v49
    v_cvt_pk_bf16_f32 v49, v50, v51
    buffer_load_dwordx4 a[24:27], v218, s[12:15], s96 offen offset:1024 sc1
    ds_write_b64 v4, v[48:49] offset:6560
    v_pk_mul_f32 v[8:9], v[68:69], s[48:49] op_sel_hi:[1,0]
    v_exp_f32 v8, v8 clamp
    v_exp_f32 v9, v9 clamp
    v_max_f32 v68, s49, v68
    v_max_f32 v69, s49, v69
    v_pk_add_f32 v[68:69], v[68:69], v[8:9]
    buffer_load_dwordx4 a[28:31], v218, s[12:15], s96 offen offset:2048 sc1
    v_pk_mul_f32 v[10:11], v[70:71], s[48:49] op_sel_hi:[1,0]
    v_exp_f32 v10, v10 clamp
    v_exp_f32 v11, v11 clamp
    v_max_f32 v70, s49, v70
    v_max_f32 v71, s49, v71
    v_pk_add_f32 v[70:71], v[70:71], v[10:11]
    v_cvt_pk_bf16_f32 v68, v68, v69
    buffer_load_dwordx4 a[32:35], v218, s[12:15], s96 offen offset:3072 sc1
    v_cvt_pk_bf16_f32 v69, v70, v71
    ds_write_b64 v4, v[68:69] offset:6592
    v_pk_mul_f32 v[8:9], v[88:89], s[48:49] op_sel_hi:[1,0]
    v_exp_f32 v8, v8 clamp
    v_exp_f32 v9, v9 clamp
    v_max_f32 v88, s49, v88
    v_max_f32 v89, s49, v89
    buffer_load_dwordx4 a[36:39], v219, s[12:15], s96 offen offset:0 sc1
    s_add_u32 s96, s96, 40960
    s_cmp_eq_u32 s96, s100
    s_cselect_b32 s96, s99, s96
    v_pk_add_f32 v[88:89], v[88:89], v[8:9]
    v_pk_mul_f32 v[10:11], v[90:91], s[48:49] op_sel_hi:[1,0]
    v_exp_f32 v10, v10 clamp
    v_exp_f32 v11, v11 clamp
    v_max_f32 v90, s49, v90
    v_max_f32 v91, s49, v91
    v_pk_add_f32 v[90:91], v[90:91], v[10:11]
    buffer_load_dwordx4 a[40:43], v218, s[12:15], s96 offen offset:0 sc1
    v_cvt_pk_bf16_f32 v88, v88, v89
    v_cvt_pk_bf16_f32 v89, v90, v91
    ds_write_b64 v4, v[88:89] offset:6624
    v_pk_mul_f32 v[8:9], v[32:33], s[48:49] op_sel_hi:[1,0]
    v_exp_f32 v8, v8 clamp
    v_exp_f32 v9, v9 clamp
    v_max_f32 v32, s49, v32
    buffer_load_dwordx4 a[44:47], v218, s[12:15], s96 offen offset:1024 sc1
    v_max_f32 v33, s49, v33
    v_pk_add_f32 v[32:33], v[32:33], v[8:9]
    v_pk_mul_f32 v[10:11], v[34:35], s[48:49] op_sel_hi:[1,0]
    v_exp_f32 v10, v10 clamp
    v_exp_f32 v11, v11 clamp
    v_max_f32 v34, s49, v34
    v_max_f32 v35, s49, v35
    buffer_load_dwordx4 a[48:51], v218, s[12:15], s96 offen offset:2048 sc1
    v_pk_add_f32 v[34:35], v[34:35], v[10:11]
    v_cvt_pk_bf16_f32 v32, v32, v33
    v_cvt_pk_bf16_f32 v33, v34, v35
    ds_write_b64 v4, v[32:33] offset:8704
    v_pk_mul_f32 v[8:9], v[52:53], s[48:49] op_sel_hi:[1,0]
    v_exp_f32 v8, v8 clamp
    v_exp_f32 v9, v9 clamp
    buffer_load_dwordx4 a[52:55], v218, s[12:15], s96 offen offset:3072 sc1
    v_max_f32 v52, s49, v52
    v_max_f32 v53, s49, v53
    v_pk_add_f32 v[52:53], v[52:53], v[8:9]
    v_pk_mul_f32 v[10:11], v[54:55], s[48:49] op_sel_hi:[1,0]
    v_exp_f32 v10, v10 clamp
    v_exp_f32 v11, v11 clamp
    v_max_f32 v54, s49, v54
    buffer_load_dwordx4 a[56:59], v219, s[12:15], s96 offen offset:0 sc1
    s_add_u32 s96, s96, 40960
    s_cmp_eq_u32 s96, s100
    s_cselect_b32 s96, s99, s96
    v_max_f32 v55, s49, v55
    v_pk_add_f32 v[54:55], v[54:55], v[10:11]
    v_cvt_pk_bf16_f32 v52, v52, v53
    v_cvt_pk_bf16_f32 v53, v54, v55
    ds_write_b64 v4, v[52:53] offset:8736
    v_pk_mul_f32 v[8:9], v[72:73], s[48:49] op_sel_hi:[1,0]
    v_exp_f32 v8, v8 clamp
    buffer_load_dwordx4 a[60:63], v218, s[12:15], s96 offen offset:0 sc1
    v_exp_f32 v9, v9 clamp
    v_max_f32 v72, s49, v72
    v_max_f32 v73, s49, v73
    v_pk_add_f32 v[72:73], v[72:73], v[8:9]
    v_pk_mul_f32 v[10:11], v[74:75], s[48:49] op_sel_hi:[1,0]
    v_exp_f32 v10, v10 clamp
    v_exp_f32 v11, v11 clamp
    buffer_load_dwordx4 a[64:67], v218, s[12:15], s96 offen offset:1024 sc1
    v_max_f32 v74, s49, v74
    v_max_f32 v75, s49, v75
    v_pk_add_f32 v[74:75], v[74:75], v[10:11]
    v_cvt_pk_bf16_f32 v72, v72, v73
    v_cvt_pk_bf16_f32 v73, v74, v75
    ds_write_b64 v4, v[72:73] offset:8768
    v_pk_mul_f32 v[8:9], v[92:93], s[48:49] op_sel_hi:[1,0]
    buffer_load_dwordx4 a[68:71], v218, s[12:15], s96 offen offset:2048 sc1
    v_exp_f32 v8, v8 clamp
    v_exp_f32 v9, v9 clamp
    v_max_f32 v92, s49, v92
    v_max_f32 v93, s49, v93
    v_pk_add_f32 v[92:93], v[92:93], v[8:9]
    v_pk_mul_f32 v[10:11], v[94:95], s[48:49] op_sel_hi:[1,0]
    v_exp_f32 v10, v10 clamp
    buffer_load_dwordx4 a[72:75], v218, s[12:15], s96 offen offset:3072 sc1
    v_exp_f32 v11, v11 clamp
    v_max_f32 v94, s49, v94
    v_max_f32 v95, s49, v95
    v_pk_add_f32 v[94:95], v[94:95], v[10:11]
    v_cvt_pk_bf16_f32 v92, v92, v93
    v_cvt_pk_bf16_f32 v93, v94, v95
    ds_write_b64 v4, v[92:93] offset:8800
    buffer_load_dwordx4 a[76:79], v219, s[12:15], s96 offen offset:0 sc1
    s_add_u32 s96, s96, 40960
    s_cmp_eq_u32 s96, s100
    s_cselect_b32 s96, s99, s96
    s_waitcnt vmcnt(20)
    v_mov_b32 v8, 0
    v_mov_b32 v9, 0
    v_dot2_f32_bf16 v8, v120, v160, v8
    v_dot2_f32_bf16 v9, v121, v161, v9
    v_dot2_f32_bf16 v8, v122, v162, v8
    v_dot2_f32_bf16 v9, v123, v163, v9
    v_dot2_f32_bf16 v8, v124, v164, v8
    v_dot2_f32_bf16 v9, v125, v165, v9
    v_dot2_f32_bf16 v8, v126, v166, v8
    v_dot2_f32_bf16 v9, v127, v167, v9
    v_dot2_f32_bf16 v8, v128, v168, v8
    v_dot2_f32_bf16 v9, v129, v169, v9
    v_dot2_f32_bf16 v8, v130, v170, v8
    v_dot2_f32_bf16 v9, v131, v171, v9
    v_dot2_f32_bf16 v8, v132, v172, v8
    v_dot2_f32_bf16 v9, v133, v173, v9
    v_dot2_f32_bf16 v8, v134, v174, v8
    v_dot2_f32_bf16 v9, v135, v175, v9
    v_dot2_f32_bf16 v8, v136, v176, v8
    v_dot2_f32_bf16 v9, v137, v177, v9
    v_dot2_f32_bf16 v8, v138, v178, v8
    v_dot2_f32_bf16 v9, v139, v179, v9
    v_dot2_f32_bf16 v8, v140, v180, v8
    v_dot2_f32_bf16 v9, v141, v181, v9
    v_dot2_f32_bf16 v8, v142, v182, v8
    v_dot2_f32_bf16 v9, v143, v183, v9
    v_dot2_f32_bf16 v8, v144, v184, v8
    v_dot2_f32_bf16 v9, v145, v185, v9
    v_dot2_f32_bf16 v8, v146, v186, v8
    v_dot2_f32_bf16 v9, v147, v187, v9
    v_dot2_f32_bf16 v8, v148, v188, v8
    v_dot2_f32_bf16 v9, v149, v189, v9
    v_dot2_f32_bf16 v8, v150, v190, v8
    v_dot2_f32_bf16 v9, v151, v191, v9
    v_dot2_f32_bf16 v8, v152, v192, v8
    v_dot2_f32_bf16 v9, v153, v193, v9
    v_dot2_f32_bf16 v8, v154, v194, v8
    v_dot2_f32_bf16 v9, v155, v195, v9
    v_dot2_f32_bf16 v8, v156, v196, v8
    v_dot2_f32_bf16 v9, v157, v197, v9
    v_dot2_f32_bf16 v8, v158, v198, v8
    v_dot2_f32_bf16 v9, v159, v199, v9
    s_nop 2
    v_add_f32 v8, v8, v9
    s_nop 1
    v_add_f32_dpp v8, v8, v8 quad_perm:[1,0,3,2] row_mask:0xf bank_mask:0xf
    s_nop 1
    v_add_f32_dpp v8, v8, v8 quad_perm:[2,3,0,1] row_mask:0xf bank_mask:0xf
    s_nop 1
    v_add_f32_dpp v8, v8, v8 row_half_mirror row_mask:0xf bank_mask:0xf
    v_cvt_pk_bf16_f32 v8, v8, v8
    v_and_b32 v8, 0xffff0000, v8
    v_mul_f32 v8, s48, v8
    v_exp_f32 v8, -v8
    s_nop 0
    v_add_f32 v8, 1.0, v8
    v_rcp_f32 v8, v8
    s_nop 0
    v_cvt_pk_bf16_f32 v8, v8, v8
    v_and_b32 v8, 0xffff0000, v8
    buffer_store_dword v8, v114, s[12:15], 0 offen sc1
    v_bfe_u32 v8, v1, 2, 2
    v_lshl_add_u32 v8, v3, 3, v8
    v_and_b32 v9, 3, v1
    v_lshlrev_b32 v9, 3, v9
    v_add_u32 v9, s62, v9
    v_add_u32 v10, 0, v8
    v_min_u32 v10, 19, v10
    v_mul_u32_u24 v10, 136, v10
    v_add_u32 v5, v10, v9
    v_add_u32 v10, 4, v8
    v_min_u32 v10, 19, v10
    v_mul_u32_u24 v10, 136, v10
    v_add_u32 v6, v10, v9
    s_mul_i32 s63, s41, 5504
    s_add_u32 s63, s63, 43008
    v_mov_b32 v8, 0
    v_mov_b32 v9, 0
    v_mov_b32 v10, 0
    v_mov_b32 v11, 0
    v_add_u32 v12, s63, v218
    ds_write_b128 v12, v[8:11] offset:0
    ds_write_b128 v12, v[8:11] offset:1024
    ds_write_b128 v12, v[8:11] offset:2048
    ds_write_b128 v12, v[8:11] offset:3072
    ds_write_b128 v12, v[8:11] offset:4096
    s_mov_b64 exec, 0xffffff
    ds_write_b128 v12, v[8:11] offset:5120
    s_mov_b64 exec, -1
    v_add_u32 v8, 0, v1
    v_mul_u32_u24 v9, 0xc31, v8
    v_lshrrev_b32 v9, 16, v9
    v_mul_u32_u24 v10, 21, v9
    v_sub_u32 v10, v8, v10
    v_cmp_lt_u32 vcc, 4, v9
    s_nop 1
    v_cndmask_b32 v11, 0, 1, vcc
    v_mad_u32_u24 v10, v11, 21, v10
    v_mul_u32_u24 v11, 5, v11
    v_sub_u32 v9, v9, v11
    v_lshlrev_b32 v10, 6, v10
    v_lshl_add_u32 v10, v9, 3, v10
    v_add_u32 v108, s63, v10
    v_add_u32 v8, 64, v1
    v_mul_u32_u24 v9, 0xc31, v8
    v_lshrrev_b32 v9, 16, v9
    v_mul_u32_u24 v10, 21, v9
    v_sub_u32 v10, v8, v10
    v_cmp_lt_u32 vcc, 4, v9
    s_nop 1
    v_cndmask_b32 v11, 0, 1, vcc
    v_mad_u32_u24 v10, v11, 21, v10
    v_mul_u32_u24 v11, 5, v11
    v_sub_u32 v9, v9, v11
    v_lshlrev_b32 v10, 6, v10
    v_lshl_add_u32 v10, v9, 3, v10
    v_add_u32 v109, s63, v10
    v_add_u32 v8, 128, v1
    v_mul_u32_u24 v9, 0xc31, v8
    v_lshrrev_b32 v9, 16, v9
    v_mul_u32_u24 v10, 21, v9
    v_sub_u32 v10, v8, v10
    v_cmp_lt_u32 vcc, 4, v9
    s_nop 1
    v_cndmask_b32 v11, 0, 1, vcc
    v_mad_u32_u24 v10, v11, 21, v10
    v_mul_u32_u24 v11, 5, v11
    v_sub_u32 v9, v9, v11
    v_lshlrev_b32 v10, 6, v10
    v_lshl_add_u32 v10, v9, 3, v10
    v_add_u32 v110, s63, v10
    v_add_u32 v8, 192, v1
    v_mul_u32_u24 v9, 0xc31, v8
    v_lshrrev_b32 v9, 16, v9
    v_mul_u32_u24 v10, 21, v9
    v_sub_u32 v10, v8, v10
    v_cmp_lt_u32 vcc, 4, v9
    s_nop 1
    v_cndmask_b32 v11, 0, 1, vcc
    v_mad_u32_u24 v10, v11, 21, v10
    v_mul_u32_u24 v11, 5, v11
    v_sub_u32 v9, v9, v11
    v_lshlrev_b32 v10, 6, v10
    v_lshl_add_u32 v10, v9, 3, v10
    v_add_u32 v111, s63, v10
    v_mov_b32 v11, 155712
    v_cmp_gt_u32 vcc, 18, v1
    s_nop 1
    v_cndmask_b32 v111, v11, v111, vcc
    v_lshlrev_b32 v8, 4, v3
    v_add_u32 v8, s63, v8
    v_lshl_add_u32 v100, v2, 6, v8
    v_add_u32 v101, 1344, v100
    v_and_b32 v9, 3, v2
    v_lshrrev_b32 v10, 2, v2
    v_and_b32 v11, 1, v10
    v_lshl_add_u32 v11, v11, 1, v9
    v_add_u32 v11, 16, v11
    v_lshrrev_b32 v12, 1, v10
    v_cmp_eq_u32 vcc, 0, v12
    v_cmp_gt_u32 s[66:67], 2, v9
    s_nop 0
    s_and_b64 vcc, vcc, s[66:67]
    v_cndmask_b32 v11, 42, v11, vcc
    v_cmp_eq_u32 vcc, 2, v9
    s_nop 1
    v_cndmask_b32 v11, v11, 20, vcc
    v_lshl_add_u32 v102, v11, 6, v8
    v_and_b32 v11, 1, v10
    v_lshl_add_u32 v11, v11, 1, v9
    v_add_u32 v11, 37, v11
    v_lshrrev_b32 v12, 1, v10
    v_cmp_eq_u32 vcc, 1, v12
    v_cmp_gt_u32 s[66:67], 2, v9
    s_nop 0
    s_and_b64 vcc, vcc, s[66:67]
    v_cndmask_b32 v11, 42, v11, vcc
    v_cmp_eq_u32 vcc, 3, v9
    s_nop 1
    v_cndmask_b32 v11, v11, 41, vcc
    v_lshl_add_u32 v103, v11, 6, v8
    s_lshl_b32 s63, s44, 1
    s_add_u32 s63, s63, s41
    s_mul_i32 s64, s63, 81920
    s_add_u32 s64, s64, 5242880
    s_mul_i32 s65, s45, 10
    v_add_u32 v8, 0, v3
    v_add_u32 v8, s65, v8
    v_lshrrev_b32 v9, 2, v8
    v_and_b32 v8, 3, v8
    v_lshlrev_b32 v9, 12, v9
    v_lshl_add_u32 v9, v8, 8, v9
    v_lshl_add_u32 v9, v2, 4, v9
    v_add_u32 v104, s64, v9
    s_add_u32 s66, s65, 4
    s_lshr_b32 s67, s66, 2
    s_lshl_b32 s67, s67, 12
    s_and_b32 s66, s66, 3
    s_lshl_b32 s66, s66, 8
    s_add_u32 s66, s66, s67
    s_add_u32 s66, s66, s64
    v_lshlrev_b32 v9, 10, v3
    v_lshl_add_u32 v9, v2, 4, v9
    v_add_u32 v106, s66, v9
    v_add_u32 v8, 5, v3
    v_add_u32 v8, s65, v8
    v_lshrrev_b32 v9, 2, v8
    v_and_b32 v8, 3, v8
    v_lshlrev_b32 v9, 12, v9
    v_lshl_add_u32 v9, v8, 8, v9
    v_lshl_add_u32 v9, v2, 4, v9
    v_add_u32 v105, s64, v9
    s_add_u32 s66, s65, 9
    s_lshr_b32 s67, s66, 2
    s_lshl_b32 s67, s67, 12
    s_and_b32 s66, s66, 3
    s_lshl_b32 s66, s66, 8
    s_add_u32 s66, s66, s67
    s_add_u32 s66, s66, s64
    v_lshlrev_b32 v9, 10, v3
    v_lshl_add_u32 v9, v2, 4, v9
    v_add_u32 v107, s66, v9
    s_lshl_b32 s63, s63, 3
    s_add_u32 s63, s63, s45
    s_lshl_b32 s63, s63, 7
    s_add_u32 s63, s63, 9043968
    v_mov_b32 v15, s63
    s_lshl_b32 s63, s45, 13
    s_add_u32 s63, s63, 7864320
    v_add_u32 v112, s63, v218
    v_mov_b32 v9, 2146435072
    v_cmp_gt_u32 vcc, 18, v1
    s_nop 1
    v_cndmask_b32 v113, v9, v112, vcc
    s_lshl_b32 s63, s45, 6
    v_add_u32 v8, s63, v1
    v_lshlrev_b32 v8, 7, v8
    v_add_u32 v13, 8953856, v8
    s_waitcnt lgkmcnt(0)
    ds_read_b64_tr_b16 v[120:121], v5 offset:0
    ds_read_b64_tr_b16 v[122:123], v6 offset:0
    ds_read_b64_tr_b16 v[124:125], v5 offset:2720
    ds_read_b64_tr_b16 v[126:127], v6 offset:2720
    ds_read_b64_tr_b16 v[128:129], v5 offset:5440
    ds_read_b64_tr_b16 v[130:131], v6 offset:5440
    ds_read_b64_tr_b16 v[132:133], v5 offset:8160
    ds_read_b64_tr_b16 v[134:135], v6 offset:8160
    s_waitcnt lgkmcnt(4)
    ds_read_b64_tr_b16 v[136:137], v5 offset:32
    ds_read_b64_tr_b16 v[138:139], v6 offset:32
    ds_read_b64_tr_b16 v[140:141], v5 offset:2752
    ds_read_b64_tr_b16 v[142:143], v6 offset:2752
    ds_read_b64_tr_b16 v[144:145], v5 offset:5472
    ds_read_b64_tr_b16 v[146:147], v6 offset:5472
    ds_read_b64_tr_b16 v[148:149], v5 offset:8192
    ds_read_b64_tr_b16 v[150:151], v6 offset:8192
    s_waitcnt lgkmcnt(4)
    ds_read_b64_tr_b16 v[152:153], v5 offset:64
    ds_read_b64_tr_b16 v[154:155], v6 offset:64
    ds_read_b64_tr_b16 v[156:157], v5 offset:2784
    ds_read_b64_tr_b16 v[158:159], v6 offset:2784
    ds_read_b64_tr_b16 v[160:161], v5 offset:5504
    ds_read_b64_tr_b16 v[162:163], v6 offset:5504
    ds_read_b64_tr_b16 v[164:165], v5 offset:8224
    ds_read_b64_tr_b16 v[166:167], v6 offset:8224
    s_waitcnt lgkmcnt(4)
    ds_read_b64_tr_b16 v[168:169], v5 offset:96
    ds_read_b64_tr_b16 v[170:171], v6 offset:96
    ds_read_b64_tr_b16 v[172:173], v5 offset:2816
    ds_read_b64_tr_b16 v[174:175], v6 offset:2816
    ds_read_b64_tr_b16 v[176:177], v5 offset:5536
    ds_read_b64_tr_b16 v[178:179], v6 offset:5536
    ds_read_b64_tr_b16 v[180:181], v5 offset:8256
    ds_read_b64_tr_b16 v[182:183], v6 offset:8256
    s_waitcnt lgkmcnt(4)
    s_mov_b32 s88, -1
    s_mov_b32 s89, 0
    s_movk_i32 s62, 0x1000
    buffer_load_dwordx4 a[80:83], v218, s[12:15], s96 offen offset:0 sc1
    buffer_load_dwordx4 a[84:87], v218, s[12:15], s96 offen offset:1024 sc1
    buffer_load_dwordx4 a[88:91], v218, s[12:15], s96 offen offset:2048 sc1
    buffer_load_dwordx4 a[92:95], v218, s[12:15], s96 offen offset:3072 sc1
    buffer_load_dwordx4 a[96:99], v219, s[12:15], s96 offen offset:0 sc1
    s_add_u32 s96, s96, 40960
    s_cmp_eq_u32 s96, s100
    s_cselect_b32 s96, s99, s96
    buffer_load_dwordx4 a[100:103], v218, s[12:15], s96 offen offset:0 sc1
    buffer_load_dwordx4 a[104:107], v218, s[12:15], s96 offen offset:1024 sc1
    buffer_load_dwordx4 a[108:111], v218, s[12:15], s96 offen offset:2048 sc1
    buffer_load_dwordx4 a[112:115], v218, s[12:15], s96 offen offset:3072 sc1
    buffer_load_dwordx4 a[116:119], v219, s[12:15], s96 offen offset:0 sc1
    s_add_u32 s96, s96, 40960
    s_cmp_eq_u32 s96, s100
    s_cselect_b32 s96, s99, s96
    buffer_load_dwordx4 a[120:123], v218, s[12:15], s96 offen offset:0 sc1
    buffer_load_dwordx4 a[124:127], v218, s[12:15], s96 offen offset:1024 sc1
    buffer_load_dwordx4 a[128:131], v218, s[12:15], s96 offen offset:2048 sc1
    buffer_load_dwordx4 a[132:135], v218, s[12:15], s96 offen offset:3072 sc1
    buffer_load_dwordx4 a[136:139], v219, s[12:15], s96 offen offset:0 sc1
    s_add_u32 s96, s96, 40960
    s_cmp_eq_u32 s96, s100
    s_cselect_b32 s96, s99, s96
    buffer_load_dwordx4 a[140:143], v218, s[12:15], s96 offen offset:0 sc1
    buffer_load_dwordx4 a[144:147], v218, s[12:15], s96 offen offset:1024 sc1
    buffer_load_dwordx4 a[148:151], v218, s[12:15], s96 offen offset:2048 sc1
    buffer_load_dwordx4 a[152:155], v218, s[12:15], s96 offen offset:3072 sc1
    buffer_load_dwordx4 a[156:159], v219, s[12:15], s96 offen offset:0 sc1
    s_add_u32 s96, s96, 40960
    s_cmp_eq_u32 s96, s100
    s_cselect_b32 s96, s99, s96
    buffer_load_dwordx4 a[160:163], v218, s[12:15], s96 offen offset:0 sc1
    buffer_load_dwordx4 a[164:167], v218, s[12:15], s96 offen offset:1024 sc1
    buffer_load_dwordx4 a[168:171], v218, s[12:15], s96 offen offset:2048 sc1
    buffer_load_dwordx4 a[172:175], v218, s[12:15], s96 offen offset:3072 sc1
    buffer_load_dwordx4 a[176:179], v219, s[12:15], s96 offen offset:0 sc1
    s_add_u32 s96, s96, 40960
    s_cmp_eq_u32 s96, s100
    s_cselect_b32 s96, s99, s96
    s_mov_b32 s61, 0x40000
    buffer_load_dword v9, v13, s[12:15], 0 offen sc1
    s_waitcnt vmcnt(0)
Lpoll5:
    v_cmp_ne_u32 vcc, s46, v9
    s_cbranch_vccz Lpoll5d
    s_mov_b64 exec, vcc
    s_sleep 6
    buffer_load_dword v9, v13, s[12:15], 0 offen sc1
    s_sub_u32 s61, s61, 1
    s_waitcnt vmcnt(0)
    s_cbranch_scc0 Lpoll5
Lpoll5d:
    s_mov_b64 exec, -1
    buffer_load_dwordx4 v[48:51], v112, s[12:15], 0 offen offset:0 sc1
    buffer_load_dwordx4 v[52:55], v112, s[12:15], 0 offen offset:1024 sc1
    buffer_load_dwordx4 v[56:59], v112, s[12:15], 0 offen offset:2048 sc1
    buffer_load_dwordx4 v[60:63], v113, s[12:15], 0 offen offset:3072 sc1
    buffer_load_dwordx4 v[64:67], v112, s[12:15], s62 offen offset:0 sc1
    buffer_load_dwordx4 v[68:71], v112, s[12:15], s62 offen offset:1024 sc1
    buffer_load_dwordx4 v[72:75], v112, s[12:15], s62 offen offset:2048 sc1
    buffer_load_dwordx4 v[76:79], v113, s[12:15], s62 offen offset:3072 sc1
    s_waitcnt vmcnt(7)
    v_cvt_pk_bf16_f32 v48, v48, v49
    v_cvt_pk_bf16_f32 v49, v50, v51
    ds_write_b64 v108, v[48:49] offset:0
    s_waitcnt vmcnt(6)
    v_cvt_pk_bf16_f32 v52, v52, v53
    v_cvt_pk_bf16_f32 v53, v54, v55
    ds_write_b64 v109, v[52:53] offset:0
    s_waitcnt vmcnt(5)
    v_cvt_pk_bf16_f32 v56, v56, v57
    v_cvt_pk_bf16_f32 v57, v58, v59
    ds_write_b64 v110, v[56:57] offset:0
    s_waitcnt vmcnt(4)
    v_cvt_pk_bf16_f32 v60, v60, v61
    v_cvt_pk_bf16_f32 v61, v62, v63
    ds_write_b64 v111, v[60:61] offset:0
    s_waitcnt vmcnt(3)
    v_cvt_pk_bf16_f32 v64, v64, v65
    v_cvt_pk_bf16_f32 v65, v66, v67
    ds_write_b64 v108, v[64:65] offset:2752
    s_waitcnt vmcnt(2)
    v_cvt_pk_bf16_f32 v68, v68, v69
    v_cvt_pk_bf16_f32 v69, v70, v71
    ds_write_b64 v109, v[68:69] offset:2752
    s_waitcnt vmcnt(1)
    v_cvt_pk_bf16_f32 v72, v72, v73
    v_cvt_pk_bf16_f32 v73, v74, v75
    ds_write_b64 v110, v[72:73] offset:2752
    s_waitcnt vmcnt(0)
    v_cvt_pk_bf16_f32 v76, v76, v77
    v_cvt_pk_bf16_f32 v77, v78, v79
    ds_write_b64 v111, v[76:77] offset:2752
    ds_read_b128 v[24:27], v102 offset:0
    ds_read_b128 v[16:19], v100 offset:0
    ds_read_b128 v[28:31], v103 offset:0
    ds_read_b128 v[20:23], v101 offset:0
    ds_read_b128 v[40:43], v102 offset:2752
    ds_read_b128 v[32:35], v100 offset:2752
    ds_read_b128 v[44:47], v103 offset:2752
    ds_read_b128 v[36:39], v101 offset:2752
    s_waitcnt lgkmcnt(4)
    v_mfma_f32_16x16x32_bf16 v[56:59], v[24:27], v[120:123], 0
    v_mfma_f32_16x16x32_bf16 v[48:51], v[16:19], v[120:123], 0
    v_mfma_f32_16x16x32_bf16 v[56:59], v[28:31], v[124:127], v[56:59]
    v_mfma_f32_16x16x32_bf16 v[52:55], v[20:23], v[124:127], 0
    s_waitcnt lgkmcnt(0)
    v_mfma_f32_16x16x32_bf16 v[68:71], v[40:43], v[128:131], 0
    v_mfma_f32_16x16x32_bf16 v[60:63], v[32:35], v[128:131], 0
    v_mfma_f32_16x16x32_bf16 v[68:71], v[44:47], v[132:135], v[68:71]
    v_mfma_f32_16x16x32_bf16 v[64:67], v[36:39], v[132:135], 0
    s_nop 1
    v_pk_add_f32 v[58:59], v[58:59], s[48:49] op_sel:[0,1]
    v_rcp_f32 v58, v58
    v_rcp_f32 v59, v59
    s_nop 0
    v_mfma_f32_16x16x32_bf16 v[80:83], v[24:27], v[136:139], 0
    v_pk_mul_f32 v[48:49], v[48:49], v[58:59] op_sel_hi:[1,0]
    v_pk_mul_f32 v[50:51], v[50:51], v[58:59] op_sel_hi:[1,0]
    v_pk_mul_f32 v[52:53], v[52:53], v[58:59] op_sel:[0,1]
    v_pk_mul_f32 v[54:55], v[54:55], v[58:59] op_sel:[0,1]
    v_mfma_f32_16x16x32_bf16 v[72:75], v[16:19], v[136:139], 0
    v_cndmask_b32 v58, v59, v58, s[88:89]
    v_cvt_pk_bf16_f32 v192, v48, v49
    v_cvt_pk_bf16_f32 v193, v50, v51
    v_cvt_pk_bf16_f32 v194, v52, v53
    v_mfma_f32_16x16x32_bf16 v[80:83], v[28:31], v[140:143], v[80:83]
    v_cvt_pk_bf16_f32 v195, v54, v55
    buffer_store_dwordx4 v[192:195], v104, s[12:15], 0 offen offset:0 sc1
    v_pk_mul_f32 v[56:57], v[56:57], v[58:59] op_sel_hi:[1,0]
    v_cvt_pk_bf16_f32 v184, v56, v57
    v_mfma_f32_16x16x32_bf16 v[76:79], v[20:23], v[140:143], 0
    v_pk_add_f32 v[70:71], v[70:71], s[48:49] op_sel:[0,1]
    v_rcp_f32 v70, v70
    v_rcp_f32 v71, v71
    s_nop 0
    v_mfma_f32_16x16x32_bf16 v[92:95], v[40:43], v[144:147], 0
    v_pk_mul_f32 v[60:61], v[60:61], v[70:71] op_sel_hi:[1,0]
    v_pk_mul_f32 v[62:63], v[62:63], v[70:71] op_sel_hi:[1,0]
    v_pk_mul_f32 v[64:65], v[64:65], v[70:71] op_sel:[0,1]
    v_pk_mul_f32 v[66:67], v[66:67], v[70:71] op_sel:[0,1]
    v_mfma_f32_16x16x32_bf16 v[84:87], v[32:35], v[144:147], 0
    v_cndmask_b32 v70, v71, v70, s[88:89]
    v_cvt_pk_bf16_f32 v196, v60, v61
    v_cvt_pk_bf16_f32 v197, v62, v63
    v_cvt_pk_bf16_f32 v198, v64, v65
    v_mfma_f32_16x16x32_bf16 v[92:95], v[44:47], v[148:151], v[92:95]
    v_cvt_pk_bf16_f32 v199, v66, v67
    buffer_store_dwordx4 v[196:199], v105, s[12:15], 0 offen offset:0 sc1
    v_pk_mul_f32 v[68:69], v[68:69], v[70:71] op_sel_hi:[1,0]
    v_cvt_pk_bf16_f32 v188, v68, v69
    v_mfma_f32_16x16x32_bf16 v[88:91], v[36:39], v[148:151], 0
    v_pk_add_f32 v[82:83], v[82:83], s[48:49] op_sel:[0,1]
    v_rcp_f32 v82, v82
    v_rcp_f32 v83, v83
    s_nop 0
    v_mfma_f32_16x16x32_bf16 v[56:59], v[24:27], v[152:155], 0
    v_pk_mul_f32 v[72:73], v[72:73], v[82:83] op_sel_hi:[1,0]
    v_pk_mul_f32 v[74:75], v[74:75], v[82:83] op_sel_hi:[1,0]
    v_pk_mul_f32 v[76:77], v[76:77], v[82:83] op_sel:[0,1]
    v_pk_mul_f32 v[78:79], v[78:79], v[82:83] op_sel:[0,1]
    v_mfma_f32_16x16x32_bf16 v[48:51], v[16:19], v[152:155], 0
    v_cndmask_b32 v82, v83, v82, s[88:89]
    v_cvt_pk_bf16_f32 v192, v72, v73
    v_cvt_pk_bf16_f32 v193, v74, v75
    v_cvt_pk_bf16_f32 v194, v76, v77
    v_mfma_f32_16x16x32_bf16 v[56:59], v[28:31], v[156:159], v[56:59]
    v_cvt_pk_bf16_f32 v195, v78, v79
    buffer_store_dwordx4 v[192:195], v104, s[12:15], 0 offen offset:1024 sc1
    v_pk_mul_f32 v[80:81], v[80:81], v[82:83] op_sel_hi:[1,0]
    v_cvt_pk_bf16_f32 v185, v80, v81
    v_mfma_f32_16x16x32_bf16 v[52:55], v[20:23], v[156:159], 0
    v_pk_add_f32 v[94:95], v[94:95], s[48:49] op_sel:[0,1]
    v_rcp_f32 v94, v94
    v_rcp_f32 v95, v95
    s_nop 0
    v_mfma_f32_16x16x32_bf16 v[68:71], v[40:43], v[160:163], 0
    v_pk_mul_f32 v[84:85], v[84:85], v[94:95] op_sel_hi:[1,0]
    v_pk_mul_f32 v[86:87], v[86:87], v[94:95] op_sel_hi:[1,0]
    v_pk_mul_f32 v[88:89], v[88:89], v[94:95] op_sel:[0,1]
    v_pk_mul_f32 v[90:91], v[90:91], v[94:95] op_sel:[0,1]
    v_mfma_f32_16x16x32_bf16 v[60:63], v[32:35], v[160:163], 0
    v_cndmask_b32 v94, v95, v94, s[88:89]
    v_cvt_pk_bf16_f32 v196, v84, v85
    v_cvt_pk_bf16_f32 v197, v86, v87
    v_cvt_pk_bf16_f32 v198, v88, v89
    v_mfma_f32_16x16x32_bf16 v[68:71], v[44:47], v[164:167], v[68:71]
    v_cvt_pk_bf16_f32 v199, v90, v91
    buffer_store_dwordx4 v[196:199], v105, s[12:15], 0 offen offset:1024 sc1
    v_pk_mul_f32 v[92:93], v[92:93], v[94:95] op_sel_hi:[1,0]
    v_cvt_pk_bf16_f32 v189, v92, v93
    v_mfma_f32_16x16x32_bf16 v[64:67], v[36:39], v[164:167], 0
    v_pk_add_f32 v[58:59], v[58:59], s[48:49] op_sel:[0,1]
    v_rcp_f32 v58, v58
    v_rcp_f32 v59, v59
    s_nop 0
    v_mfma_f32_16x16x32_bf16 v[80:83], v[24:27], v[168:171], 0
    v_pk_mul_f32 v[48:49], v[48:49], v[58:59] op_sel_hi:[1,0]
    v_pk_mul_f32 v[50:51], v[50:51], v[58:59] op_sel_hi:[1,0]
    v_pk_mul_f32 v[52:53], v[52:53], v[58:59] op_sel:[0,1]
    v_pk_mul_f32 v[54:55], v[54:55], v[58:59] op_sel:[0,1]
    v_mfma_f32_16x16x32_bf16 v[72:75], v[16:19], v[168:171], 0
    v_cndmask_b32 v58, v59, v58, s[88:89]
    v_cvt_pk_bf16_f32 v192, v48, v49
    v_cvt_pk_bf16_f32 v193, v50, v51
    v_cvt_pk_bf16_f32 v194, v52, v53
    v_mfma_f32_16x16x32_bf16 v[80:83], v[28:31], v[172:175], v[80:83]
    v_cvt_pk_bf16_f32 v195, v54, v55
    buffer_store_dwordx4 v[192:195], v104, s[12:15], 0 offen offset:2048 sc1
    v_pk_mul_f32 v[56:57], v[56:57], v[58:59] op_sel_hi:[1,0]
    v_cvt_pk_bf16_f32 v186, v56, v57
    v_mfma_f32_16x16x32_bf16 v[76:79], v[20:23], v[172:175], 0
    v_pk_add_f32 v[70:71], v[70:71], s[48:49] op_sel:[0,1]
    v_rcp_f32 v70, v70
    v_rcp_f32 v71, v71
    s_nop 0
    v_mfma_f32_16x16x32_bf16 v[92:95], v[40:43], v[176:179], 0
    v_pk_mul_f32 v[60:61], v[60:61], v[70:71] op_sel_hi:[1,0]
    v_pk_mul_f32 v[62:63], v[62:63], v[70:71] op_sel_hi:[1,0]
    v_pk_mul_f32 v[64:65], v[64:65], v[70:71] op_sel:[0,1]
    v_pk_mul_f32 v[66:67], v[66:67], v[70:71] op_sel:[0,1]
    v_mfma_f32_16x16x32_bf16 v[84:87], v[32:35], v[176:179], 0
    v_cndmask_b32 v70, v71, v70, s[88:89]
    v_cvt_pk_bf16_f32 v196, v60, v61
    v_cvt_pk_bf16_f32 v197, v62, v63
    v_cvt_pk_bf16_f32 v198, v64, v65
    v_mfma_f32_16x16x32_bf16 v[92:95], v[44:47], v[180:183], v[92:95]
    v_cvt_pk_bf16_f32 v199, v66, v67
    buffer_store_dwordx4 v[196:199], v105, s[12:15], 0 offen offset:2048 sc1
    v_pk_mul_f32 v[68:69], v[68:69], v[70:71] op_sel_hi:[1,0]
    v_cvt_pk_bf16_f32 v190, v68, v69
    v_mfma_f32_16x16x32_bf16 v[88:91], v[36:39], v[180:183], 0
    v_pk_add_f32 v[82:83], v[82:83], s[48:49] op_sel:[0,1]
    v_rcp_f32 v82, v82
    v_rcp_f32 v83, v83
    s_nop 0
    v_pk_mul_f32 v[72:73], v[72:73], v[82:83] op_sel_hi:[1,0]
    v_pk_mul_f32 v[74:75], v[74:75], v[82:83] op_sel_hi:[1,0]
    v_pk_mul_f32 v[76:77], v[76:77], v[82:83] op_sel:[0,1]
    v_pk_mul_f32 v[78:79], v[78:79], v[82:83] op_sel:[0,1]
    v_cndmask_b32 v82, v83, v82, s[88:89]
    v_cvt_pk_bf16_f32 v192, v72, v73
    v_cvt_pk_bf16_f32 v193, v74, v75
    v_cvt_pk_bf16_f32 v194, v76, v77
    v_cvt_pk_bf16_f32 v195, v78, v79
    buffer_store_dwordx4 v[192:195], v104, s[12:15], 0 offen offset:3072 sc1
    v_pk_mul_f32 v[80:81], v[80:81], v[82:83] op_sel_hi:[1,0]
    v_cvt_pk_bf16_f32 v187, v80, v81
    v_pk_add_f32 v[94:95], v[94:95], s[48:49] op_sel:[0,1]
    v_rcp_f32 v94, v94
    v_rcp_f32 v95, v95
    s_nop 0
    v_pk_mul_f32 v[84:85], v[84:85], v[94:95] op_sel_hi:[1,0]
    v_pk_mul_f32 v[86:87], v[86:87], v[94:95] op_sel_hi:[1,0]
    v_pk_mul_f32 v[88:89], v[88:89], v[94:95] op_sel:[0,1]
    v_pk_mul_f32 v[90:91], v[90:91], v[94:95] op_sel:[0,1]
    v_cndmask_b32 v94, v95, v94, s[88:89]
    v_cvt_pk_bf16_f32 v196, v84, v85
    v_cvt_pk_bf16_f32 v197, v86, v87
    v_cvt_pk_bf16_f32 v198, v88, v89
    v_cvt_pk_bf16_f32 v199, v90, v91
    buffer_store_dwordx4 v[196:199], v105, s[12:15], 0 offen offset:3072 sc1
    v_pk_mul_f32 v[92:93], v[92:93], v[94:95] op_sel_hi:[1,0]
    v_cvt_pk_bf16_f32 v191, v92, v93
    v_permlane32_swap_b32 v184, v186
    v_permlane32_swap_b32 v185, v187
    s_nop 1
    v_permlane16_swap_b32 v184, v185
    v_permlane16_swap_b32 v186, v187
    buffer_store_dwordx4 v[184:187], v106, s[12:15], 0 offen sc1
    v_permlane32_swap_b32 v188, v190
    v_permlane32_swap_b32 v189, v191
    s_nop 1
    v_permlane16_swap_b32 v188, v189
    v_permlane16_swap_b32 v190, v191
    buffer_store_dwordx4 v[188:191], v107, s[12:15], 0 offen sc1
    v_mov_b32 v10, s46
    v_mov_b32 v11, s46
    s_waitcnt vmcnt(0)
    s_mov_b64 exec, 1
    buffer_store_dwordx2 v[10:11], v15, s[12:15], 0 offen sc1
    s_mov_b64 exec, -1
Lp3:
    v_lshlrev_b32 v6, 4, v1
    s_add_u32 s62, s40, 0
    s_and_b32 s62, s62, 3
    s_lshl_b32 s63, s62, 10
    v_add_u32 v240, s63, v6
    s_add_u32 s62, s40, 1
    s_and_b32 s62, s62, 3
    s_lshl_b32 s63, s62, 10
    v_add_u32 v241, s63, v6
    s_mul_i32 s62, s62, 15360
    s_add_u32 s62, s62, 81920
    v_add_u32 v244, s62, v6
    s_add_u32 s62, s40, 2
    s_and_b32 s62, s62, 3
    s_lshl_b32 s63, s62, 10
    v_add_u32 v242, s63, v6
    s_mul_i32 s62, s62, 15360
    s_add_u32 s62, s62, 87040
    v_add_u32 v245, s62, v6
    s_add_u32 s62, s40, 3
    s_and_b32 s62, s62, 3
    s_lshl_b32 s63, s62, 10
    v_add_u32 v243, s63, v6
    s_mul_i32 s62, s62, 15360
    s_add_u32 s62, s62, 92160
    v_add_u32 v246, s62, v6
    s_mul_i32 s62, s40, 15360
    s_add_u32 s62, s62, 81920
    v_add_u32 v247, s62, v6
    s_mul_i32 s62, s40, 3072
    s_add_u32 s62, s62, 57344
    v_add_u32 v248, s62, v6
    s_mul_i32 s62, s41, 12288
    s_add_u32 s62, s62, 57344
    v_add_u32 v249, s62, v6
    s_lshl_b32 s62, s58, 3
    s_mul_i32 s63, s101, 26216
    s_lshr_b32 s63, s63, 16
    v_add_u32 v7, s63, v1
    v_and_b32 v7, 7, v7
    v_add_u32 v7, s62, v7
    s_mov_b32 s56, s63
    v_lshlrev_b32 v7, 7, v7
    v_add_u32 v9, 9043968, v7
    v_mov_b32 v15, 560
    v_add_u32 v12, 0, v1
    v_mul_u32_u24 v13, 0x199a, v12
    v_lshrrev_b32 v13, 16, v13
    v_mul_u32_u24 v14, 10, v13
    v_sub_u32 v14, v12, v14
    v_mul_u32_u24 v13, 40960, v13
    v_lshl_add_u32 v13, v14, 4, v13
    v_cmp_lt_u32 vcc, 4, v14
    s_nop 1
    v_cndmask_b32 v14, 0, v15, vcc
    v_add_u32 v253, v13, v14
    v_add_u32 v12, 64, v1
    v_mul_u32_u24 v13, 0x199a, v12
    v_lshrrev_b32 v13, 16, v13
    v_mul_u32_u24 v14, 10, v13
    v_sub_u32 v14, v12, v14
    v_mul_u32_u24 v13, 40960, v13
    v_lshl_add_u32 v13, v14, 4, v13
    v_cmp_lt_u32 vcc, 4, v14
    s_nop 1
    v_cndmask_b32 v14, 0, v15, vcc
    v_add_u32 v254, v13, v14
    v_add_u32 v12, 128, v1
    v_mul_u32_u24 v13, 0x199a, v12
    v_lshrrev_b32 v13, 16, v13
    v_mul_u32_u24 v14, 10, v13
    v_sub_u32 v14, v12, v14
    v_mul_u32_u24 v13, 40960, v13
    v_lshl_add_u32 v13, v14, 4, v13
    v_cmp_lt_u32 vcc, 4, v14
    s_nop 1
    v_cndmask_b32 v14, 0, v15, vcc
    v_add_u32 v255, v13, v14
    v_mov_b32 v12, 2146435072
    v_cmp_gt_u32 vcc, 32, v1
    s_nop 1
    v_cndmask_b32 v255, v12, v255, vcc
    s_mul_i32 s94, s40, 655360
    s_mul_i32 s63, s58, 1280
    s_add_u32 s94, s94, s63
    s_mul_i32 s63, s59, 80
    s_add_u32 s94, s94, s63
    s_mul_i32 s64, s40, 2560
    s_add_u32 s64, s64, 143360
    v_mul_u32_u24 v12, 160, v2
    v_lshl_add_u32 v12, v3, 3, v12
    v_add_u32 v250, s64, v12
    v_add_u32 v252, s64, v6
    v_lshrrev_b32 v12, 5, v1
    v_lshl_add_u32 v251, v12, 6, v250
    v_lshlrev_b32 v12, 31, v12
    v_or_b32 v14, 0x3f800000, v12
    s_lshl_b32 s95, s58, 8
    s_lshl_b32 s63, s40, 6
    s_add_u32 s95, s95, s63
    s_add_u32 s95, s95, 8912896
    v_lshlrev_b32 v7, 2, v2
    s_mul_i32 s53, s58, 81920
    s_lshl_b32 s63, s101, 12
    s_add_u32 s51, s53, s63
    s_add_u32 s51, s51, 5242880
    s_add_u32 s52, s51, 36864
    s_lshl_b32 s63, s84, 12
    s_add_u32 s98, s51, s63
    s_cmp_eq_u32 s42, 0
    s_cbranch_scc0 Lp3b
    buffer_load_dwordx4 a[120:123], v218, s[12:15], s96 offen offset:0 sc1
    buffer_load_dwordx4 a[124:127], v218, s[12:15], s96 offen offset:1024 sc1
    buffer_load_dwordx4 a[128:131], v218, s[12:15], s96 offen offset:2048 sc1
    buffer_load_dwordx4 a[132:135], v218, s[12:15], s96 offen offset:3072 sc1
    buffer_load_dwordx4 a[136:139], v219, s[12:15], s96 offen offset:0 sc1
    s_add_u32 s96, s96, 40960
    s_cmp_eq_u32 s96, s100
    s_cselect_b32 s96, s99, s96
    s_mov_b32 s62, 843776
    buffer_load_dwordx4 a[160:163], v6, s[24:27], s62 offen offset:0
    buffer_load_dwordx4 a[164:167], v6, s[24:27], s62 offen offset:1024
    buffer_load_dwordx4 a[168:171], v6, s[24:27], s62 offen offset:2048
    buffer_load_dwordx4 a[172:175], v6, s[24:27], s62 offen offset:3072
    s_mov_b32 s62, 847872
    buffer_load_dwordx4 a[176:179], v6, s[24:27], s62 offen offset:0
    buffer_load_dwordx4 a[180:183], v6, s[24:27], s62 offen offset:1024
    buffer_load_dwordx4 a[184:187], v6, s[24:27], s62 offen offset:2048
    buffer_load_dwordx4 a[188:191], v6, s[24:27], s62 offen offset:3072
    v_lshrrev_b32 v4, 2, v2
    v_lshlrev_b32 v4, 8, v4
    v_lshl_add_u32 v4, v3, 6, v4
    v_and_b32 v12, 3, v2
    v_lshl_add_u32 v4, v12, 4, v4
    s_mul_i32 s63, s41, 40960
    s_add_u32 s54, s53, s63
    s_add_u32 s54, s54, 2621440
    s_add_u32 s55, s54, 40960
    s_lshl_b32 s63, s85, 12
    s_add_u32 s50, s54, s63
    s_mul_i32 s62, s41, 48
    s_add_u32 s63, s62, 47
    v_add_u32 v12, s62, v1
    v_min_u32 v12, s63, v12
    v_lshlrev_b32 v12, 7, v12
    v_add_u32 v8, 9019392, v12
    s_mov_b32 s61, 0x40000
    buffer_load_dwordx2 v[10:11], v8, s[12:15], 0 offen sc1
    s_waitcnt vmcnt(0)
Lpoll6:
    v_cmp_ne_u32 vcc, s46, v10
    v_cmp_ne_u32 s[66:67], s46, v11
    s_nop 0
    s_or_b64 vcc, vcc, s[66:67]
    s_cbranch_vccz Lpoll6d
    s_mov_b64 exec, vcc
    s_sleep 6
    buffer_load_dwordx2 v[10:11], v8, s[12:15], 0 offen sc1
    s_sub_u32 s61, s61, 1
    s_waitcnt vmcnt(0)
    s_cbranch_scc0 Lpoll6
Lpoll6d:
    s_mov_b64 exec, -1
    s_mov_b32 s49, 0
    s_mov_b32 s61, 0x40000
    buffer_load_dwordx4 v[64:67], v4, s[12:15], s50 offen offset:0 sc1
    buffer_load_dwordx4 v[68:71], v4, s[12:15], s50 offen offset:1024 sc1
    buffer_load_dwordx4 v[72:75], v4, s[12:15], s50 offen offset:2048 sc1
    buffer_load_dwordx4 v[76:79], v4, s[12:15], s50 offen offset:3072 sc1
    s_add_u32 s50, s50, 4096
    s_cmp_eq_u32 s50, s55
    s_cselect_b32 s50, s54, s50
    buffer_load_dwordx4 v[80:83], v4, s[12:15], s50 offen offset:0 sc1
    buffer_load_dwordx4 v[84:87], v4, s[12:15], s50 offen offset:1024 sc1
    buffer_load_dwordx4 v[88:91], v4, s[12:15], s50 offen offset:2048 sc1
    buffer_load_dwordx4 v[92:95], v4, s[12:15], s50 offen offset:3072 sc1
    s_add_u32 s50, s50, 4096
    s_cmp_eq_u32 s50, s55
    s_cselect_b32 s50, s54, s50
    buffer_load_dwordx4 v[96:99], v4, s[12:15], s50 offen offset:0 sc1
    buffer_load_dwordx4 v[100:103], v4, s[12:15], s50 offen offset:1024 sc1
    buffer_load_dwordx4 v[104:107], v4, s[12:15], s50 offen offset:2048 sc1
    buffer_load_dwordx4 v[108:111], v4, s[12:15], s50 offen offset:3072 sc1
    s_add_u32 s50, s50, 4096
    s_cmp_eq_u32 s50, s55
    s_cselect_b32 s50, s54, s50
    buffer_load_dwordx4 v[112:115], v4, s[12:15], s50 offen offset:0 sc1
    buffer_load_dwordx4 v[116:119], v4, s[12:15], s50 offen offset:1024 sc1
    buffer_load_dwordx4 v[120:123], v4, s[12:15], s50 offen offset:2048 sc1
    buffer_load_dwordx4 v[124:127], v4, s[12:15], s50 offen offset:3072 sc1
    s_add_u32 s50, s50, 4096
    s_cmp_eq_u32 s50, s55
    s_cselect_b32 s50, s54, s50
    s_waitcnt vmcnt(12)
    v_mfma_f32_16x16x32_bf16 v[16:19], v[64:67], a[0:3], 0
    v_mfma_f32_16x16x32_bf16 v[28:31], v[68:71], a[0:3], 0
    v_mfma_f32_16x16x32_bf16 v[40:43], v[72:75], a[0:3], 0
    buffer_load_dwordx4 v[128:131], v4, s[12:15], s50 offen offset:0 sc1
    v_mfma_f32_16x16x32_bf16 v[52:55], v[76:79], a[0:3], 0
    v_mfma_f32_16x16x32_bf16 v[20:23], v[64:67], a[4:7], 0
    buffer_load_dwordx4 v[132:135], v4, s[12:15], s50 offen offset:1024 sc1
    v_mfma_f32_16x16x32_bf16 v[32:35], v[68:71], a[4:7], 0
    v_mfma_f32_16x16x32_bf16 v[44:47], v[72:75], a[4:7], 0
    v_mfma_f32_16x16x32_bf16 v[56:59], v[76:79], a[4:7], 0
    buffer_load_dwordx4 v[136:139], v4, s[12:15], s50 offen offset:2048 sc1
    v_mfma_f32_16x16x32_bf16 v[24:27], v[64:67], a[8:11], 0
    v_mfma_f32_16x16x32_bf16 v[36:39], v[68:71], a[8:11], 0
    buffer_load_dwordx4 v[140:143], v4, s[12:15], s50 offen offset:3072 sc1
    s_add_u32 s50, s50, 4096
    s_cmp_eq_u32 s50, s55
    s_cselect_b32 s50, s54, s50
    v_mfma_f32_16x16x32_bf16 v[48:51], v[72:75], a[8:11], 0
    v_mfma_f32_16x16x32_bf16 v[60:63], v[76:79], a[8:11], 0
    s_waitcnt vmcnt(12)
    v_mfma_f32_16x16x32_bf16 v[16:19], v[80:83], a[12:15], v[16:19]
    v_mfma_f32_16x16x32_bf16 v[28:31], v[84:87], a[12:15], v[28:31]
    v_mfma_f32_16x16x32_bf16 v[40:43], v[88:91], a[12:15], v[40:43]
    buffer_load_dwordx4 v[144:147], v4, s[12:15], s50 offen offset:0 sc1
    v_mfma_f32_16x16x32_bf16 v[52:55], v[92:95], a[12:15], v[52:55]
    v_mfma_f32_16x16x32_bf16 v[20:23], v[80:83], a[16:19], v[20:23]
    buffer_load_dwordx4 v[148:151], v4, s[12:15], s50 offen offset:1024 sc1
    v_mfma_f32_16x16x32_bf16 v[32:35], v[84:87], a[16:19], v[32:35]
    v_mfma_f32_16x16x32_bf16 v[44:47], v[88:91], a[16:19], v[44:47]
    v_mfma_f32_16x16x32_bf16 v[56:59], v[92:95], a[16:19], v[56:59]
    buffer_load_dwordx4 v[152:155], v4, s[12:15], s50 offen offset:2048 sc1
    v_mfma_f32_16x16x32_bf16 v[24:27], v[80:83], a[20:23], v[24:27]
    v_mfma_f32_16x16x32_bf16 v[36:39], v[84:87], a[20:23], v[36:39]
    buffer_load_dwordx4 v[156:159], v4, s[12:15], s50 offen offset:3072 sc1
    s_add_u32 s50, s50, 4096
    s_cmp_eq_u32 s50, s55
    s_cselect_b32 s50, s54, s50
    v_mfma_f32_16x16x32_bf16 v[48:51], v[88:91], a[20:23], v[48:51]
    v_mfma_f32_16x16x32_bf16 v[60:63], v[92:95], a[20:23], v[60:63]
    s_waitcnt vmcnt(12)
    v_mfma_f32_16x16x32_bf16 v[16:19], v[96:99], a[24:27], v[16:19]
    v_mfma_f32_16x16x32_bf16 v[28:31], v[100:103], a[24:27], v[28:31]
    v_mfma_f32_16x16x32_bf16 v[40:43], v[104:107], a[24:27], v[40:43]
    buffer_load_dwordx4 v[160:163], v4, s[12:15], s50 offen offset:0 sc1
    v_mfma_f32_16x16x32_bf16 v[52:55], v[108:111], a[24:27], v[52:55]
    v_mfma_f32_16x16x32_bf16 v[20:23], v[96:99], a[28:31], v[20:23]
    buffer_load_dwordx4 v[164:167], v4, s[12:15], s50 offen offset:1024 sc1
    v_mfma_f32_16x16x32_bf16 v[32:35], v[100:103], a[28:31], v[32:35]
    v_mfma_f32_16x16x32_bf16 v[44:47], v[104:107], a[28:31], v[44:47]
    v_mfma_f32_16x16x32_bf16 v[56:59], v[108:111], a[28:31], v[56:59]
    buffer_load_dwordx4 v[168:171], v4, s[12:15], s50 offen offset:2048 sc1
    v_mfma_f32_16x16x32_bf16 v[24:27], v[96:99], a[32:35], v[24:27]
    v_mfma_f32_16x16x32_bf16 v[36:39], v[100:103], a[32:35], v[36:39]
    buffer_load_dwordx4 v[172:175], v4, s[12:15], s50 offen offset:3072 sc1
    s_add_u32 s50, s50, 4096
    s_cmp_eq_u32 s50, s55
    s_cselect_b32 s50, s54, s50
    v_mfma_f32_16x16x32_bf16 v[48:51], v[104:107], a[32:35], v[48:51]
    v_mfma_f32_16x16x32_bf16 v[60:63], v[108:111], a[32:35], v[60:63]
    s_waitcnt vmcnt(12)
    v_mfma_f32_16x16x32_bf16 v[16:19], v[112:115], a[36:39], v[16:19]
    v_mfma_f32_16x16x32_bf16 v[28:31], v[116:119], a[36:39], v[28:31]
    v_mfma_f32_16x16x32_bf16 v[40:43], v[120:123], a[36:39], v[40:43]
    buffer_load_dwordx4 v[176:179], v4, s[12:15], s50 offen offset:0 sc1
    v_mfma_f32_16x16x32_bf16 v[52:55], v[124:127], a[36:39], v[52:55]
    v_mfma_f32_16x16x32_bf16 v[20:23], v[112:115], a[40:43], v[20:23]
    buffer_load_dwordx4 v[180:183], v4, s[12:15], s50 offen offset:1024 sc1
    v_mfma_f32_16x16x32_bf16 v[32:35], v[116:119], a[40:43], v[32:35]
    v_mfma_f32_16x16x32_bf16 v[44:47], v[120:123], a[40:43], v[44:47]
    v_mfma_f32_16x16x32_bf16 v[56:59], v[124:127], a[40:43], v[56:59]
    buffer_load_dwordx4 v[184:187], v4, s[12:15], s50 offen offset:2048 sc1
    v_mfma_f32_16x16x32_bf16 v[24:27], v[112:115], a[44:47], v[24:27]
    v_mfma_f32_16x16x32_bf16 v[36:39], v[116:119], a[44:47], v[36:39]
    buffer_load_dwordx4 v[188:191], v4, s[12:15], s50 offen offset:3072 sc1
    s_add_u32 s50, s50, 4096
    s_cmp_eq_u32 s50, s55
    s_cselect_b32 s50, s54, s50
    v_mfma_f32_16x16x32_bf16 v[48:51], v[120:123], a[44:47], v[48:51]
    v_mfma_f32_16x16x32_bf16 v[60:63], v[124:127], a[44:47], v[60:63]
    s_waitcnt vmcnt(12)
    v_mfma_f32_16x16x32_bf16 v[16:19], v[128:131], a[48:51], v[16:19]
    v_mfma_f32_16x16x32_bf16 v[28:31], v[132:135], a[48:51], v[28:31]
    v_mfma_f32_16x16x32_bf16 v[40:43], v[136:139], a[48:51], v[40:43]
    buffer_load_dwordx4 v[192:195], v4, s[12:15], s50 offen offset:0 sc1
    v_mfma_f32_16x16x32_bf16 v[52:55], v[140:143], a[48:51], v[52:55]
    v_mfma_f32_16x16x32_bf16 v[20:23], v[128:131], a[52:55], v[20:23]
    buffer_load_dwordx4 v[196:199], v4, s[12:15], s50 offen offset:1024 sc1
    v_mfma_f32_16x16x32_bf16 v[32:35], v[132:135], a[52:55], v[32:35]
    v_mfma_f32_16x16x32_bf16 v[44:47], v[136:139], a[52:55], v[44:47]
    v_mfma_f32_16x16x32_bf16 v[56:59], v[140:143], a[52:55], v[56:59]
    buffer_load_dwordx4 v[200:203], v4, s[12:15], s50 offen offset:2048 sc1
    v_mfma_f32_16x16x32_bf16 v[24:27], v[128:131], a[56:59], v[24:27]
    v_mfma_f32_16x16x32_bf16 v[36:39], v[132:135], a[56:59], v[36:39]
    buffer_load_dwordx4 v[204:207], v4, s[12:15], s50 offen offset:3072 sc1
    s_add_u32 s50, s50, 4096
    s_cmp_eq_u32 s50, s55
    s_cselect_b32 s50, s54, s50
    v_mfma_f32_16x16x32_bf16 v[48:51], v[136:139], a[56:59], v[48:51]
    v_mfma_f32_16x16x32_bf16 v[60:63], v[140:143], a[56:59], v[60:63]
    s_waitcnt vmcnt(12)
    v_mfma_f32_16x16x32_bf16 v[16:19], v[144:147], a[60:63], v[16:19]
    v_mfma_f32_16x16x32_bf16 v[28:31], v[148:151], a[60:63], v[28:31]
    v_mfma_f32_16x16x32_bf16 v[40:43], v[152:155], a[60:63], v[40:43]
    buffer_load_dwordx4 v[64:67], v4, s[12:15], s50 offen offset:0 sc1
    v_mfma_f32_16x16x32_bf16 v[52:55], v[156:159], a[60:63], v[52:55]
    v_mfma_f32_16x16x32_bf16 v[20:23], v[144:147], a[64:67], v[20:23]
    buffer_load_dwordx4 v[68:71], v4, s[12:15], s50 offen offset:1024 sc1
    v_mfma_f32_16x16x32_bf16 v[32:35], v[148:151], a[64:67], v[32:35]
    v_mfma_f32_16x16x32_bf16 v[44:47], v[152:155], a[64:67], v[44:47]
    v_mfma_f32_16x16x32_bf16 v[56:59], v[156:159], a[64:67], v[56:59]
    buffer_load_dwordx4 v[72:75], v4, s[12:15], s50 offen offset:2048 sc1
    v_mfma_f32_16x16x32_bf16 v[24:27], v[144:147], a[68:71], v[24:27]
    v_mfma_f32_16x16x32_bf16 v[36:39], v[148:151], a[68:71], v[36:39]
    buffer_load_dwordx4 v[76:79], v4, s[12:15], s50 offen offset:3072 sc1
    s_add_u32 s50, s50, 4096
    s_cmp_eq_u32 s50, s55
    s_cselect_b32 s50, s54, s50
    v_mfma_f32_16x16x32_bf16 v[48:51], v[152:155], a[68:71], v[48:51]
    v_mfma_f32_16x16x32_bf16 v[60:63], v[156:159], a[68:71], v[60:63]
    s_waitcnt vmcnt(12)
    v_mfma_f32_16x16x32_bf16 v[16:19], v[160:163], a[72:75], v[16:19]
    v_mfma_f32_16x16x32_bf16 v[28:31], v[164:167], a[72:75], v[28:31]
    v_mfma_f32_16x16x32_bf16 v[40:43], v[168:171], a[72:75], v[40:43]
    v_mfma_f32_16x16x32_bf16 v[52:55], v[172:175], a[72:75], v[52:55]
    v_mfma_f32_16x16x32_bf16 v[20:23], v[160:163], a[76:79], v[20:23]
    v_mfma_f32_16x16x32_bf16 v[32:35], v[164:167], a[76:79], v[32:35]
    v_mfma_f32_16x16x32_bf16 v[44:47], v[168:171], a[76:79], v[44:47]
    v_mfma_f32_16x16x32_bf16 v[56:59], v[172:175], a[76:79], v[56:59]
    v_mfma_f32_16x16x32_bf16 v[24:27], v[160:163], a[80:83], v[24:27]
    v_mfma_f32_16x16x32_bf16 v[36:39], v[164:167], a[80:83], v[36:39]
    buffer_load_dword v10, v9, s[12:15], 0 offen sc1
    v_mfma_f32_16x16x32_bf16 v[48:51], v[168:171], a[80:83], v[48:51]
    v_mfma_f32_16x16x32_bf16 v[60:63], v[172:175], a[80:83], v[60:63]
    s_waitcnt vmcnt(9)
    v_mfma_f32_16x16x32_bf16 v[16:19], v[176:179], a[84:87], v[16:19]
    v_mfma_f32_16x16x32_bf16 v[28:31], v[180:183], a[84:87], v[28:31]
    v_mfma_f32_16x16x32_bf16 v[40:43], v[184:187], a[84:87], v[40:43]
    v_mfma_f32_16x16x32_bf16 v[52:55], v[188:191], a[84:87], v[52:55]
    v_mfma_f32_16x16x32_bf16 v[20:23], v[176:179], a[88:91], v[20:23]
    v_mfma_f32_16x16x32_bf16 v[32:35], v[180:183], a[88:91], v[32:35]
    v_mfma_f32_16x16x32_bf16 v[44:47], v[184:187], a[88:91], v[44:47]
    v_mfma_f32_16x16x32_bf16 v[56:59], v[188:191], a[88:91], v[56:59]
    v_mfma_f32_16x16x32_bf16 v[24:27], v[176:179], a[92:95], v[24:27]
    v_mfma_f32_16x16x32_bf16 v[36:39], v[180:183], a[92:95], v[36:39]
    v_mfma_f32_16x16x32_bf16 v[48:51], v[184:187], a[92:95], v[48:51]
    v_mfma_f32_16x16x32_bf16 v[60:63], v[188:191], a[92:95], v[60:63]
    s_waitcnt vmcnt(5)
    v_mfma_f32_16x16x32_bf16 v[16:19], v[192:195], a[96:99], v[16:19]
    v_mfma_f32_16x16x32_bf16 v[28:31], v[196:199], a[96:99], v[28:31]
    v_mfma_f32_16x16x32_bf16 v[40:43], v[200:203], a[96:99], v[40:43]
    v_mfma_f32_16x16x32_bf16 v[52:55], v[204:207], a[96:99], v[52:55]
    v_mfma_f32_16x16x32_bf16 v[20:23], v[192:195], a[100:103], v[20:23]
    v_mfma_f32_16x16x32_bf16 v[32:35], v[196:199], a[100:103], v[32:35]
    v_mfma_f32_16x16x32_bf16 v[44:47], v[200:203], a[100:103], v[44:47]
    v_mfma_f32_16x16x32_bf16 v[56:59], v[204:207], a[100:103], v[56:59]
    v_mfma_f32_16x16x32_bf16 v[24:27], v[192:195], a[104:107], v[24:27]
    v_mfma_f32_16x16x32_bf16 v[36:39], v[196:199], a[104:107], v[36:39]
    v_mfma_f32_16x16x32_bf16 v[48:51], v[200:203], a[104:107], v[48:51]
    v_mfma_f32_16x16x32_bf16 v[60:63], v[204:207], a[104:107], v[60:63]
    s_waitcnt vmcnt(1)
    v_mfma_f32_16x16x32_bf16 v[16:19], v[64:67], a[108:111], v[16:19]
    v_mfma_f32_16x16x32_bf16 v[28:31], v[68:71], a[108:111], v[28:31]
    v_mfma_f32_16x16x32_bf16 v[40:43], v[72:75], a[108:111], v[40:43]
    v_mfma_f32_16x16x32_bf16 v[52:55], v[76:79], a[108:111], v[52:55]
    v_mfma_f32_16x16x32_bf16 v[20:23], v[64:67], a[112:115], v[20:23]
    v_mfma_f32_16x16x32_bf16 v[32:35], v[68:71], a[112:115], v[32:35]
    v_mfma_f32_16x16x32_bf16 v[44:47], v[72:75], a[112:115], v[44:47]
    v_mfma_f32_16x16x32_bf16 v[56:59], v[76:79], a[112:115], v[56:59]
    v_mfma_f32_16x16x32_bf16 v[24:27], v[64:67], a[116:119], v[24:27]
    v_mfma_f32_16x16x32_bf16 v[36:39], v[68:71], a[116:119], v[36:39]
    v_mfma_f32_16x16x32_bf16 v[48:51], v[72:75], a[116:119], v[48:51]
    v_mfma_f32_16x16x32_bf16 v[60:63], v[76:79], a[116:119], v[60:63]
    s_waitcnt vmcnt(0)
    v_cmp_ne_u32 vcc, s46, v10
    s_cbranch_vccz LoOK
    s_mov_b32 s61, 0x40000
    buffer_load_dword v10, v9, s[12:15], 0 offen sc1
    s_waitcnt vmcnt(0)
Lpoll7:
    v_cmp_ne_u32 vcc, s46, v10
    s_cbranch_vccz Lpoll7d
    s_mov_b64 exec, vcc
    s_sleep 6
    buffer_load_dword v10, v9, s[12:15], 0 offen sc1
    s_sub_u32 s61, s61, 1
    s_waitcnt vmcnt(0)
    s_cbranch_scc0 Lpoll7
Lpoll7d:
    s_mov_b64 exec, -1
LoOK:
    buffer_load_dwordx4 v[144:147], v240, s[12:15], s98 offen sc1
    buffer_load_dwordx4 v[148:151], v241, s[12:15], s98 offen sc1
    buffer_load_dwordx4 v[152:155], v242, s[12:15], s98 offen sc1
    buffer_load_dwordx4 v[156:159], v243, s[12:15], s98 offen sc1
    s_add_u32 s98, s98, 4096
    s_cmp_eq_u32 s98, s52
    s_cselect_b32 s98, s51, s98
    buffer_load_dword v5, v7, s[12:15], s95 offen sc1
    v_cvt_pk_bf16_f32 v208, v16, v17
    v_cvt_pk_bf16_f32 v209, v18, v19
    v_cvt_pk_bf16_f32 v210, v28, v29
    v_cvt_pk_bf16_f32 v211, v30, v31
    v_cvt_pk_bf16_f32 v212, v40, v41
    v_cvt_pk_bf16_f32 v213, v42, v43
    v_cvt_pk_bf16_f32 v214, v52, v53
    v_cvt_pk_bf16_f32 v215, v54, v55
    v_cvt_pk_bf16_f32 v216, v20, v21
    v_cvt_pk_bf16_f32 v217, v22, v23
    v_cvt_pk_bf16_f32 v218, v32, v33
    v_cvt_pk_bf16_f32 v219, v34, v35
    v_cvt_pk_bf16_f32 v220, v44, v45
    v_cvt_pk_bf16_f32 v221, v46, v47
    v_cvt_pk_bf16_f32 v222, v56, v57
    v_cvt_pk_bf16_f32 v223, v58, v59
    v_cvt_pk_bf16_f32 v224, v24, v25
    v_cvt_pk_bf16_f32 v225, v26, v27
    v_cvt_pk_bf16_f32 v226, v36, v37
    v_cvt_pk_bf16_f32 v227, v38, v39
    v_cvt_pk_bf16_f32 v228, v48, v49
    v_cvt_pk_bf16_f32 v229, v50, v51
    v_cvt_pk_bf16_f32 v230, v60, v61
    v_cvt_pk_bf16_f32 v231, v62, v63
    v_mfma_f32_16x16x32_bf16 v[96:99], v[208:211], a[160:163], 0
    v_mfma_f32_16x16x32_bf16 v[108:111], v[208:211], a[168:171], 0
    v_mfma_f32_16x16x32_bf16 v[120:123], v[208:211], a[176:179], 0
    v_mfma_f32_16x16x32_bf16 v[132:135], v[208:211], a[184:187], 0
    v_mfma_f32_16x16x32_bf16 v[96:99], v[212:215], a[164:167], v[96:99]
    v_mfma_f32_16x16x32_bf16 v[108:111], v[212:215], a[172:175], v[108:111]
    v_mfma_f32_16x16x32_bf16 v[120:123], v[212:215], a[180:183], v[120:123]
    v_mfma_f32_16x16x32_bf16 v[132:135], v[212:215], a[188:191], v[132:135]
    v_mfma_f32_16x16x32_bf16 v[100:103], v[216:219], a[160:163], 0
    v_mfma_f32_16x16x32_bf16 v[112:115], v[216:219], a[168:171], 0
    v_mfma_f32_16x16x32_bf16 v[124:127], v[216:219], a[176:179], 0
    v_mfma_f32_16x16x32_bf16 v[136:139], v[216:219], a[184:187], 0
    v_mfma_f32_16x16x32_bf16 v[100:103], v[220:223], a[164:167], v[100:103]
    v_mfma_f32_16x16x32_bf16 v[112:115], v[220:223], a[172:175], v[112:115]
    v_mfma_f32_16x16x32_bf16 v[124:127], v[220:223], a[180:183], v[124:127]
    v_mfma_f32_16x16x32_bf16 v[136:139], v[220:223], a[188:191], v[136:139]
    v_mfma_f32_16x16x32_bf16 v[104:107], v[224:227], a[160:163], 0
    v_mfma_f32_16x16x32_bf16 v[116:119], v[224:227], a[168:171], 0
    v_mfma_f32_16x16x32_bf16 v[128:131], v[224:227], a[176:179], 0
    v_mfma_f32_16x16x32_bf16 v[140:143], v[224:227], a[184:187], 0
    v_mfma_f32_16x16x32_bf16 v[104:107], v[228:231], a[164:167], v[104:107]
    v_mfma_f32_16x16x32_bf16 v[116:119], v[228:231], a[172:175], v[116:119]
    v_mfma_f32_16x16x32_bf16 v[128:131], v[228:231], a[180:183], v[128:131]
    v_mfma_f32_16x16x32_bf16 v[140:143], v[228:231], a[188:191], v[140:143]
    s_waitcnt vmcnt(1)
    v_mfma_f32_16x16x32_bf16 v[36:39], a[120:123], v[148:151], 0
    ds_write_b128 v249, v[96:99] offset:0
    v_mfma_f32_16x16x32_bf16 v[40:43], a[124:127], v[148:151], 0
    ds_write_b128 v249, v[108:111] offset:3072
    ds_write_b128 v249, v[120:123] offset:6144
    v_mfma_f32_16x16x32_bf16 v[44:47], a[128:131], v[148:151], 0
    ds_write_b128 v249, v[132:135] offset:9216
    v_mfma_f32_16x16x32_bf16 v[48:51], a[132:135], v[148:151], 0
    ds_write_b128 v249, v[100:103] offset:1024
    ds_write_b128 v249, v[112:115] offset:4096
    v_mfma_f32_16x16x32_bf16 v[52:55], a[136:139], v[148:151], 0
    ds_write_b128 v249, v[124:127] offset:7168
    v_mfma_f32_16x16x32_bf16 v[56:59], a[120:123], v[152:155], 0
    ds_write_b128 v249, v[136:139] offset:10240
    ds_write_b128 v249, v[104:107] offset:2048
    v_mfma_f32_16x16x32_bf16 v[60:63], a[124:127], v[152:155], 0
    ds_write_b128 v249, v[116:119] offset:5120
    v_mfma_f32_16x16x32_bf16 v[64:67], a[128:131], v[152:155], 0
    ds_write_b128 v249, v[128:131] offset:8192
    ds_write_b128 v249, v[140:143] offset:11264
    v_mfma_f32_16x16x32_bf16 v[68:71], a[132:135], v[152:155], 0
    ds_write_b128 v244, v[36:39] offset:0
    v_mfma_f32_16x16x32_bf16 v[72:75], a[136:139], v[152:155], 0
    ds_write_b128 v244, v[40:43] offset:1024
    v_mfma_f32_16x16x32_bf16 v[76:79], a[120:123], v[156:159], 0
    ds_write_b128 v244, v[44:47] offset:2048
    v_mfma_f32_16x16x32_bf16 v[80:83], a[124:127], v[156:159], 0
    ds_write_b128 v244, v[48:51] offset:3072
    v_mfma_f32_16x16x32_bf16 v[84:87], a[128:131], v[156:159], 0
    ds_write_b128 v244, v[52:55] offset:4096
    v_mfma_f32_16x16x32_bf16 v[88:91], a[132:135], v[156:159], 0
    ds_write_b128 v245, v[56:59] offset:0
    v_mfma_f32_16x16x32_bf16 v[92:95], a[136:139], v[156:159], 0
    ds_write_b128 v245, v[60:63] offset:1024
    v_mfma_f32_16x16x32_bf16 v[16:19], a[120:123], v[144:147], 0
    ds_write_b128 v245, v[64:67] offset:2048
    v_mfma_f32_16x16x32_bf16 v[20:23], a[124:127], v[144:147], 0
    ds_write_b128 v245, v[68:71] offset:3072
    v_mfma_f32_16x16x32_bf16 v[24:27], a[128:131], v[144:147], 0
    ds_write_b128 v245, v[72:75] offset:4096
    v_mfma_f32_16x16x32_bf16 v[28:31], a[132:135], v[144:147], 0
    ds_write_b128 v246, v[76:79] offset:0
    v_mfma_f32_16x16x32_bf16 v[32:35], a[136:139], v[144:147], 0
    ds_write_b128 v246, v[80:83] offset:1024
    s_branch Lp3t
Lp3b:
    s_mov_b32 s61, 0x40000
    buffer_load_dword v10, v9, s[12:15], 0 offen sc1
    s_waitcnt vmcnt(0)
Lpoll8:
    v_cmp_ne_u32 vcc, s46, v10
    s_cbranch_vccz Lpoll8d
    s_mov_b64 exec, vcc
    s_sleep 6
    buffer_load_dword v10, v9, s[12:15], 0 offen sc1
    s_sub_u32 s61, s61, 1
    s_waitcnt vmcnt(0)
    s_cbranch_scc0 Lpoll8
Lpoll8d:
    s_mov_b64 exec, -1
    s_mov_b32 s49, 0
    s_mov_b32 s61, 0x40000
    buffer_load_dwordx4 v[144:147], v240, s[12:15], s98 offen sc1
    buffer_load_dwordx4 v[148:151], v241, s[12:15], s98 offen sc1
    buffer_load_dwordx4 v[152:155], v242, s[12:15], s98 offen sc1
    buffer_load_dwordx4 v[156:159], v243, s[12:15], s98 offen sc1
    s_add_u32 s98, s98, 4096
    s_cmp_eq_u32 s98, s52
    s_cselect_b32 s98, s51, s98
    buffer_load_dwordx4 v[160:163], v240, s[12:15], s98 offen sc1
    buffer_load_dwordx4 v[164:167], v241, s[12:15], s98 offen sc1
    buffer_load_dwordx4 v[168:171], v242, s[12:15], s98 offen sc1
    buffer_load_dwordx4 v[172:175], v243, s[12:15], s98 offen sc1
    s_add_u32 s98, s98, 4096
    s_cmp_eq_u32 s98, s52
    s_cselect_b32 s98, s51, s98
    buffer_load_dwordx4 v[176:179], v240, s[12:15], s98 offen sc1
    buffer_load_dwordx4 v[180:183], v241, s[12:15], s98 offen sc1
    buffer_load_dwordx4 v[184:187], v242, s[12:15], s98 offen sc1
    buffer_load_dwordx4 v[188:191], v243, s[12:15], s98 offen sc1
    s_add_u32 s98, s98, 4096
    s_cmp_eq_u32 s98, s52
    s_cselect_b32 s98, s51, s98
    s_waitcnt vmcnt(8)
    v_mfma_f32_16x16x32_bf16 v[16:19], a[0:3], v[144:147], 0
    v_mfma_f32_16x16x32_bf16 v[36:39], a[0:3], v[148:151], 0
    v_mfma_f32_16x16x32_bf16 v[56:59], a[0:3], v[152:155], 0
    v_mfma_f32_16x16x32_bf16 v[76:79], a[0:3], v[156:159], 0
    v_mfma_f32_16x16x32_bf16 v[20:23], a[4:7], v[144:147], 0
    buffer_load_dwordx4 v[192:195], v240, s[12:15], s98 offen sc1
    v_mfma_f32_16x16x32_bf16 v[40:43], a[4:7], v[148:151], 0
    v_mfma_f32_16x16x32_bf16 v[60:63], a[4:7], v[152:155], 0
    v_mfma_f32_16x16x32_bf16 v[80:83], a[4:7], v[156:159], 0
    v_mfma_f32_16x16x32_bf16 v[24:27], a[8:11], v[144:147], 0
    buffer_load_dwordx4 v[196:199], v241, s[12:15], s98 offen sc1
    v_mfma_f32_16x16x32_bf16 v[44:47], a[8:11], v[148:151], 0
    v_mfma_f32_16x16x32_bf16 v[64:67], a[8:11], v[152:155], 0
    v_mfma_f32_16x16x32_bf16 v[84:87], a[8:11], v[156:159], 0
    v_mfma_f32_16x16x32_bf16 v[28:31], a[12:15], v[144:147], 0
    v_mfma_f32_16x16x32_bf16 v[48:51], a[12:15], v[148:151], 0
    buffer_load_dwordx4 v[200:203], v242, s[12:15], s98 offen sc1
    v_mfma_f32_16x16x32_bf16 v[68:71], a[12:15], v[152:155], 0
    v_mfma_f32_16x16x32_bf16 v[88:91], a[12:15], v[156:159], 0
    v_mfma_f32_16x16x32_bf16 v[32:35], a[16:19], v[144:147], 0
    v_mfma_f32_16x16x32_bf16 v[52:55], a[16:19], v[148:151], 0
    buffer_load_dwordx4 v[204:207], v243, s[12:15], s98 offen sc1
    s_add_u32 s98, s98, 4096
    s_cmp_eq_u32 s98, s52
    s_cselect_b32 s98, s51, s98
    v_mfma_f32_16x16x32_bf16 v[72:75], a[16:19], v[152:155], 0
    v_mfma_f32_16x16x32_bf16 v[92:95], a[16:19], v[156:159], 0
    s_waitcnt vmcnt(8)
    v_mfma_f32_16x16x32_bf16 v[16:19], a[20:23], v[160:163], v[16:19]
    v_mfma_f32_16x16x32_bf16 v[36:39], a[20:23], v[164:167], v[36:39]
    v_mfma_f32_16x16x32_bf16 v[56:59], a[20:23], v[168:171], v[56:59]
    v_mfma_f32_16x16x32_bf16 v[76:79], a[20:23], v[172:175], v[76:79]
    v_mfma_f32_16x16x32_bf16 v[20:23], a[24:27], v[160:163], v[20:23]
    buffer_load_dwordx4 v[208:211], v240, s[12:15], s98 offen sc1
    v_mfma_f32_16x16x32_bf16 v[40:43], a[24:27], v[164:167], v[40:43]
    v_mfma_f32_16x16x32_bf16 v[60:63], a[24:27], v[168:171], v[60:63]
    v_mfma_f32_16x16x32_bf16 v[80:83], a[24:27], v[172:175], v[80:83]
    v_mfma_f32_16x16x32_bf16 v[24:27], a[28:31], v[160:163], v[24:27]
    buffer_load_dwordx4 v[212:215], v241, s[12:15], s98 offen sc1
    v_mfma_f32_16x16x32_bf16 v[44:47], a[28:31], v[164:167], v[44:47]
    v_mfma_f32_16x16x32_bf16 v[64:67], a[28:31], v[168:171], v[64:67]
    v_mfma_f32_16x16x32_bf16 v[84:87], a[28:31], v[172:175], v[84:87]
    v_mfma_f32_16x16x32_bf16 v[28:31], a[32:35], v[160:163], v[28:31]
    v_mfma_f32_16x16x32_bf16 v[48:51], a[32:35], v[164:167], v[48:51]
    buffer_load_dwordx4 v[216:219], v242, s[12:15], s98 offen sc1
    v_mfma_f32_16x16x32_bf16 v[68:71], a[32:35], v[168:171], v[68:71]
    v_mfma_f32_16x16x32_bf16 v[88:91], a[32:35], v[172:175], v[88:91]
    v_mfma_f32_16x16x32_bf16 v[32:35], a[36:39], v[160:163], v[32:35]
    v_mfma_f32_16x16x32_bf16 v[52:55], a[36:39], v[164:167], v[52:55]
    buffer_load_dwordx4 v[220:223], v243, s[12:15], s98 offen sc1
    s_add_u32 s98, s98, 4096
    s_cmp_eq_u32 s98, s52
    s_cselect_b32 s98, s51, s98
    v_mfma_f32_16x16x32_bf16 v[72:75], a[36:39], v[168:171], v[72:75]
    v_mfma_f32_16x16x32_bf16 v[92:95], a[36:39], v[172:175], v[92:95]
    s_waitcnt vmcnt(8)
    v_mfma_f32_16x16x32_bf16 v[16:19], a[40:43], v[176:179], v[16:19]
    v_mfma_f32_16x16x32_bf16 v[36:39], a[40:43], v[180:183], v[36:39]
    v_mfma_f32_16x16x32_bf16 v[56:59], a[40:43], v[184:187], v[56:59]
    v_mfma_f32_16x16x32_bf16 v[76:79], a[40:43], v[188:191], v[76:79]
    v_mfma_f32_16x16x32_bf16 v[20:23], a[44:47], v[176:179], v[20:23]
    buffer_load_dwordx4 v[144:147], v240, s[12:15], s98 offen sc1
    v_mfma_f32_16x16x32_bf16 v[40:43], a[44:47], v[180:183], v[40:43]
    v_mfma_f32_16x16x32_bf16 v[60:63], a[44:47], v[184:187], v[60:63]
    v_mfma_f32_16x16x32_bf16 v[80:83], a[44:47], v[188:191], v[80:83]
    v_mfma_f32_16x16x32_bf16 v[24:27], a[48:51], v[176:179], v[24:27]
    buffer_load_dwordx4 v[148:151], v241, s[12:15], s98 offen sc1
    v_mfma_f32_16x16x32_bf16 v[44:47], a[48:51], v[180:183], v[44:47]
    v_mfma_f32_16x16x32_bf16 v[64:67], a[48:51], v[184:187], v[64:67]
    v_mfma_f32_16x16x32_bf16 v[84:87], a[48:51], v[188:191], v[84:87]
    v_mfma_f32_16x16x32_bf16 v[28:31], a[52:55], v[176:179], v[28:31]
    v_mfma_f32_16x16x32_bf16 v[48:51], a[52:55], v[180:183], v[48:51]
    buffer_load_dwordx4 v[152:155], v242, s[12:15], s98 offen sc1
    v_mfma_f32_16x16x32_bf16 v[68:71], a[52:55], v[184:187], v[68:71]
    v_mfma_f32_16x16x32_bf16 v[88:91], a[52:55], v[188:191], v[88:91]
    v_mfma_f32_16x16x32_bf16 v[32:35], a[56:59], v[176:179], v[32:35]
    v_mfma_f32_16x16x32_bf16 v[52:55], a[56:59], v[180:183], v[52:55]
    buffer_load_dwordx4 v[156:159], v243, s[12:15], s98 offen sc1
    s_add_u32 s98, s98, 4096
    s_cmp_eq_u32 s98, s52
    s_cselect_b32 s98, s51, s98
    v_mfma_f32_16x16x32_bf16 v[72:75], a[56:59], v[184:187], v[72:75]
    v_mfma_f32_16x16x32_bf16 v[92:95], a[56:59], v[188:191], v[92:95]
    s_waitcnt vmcnt(8)
    v_mfma_f32_16x16x32_bf16 v[16:19], a[60:63], v[192:195], v[16:19]
    v_mfma_f32_16x16x32_bf16 v[36:39], a[60:63], v[196:199], v[36:39]
    v_mfma_f32_16x16x32_bf16 v[56:59], a[60:63], v[200:203], v[56:59]
    v_mfma_f32_16x16x32_bf16 v[76:79], a[60:63], v[204:207], v[76:79]
    v_mfma_f32_16x16x32_bf16 v[20:23], a[64:67], v[192:195], v[20:23]
    buffer_load_dwordx4 v[160:163], v240, s[12:15], s98 offen sc1
    v_mfma_f32_16x16x32_bf16 v[40:43], a[64:67], v[196:199], v[40:43]
    v_mfma_f32_16x16x32_bf16 v[60:63], a[64:67], v[200:203], v[60:63]
    v_mfma_f32_16x16x32_bf16 v[80:83], a[64:67], v[204:207], v[80:83]
    v_mfma_f32_16x16x32_bf16 v[24:27], a[68:71], v[192:195], v[24:27]
    buffer_load_dwordx4 v[164:167], v241, s[12:15], s98 offen sc1
    v_mfma_f32_16x16x32_bf16 v[44:47], a[68:71], v[196:199], v[44:47]
    v_mfma_f32_16x16x32_bf16 v[64:67], a[68:71], v[200:203], v[64:67]
    v_mfma_f32_16x16x32_bf16 v[84:87], a[68:71], v[204:207], v[84:87]
    v_mfma_f32_16x16x32_bf16 v[28:31], a[72:75], v[192:195], v[28:31]
    v_mfma_f32_16x16x32_bf16 v[48:51], a[72:75], v[196:199], v[48:51]
    buffer_load_dwordx4 v[168:171], v242, s[12:15], s98 offen sc1
    v_mfma_f32_16x16x32_bf16 v[68:71], a[72:75], v[200:203], v[68:71]
    v_mfma_f32_16x16x32_bf16 v[88:91], a[72:75], v[204:207], v[88:91]
    v_mfma_f32_16x16x32_bf16 v[32:35], a[76:79], v[192:195], v[32:35]
    v_mfma_f32_16x16x32_bf16 v[52:55], a[76:79], v[196:199], v[52:55]
    buffer_load_dwordx4 v[172:175], v243, s[12:15], s98 offen sc1
    s_add_u32 s98, s98, 4096
    s_cmp_eq_u32 s98, s52
    s_cselect_b32 s98, s51, s98
    v_mfma_f32_16x16x32_bf16 v[72:75], a[76:79], v[200:203], v[72:75]
    v_mfma_f32_16x16x32_bf16 v[92:95], a[76:79], v[204:207], v[92:95]
    s_waitcnt vmcnt(8)
    v_mfma_f32_16x16x32_bf16 v[16:19], a[80:83], v[208:211], v[16:19]
    v_mfma_f32_16x16x32_bf16 v[36:39], a[80:83], v[212:215], v[36:39]
    v_mfma_f32_16x16x32_bf16 v[56:59], a[80:83], v[216:219], v[56:59]
    v_mfma_f32_16x16x32_bf16 v[76:79], a[80:83], v[220:223], v[76:79]
    v_mfma_f32_16x16x32_bf16 v[20:23], a[84:87], v[208:211], v[20:23]
    buffer_load_dwordx4 v[176:179], v240, s[12:15], s98 offen sc1
    v_mfma_f32_16x16x32_bf16 v[40:43], a[84:87], v[212:215], v[40:43]
    v_mfma_f32_16x16x32_bf16 v[60:63], a[84:87], v[216:219], v[60:63]
    v_mfma_f32_16x16x32_bf16 v[80:83], a[84:87], v[220:223], v[80:83]
    v_mfma_f32_16x16x32_bf16 v[24:27], a[88:91], v[208:211], v[24:27]
    buffer_load_dwordx4 v[180:183], v241, s[12:15], s98 offen sc1
    v_mfma_f32_16x16x32_bf16 v[44:47], a[88:91], v[212:215], v[44:47]
    v_mfma_f32_16x16x32_bf16 v[64:67], a[88:91], v[216:219], v[64:67]
    v_mfma_f32_16x16x32_bf16 v[84:87], a[88:91], v[220:223], v[84:87]
    v_mfma_f32_16x16x32_bf16 v[28:31], a[92:95], v[208:211], v[28:31]
    v_mfma_f32_16x16x32_bf16 v[48:51], a[92:95], v[212:215], v[48:51]
    buffer_load_dwordx4 v[184:187], v242, s[12:15], s98 offen sc1
    v_mfma_f32_16x16x32_bf16 v[68:71], a[92:95], v[216:219], v[68:71]
    v_mfma_f32_16x16x32_bf16 v[88:91], a[92:95], v[220:223], v[88:91]
    v_mfma_f32_16x16x32_bf16 v[32:35], a[96:99], v[208:211], v[32:35]
    v_mfma_f32_16x16x32_bf16 v[52:55], a[96:99], v[212:215], v[52:55]
    buffer_load_dwordx4 v[188:191], v243, s[12:15], s98 offen sc1
    s_add_u32 s98, s98, 4096
    s_cmp_eq_u32 s98, s52
    s_cselect_b32 s98, s51, s98
    v_mfma_f32_16x16x32_bf16 v[72:75], a[96:99], v[216:219], v[72:75]
    v_mfma_f32_16x16x32_bf16 v[92:95], a[96:99], v[220:223], v[92:95]
    s_waitcnt vmcnt(8)
    v_mfma_f32_16x16x32_bf16 v[16:19], a[100:103], v[144:147], v[16:19]
    v_mfma_f32_16x16x32_bf16 v[36:39], a[100:103], v[148:151], v[36:39]
    v_mfma_f32_16x16x32_bf16 v[56:59], a[100:103], v[152:155], v[56:59]
    v_mfma_f32_16x16x32_bf16 v[76:79], a[100:103], v[156:159], v[76:79]
    v_mfma_f32_16x16x32_bf16 v[20:23], a[104:107], v[144:147], v[20:23]
    buffer_load_dwordx4 v[192:195], v240, s[12:15], s98 offen sc1
    v_mfma_f32_16x16x32_bf16 v[40:43], a[104:107], v[148:151], v[40:43]
    v_mfma_f32_16x16x32_bf16 v[60:63], a[104:107], v[152:155], v[60:63]
    v_mfma_f32_16x16x32_bf16 v[80:83], a[104:107], v[156:159], v[80:83]
    v_mfma_f32_16x16x32_bf16 v[24:27], a[108:111], v[144:147], v[24:27]
    buffer_load_dwordx4 v[196:199], v241, s[12:15], s98 offen sc1
    v_mfma_f32_16x16x32_bf16 v[44:47], a[108:111], v[148:151], v[44:47]
    v_mfma_f32_16x16x32_bf16 v[64:67], a[108:111], v[152:155], v[64:67]
    v_mfma_f32_16x16x32_bf16 v[84:87], a[108:111], v[156:159], v[84:87]
    v_mfma_f32_16x16x32_bf16 v[28:31], a[112:115], v[144:147], v[28:31]
    v_mfma_f32_16x16x32_bf16 v[48:51], a[112:115], v[148:151], v[48:51]
    buffer_load_dwordx4 v[200:203], v242, s[12:15], s98 offen sc1
    v_mfma_f32_16x16x32_bf16 v[68:71], a[112:115], v[152:155], v[68:71]
    v_mfma_f32_16x16x32_bf16 v[88:91], a[112:115], v[156:159], v[88:91]
    v_mfma_f32_16x16x32_bf16 v[32:35], a[116:119], v[144:147], v[32:35]
    v_mfma_f32_16x16x32_bf16 v[52:55], a[116:119], v[148:151], v[52:55]
    buffer_load_dwordx4 v[204:207], v243, s[12:15], s98 offen sc1
    s_add_u32 s98, s98, 4096
    s_cmp_eq_u32 s98, s52
    s_cselect_b32 s98, s51, s98
    v_mfma_f32_16x16x32_bf16 v[72:75], a[116:119], v[152:155], v[72:75]
    v_mfma_f32_16x16x32_bf16 v[92:95], a[116:119], v[156:159], v[92:95]
    s_waitcnt vmcnt(8)
    v_mfma_f32_16x16x32_bf16 v[16:19], a[120:123], v[160:163], v[16:19]
    v_mfma_f32_16x16x32_bf16 v[36:39], a[120:123], v[164:167], v[36:39]
    v_mfma_f32_16x16x32_bf16 v[56:59], a[120:123], v[168:171], v[56:59]
    v_mfma_f32_16x16x32_bf16 v[76:79], a[120:123], v[172:175], v[76:79]
    v_mfma_f32_16x16x32_bf16 v[20:23], a[124:127], v[160:163], v[20:23]
    v_mfma_f32_16x16x32_bf16 v[40:43], a[124:127], v[164:167], v[40:43]
    v_mfma_f32_16x16x32_bf16 v[60:63], a[124:127], v[168:171], v[60:63]
    v_mfma_f32_16x16x32_bf16 v[80:83], a[124:127], v[172:175], v[80:83]
    v_mfma_f32_16x16x32_bf16 v[24:27], a[128:131], v[160:163], v[24:27]
    v_mfma_f32_16x16x32_bf16 v[44:47], a[128:131], v[164:167], v[44:47]
    v_mfma_f32_16x16x32_bf16 v[64:67], a[128:131], v[168:171], v[64:67]
    v_mfma_f32_16x16x32_bf16 v[84:87], a[128:131], v[172:175], v[84:87]
    v_mfma_f32_16x16x32_bf16 v[28:31], a[132:135], v[160:163], v[28:31]
    v_mfma_f32_16x16x32_bf16 v[48:51], a[132:135], v[164:167], v[48:51]
    v_mfma_f32_16x16x32_bf16 v[68:71], a[132:135], v[168:171], v[68:71]
    v_mfma_f32_16x16x32_bf16 v[88:91], a[132:135], v[172:175], v[88:91]
    v_mfma_f32_16x16x32_bf16 v[32:35], a[136:139], v[160:163], v[32:35]
    v_mfma_f32_16x16x32_bf16 v[52:55], a[136:139], v[164:167], v[52:55]
    buffer_load_dword v5, v7, s[12:15], s95 offen sc1
    v_mfma_f32_16x16x32_bf16 v[72:75], a[136:139], v[168:171], v[72:75]
    v_mfma_f32_16x16x32_bf16 v[92:95], a[136:139], v[172:175], v[92:95]
    s_waitcnt vmcnt(5)
    v_mfma_f32_16x16x32_bf16 v[16:19], a[140:143], v[176:179], v[16:19]
    v_mfma_f32_16x16x32_bf16 v[36:39], a[140:143], v[180:183], v[36:39]
    v_mfma_f32_16x16x32_bf16 v[56:59], a[140:143], v[184:187], v[56:59]
    v_mfma_f32_16x16x32_bf16 v[76:79], a[140:143], v[188:191], v[76:79]
    v_mfma_f32_16x16x32_bf16 v[20:23], a[144:147], v[176:179], v[20:23]
    v_mfma_f32_16x16x32_bf16 v[40:43], a[144:147], v[180:183], v[40:43]
    v_mfma_f32_16x16x32_bf16 v[60:63], a[144:147], v[184:187], v[60:63]
    v_mfma_f32_16x16x32_bf16 v[80:83], a[144:147], v[188:191], v[80:83]
    v_mfma_f32_16x16x32_bf16 v[24:27], a[148:151], v[176:179], v[24:27]
    v_mfma_f32_16x16x32_bf16 v[44:47], a[148:151], v[180:183], v[44:47]
    v_mfma_f32_16x16x32_bf16 v[64:67], a[148:151], v[184:187], v[64:67]
    v_mfma_f32_16x16x32_bf16 v[84:87], a[148:151], v[188:191], v[84:87]
    v_mfma_f32_16x16x32_bf16 v[28:31], a[152:155], v[176:179], v[28:31]
    v_mfma_f32_16x16x32_bf16 v[48:51], a[152:155], v[180:183], v[48:51]
    v_mfma_f32_16x16x32_bf16 v[68:71], a[152:155], v[184:187], v[68:71]
    v_mfma_f32_16x16x32_bf16 v[88:91], a[152:155], v[188:191], v[88:91]
    v_mfma_f32_16x16x32_bf16 v[32:35], a[156:159], v[176:179], v[32:35]
    v_mfma_f32_16x16x32_bf16 v[52:55], a[156:159], v[180:183], v[52:55]
    v_mfma_f32_16x16x32_bf16 v[72:75], a[156:159], v[184:187], v[72:75]
    v_mfma_f32_16x16x32_bf16 v[92:95], a[156:159], v[188:191], v[92:95]
    s_waitcnt vmcnt(1)
    v_mfma_f32_16x16x32_bf16 v[36:39], a[160:163], v[196:199], v[36:39]
    v_mfma_f32_16x16x32_bf16 v[40:43], a[164:167], v[196:199], v[40:43]
    v_mfma_f32_16x16x32_bf16 v[44:47], a[168:171], v[196:199], v[44:47]
    v_mfma_f32_16x16x32_bf16 v[48:51], a[172:175], v[196:199], v[48:51]
    v_mfma_f32_16x16x32_bf16 v[52:55], a[176:179], v[196:199], v[52:55]
    v_mfma_f32_16x16x32_bf16 v[56:59], a[160:163], v[200:203], v[56:59]
    v_mfma_f32_16x16x32_bf16 v[60:63], a[164:167], v[200:203], v[60:63]
    v_mfma_f32_16x16x32_bf16 v[64:67], a[168:171], v[200:203], v[64:67]
    v_mfma_f32_16x16x32_bf16 v[68:71], a[172:175], v[200:203], v[68:71]
    ds_write_b128 v244, v[36:39] offset:0
    v_mfma_f32_16x16x32_bf16 v[72:75], a[176:179], v[200:203], v[72:75]
    ds_write_b128 v244, v[40:43] offset:1024
    v_mfma_f32_16x16x32_bf16 v[76:79], a[160:163], v[204:207], v[76:79]
    ds_write_b128 v244, v[44:47] offset:2048
    v_mfma_f32_16x16x32_bf16 v[80:83], a[164:167], v[204:207], v[80:83]
    ds_write_b128 v244, v[48:51] offset:3072
    v_mfma_f32_16x16x32_bf16 v[84:87], a[168:171], v[204:207], v[84:87]
    ds_write_b128 v244, v[52:55] offset:4096
    v_mfma_f32_16x16x32_bf16 v[88:91], a[172:175], v[204:207], v[88:91]
    ds_write_b128 v245, v[56:59] offset:0
    v_mfma_f32_16x16x32_bf16 v[92:95], a[176:179], v[204:207], v[92:95]
    ds_write_b128 v245, v[60:63] offset:1024
    v_mfma_f32_16x16x32_bf16 v[16:19], a[160:163], v[192:195], v[16:19]
    ds_write_b128 v245, v[64:67] offset:2048
    v_mfma_f32_16x16x32_bf16 v[20:23], a[164:167], v[192:195], v[20:23]
    ds_write_b128 v245, v[68:71] offset:3072
    v_mfma_f32_16x16x32_bf16 v[24:27], a[168:171], v[192:195], v[24:27]
    ds_write_b128 v245, v[72:75] offset:4096
    v_mfma_f32_16x16x32_bf16 v[28:31], a[172:175], v[192:195], v[28:31]
    ds_write_b128 v246, v[76:79] offset:0
    v_mfma_f32_16x16x32_bf16 v[32:35], a[176:179], v[192:195], v[32:35]
    ds_write_b128 v246, v[80:83] offset:1024
Lp3t:
    s_nop 7
    ds_write_b128 v246, v[84:87] offset:2048
    ds_write_b128 v246, v[88:91] offset:3072
    ds_write_b128 v246, v[92:95] offset:4096
    s_waitcnt vmcnt(0)
    v_sub_f32 v11, 1.0, v5
    v_cvt_pk_bf16_f32 v11, v11, v11
    v_and_b32 v11, 0xffff0000, v11
    v_mul_f32 v10, 0x35cccccd, v5
    s_waitcnt lgkmcnt(0)
    s_barrier
    ds_read_b128 v[160:163], v248 offset:0
    ds_read_b128 v[164:167], v248 offset:12288
    ds_read_b128 v[168:171], v248 offset:1024
    ds_read_b128 v[172:175], v248 offset:13312
    ds_read_b128 v[176:179], v248 offset:2048
    ds_read_b128 v[180:183], v248 offset:14336
    ds_read_b128 v[96:99], v247 offset:0
    ds_read_b128 v[100:103], v247 offset:5120
    ds_read_b128 v[104:107], v247 offset:10240
    ds_read_b128 v[108:111], v247 offset:1024
    ds_read_b128 v[112:115], v247 offset:6144
    ds_read_b128 v[116:119], v247 offset:11264
    ds_read_b128 v[120:123], v247 offset:2048
    ds_read_b128 v[124:127], v247 offset:7168
    ds_read_b128 v[128:131], v247 offset:12288
    s_waitcnt lgkmcnt(9)
    ds_read_b128 v[132:135], v247 offset:3072
    ds_read_b128 v[136:139], v247 offset:8192
    ds_read_b128 v[140:143], v247 offset:13312
    ds_read_b128 v[144:147], v247 offset:4096
    ds_read_b128 v[148:151], v247 offset:9216
    ds_read_b128 v[152:155], v247 offset:14336
    v_pk_add_f32 v[40:41], v[160:161], v[164:165]
    v_pk_mul_f32 v[40:41], v[40:41], v[10:11] op_sel_hi:[1,0]
    v_pk_add_f32 v[42:43], v[162:163], v[166:167]
    v_pk_mul_f32 v[42:43], v[42:43], v[10:11] op_sel_hi:[1,0]
    v_pk_add_f32 v[44:45], v[168:169], v[172:173]
    v_pk_mul_f32 v[44:45], v[44:45], v[10:11] op_sel_hi:[1,0]
    v_pk_add_f32 v[46:47], v[170:171], v[174:175]
    v_pk_mul_f32 v[46:47], v[46:47], v[10:11] op_sel_hi:[1,0]
    v_pk_add_f32 v[48:49], v[160:161], v[164:165] neg_lo:[0,1] neg_hi:[0,1]
    v_pk_mul_f32 v[48:49], v[48:49], v[10:11] op_sel_hi:[1,0]
    v_pk_add_f32 v[50:51], v[162:163], v[166:167] neg_lo:[0,1] neg_hi:[0,1]
    v_pk_mul_f32 v[50:51], v[50:51], v[10:11] op_sel_hi:[1,0]
    v_pk_add_f32 v[52:53], v[168:169], v[172:173] neg_lo:[0,1] neg_hi:[0,1]
    v_pk_mul_f32 v[52:53], v[52:53], v[10:11] op_sel_hi:[1,0]
    v_pk_add_f32 v[54:55], v[170:171], v[174:175] neg_lo:[0,1] neg_hi:[0,1]
    v_pk_mul_f32 v[54:55], v[54:55], v[10:11] op_sel_hi:[1,0]
    v_pk_fma_f32 v[56:57], v[180:181], v[14:15], v[176:177] op_sel_hi:[1,0,1]
    v_pk_mul_f32 v[56:57], v[56:57], v[10:11] op_sel_hi:[1,0]
    v_pk_fma_f32 v[58:59], v[182:183], v[14:15], v[178:179] op_sel_hi:[1,0,1]
    v_pk_mul_f32 v[58:59], v[58:59], v[10:11] op_sel_hi:[1,0]
    s_waitcnt lgkmcnt(12)
    v_pk_add_f32 v[96:97], v[96:97], v[100:101]
    v_pk_add_f32 v[16:17], v[16:17], v[104:105]
    v_pk_add_f32 v[96:97], v[96:97], v[16:17]
    v_pk_fma_f32 v[40:41], v[96:97], v[10:11], v[40:41] op_sel:[0,1,0]
    v_pk_add_f32 v[98:99], v[98:99], v[102:103]
    v_pk_add_f32 v[18:19], v[18:19], v[106:107]
    v_pk_add_f32 v[98:99], v[98:99], v[18:19]
    v_pk_fma_f32 v[42:43], v[98:99], v[10:11], v[42:43] op_sel:[0,1,0]
    v_cvt_pk_bf16_f32 v40, v40, v41
    v_cvt_pk_bf16_f32 v41, v42, v43
    ds_write_b64 v250, v[40:41] offset:0
    s_waitcnt lgkmcnt(10)
    v_pk_add_f32 v[108:109], v[108:109], v[112:113]
    v_pk_add_f32 v[20:21], v[20:21], v[116:117]
    v_pk_add_f32 v[108:109], v[108:109], v[20:21]
    v_pk_fma_f32 v[44:45], v[108:109], v[10:11], v[44:45] op_sel:[0,1,0]
    v_pk_add_f32 v[110:111], v[110:111], v[114:115]
    v_pk_add_f32 v[22:23], v[22:23], v[118:119]
    v_pk_add_f32 v[110:111], v[110:111], v[22:23]
    v_pk_fma_f32 v[46:47], v[110:111], v[10:11], v[46:47] op_sel:[0,1,0]
    v_cvt_pk_bf16_f32 v44, v44, v45
    v_cvt_pk_bf16_f32 v45, v46, v47
    ds_write_b64 v250, v[44:45] offset:32
    s_waitcnt lgkmcnt(8)
    v_pk_add_f32 v[120:121], v[120:121], v[124:125]
    v_pk_add_f32 v[24:25], v[24:25], v[128:129]
    v_pk_add_f32 v[120:121], v[120:121], v[24:25]
    v_pk_fma_f32 v[48:49], v[120:121], v[10:11], v[48:49] op_sel:[0,1,0]
    v_pk_add_f32 v[122:123], v[122:123], v[126:127]
    v_pk_add_f32 v[26:27], v[26:27], v[130:131]
    v_pk_add_f32 v[122:123], v[122:123], v[26:27]
    v_pk_fma_f32 v[50:51], v[122:123], v[10:11], v[50:51] op_sel:[0,1,0]
    v_cvt_pk_bf16_f32 v48, v48, v49
    v_cvt_pk_bf16_f32 v49, v50, v51
    ds_write_b64 v250, v[48:49] offset:80
    s_waitcnt lgkmcnt(6)
    v_pk_add_f32 v[132:133], v[132:133], v[136:137]
    v_pk_add_f32 v[28:29], v[28:29], v[140:141]
    v_pk_add_f32 v[132:133], v[132:133], v[28:29]
    v_pk_fma_f32 v[52:53], v[132:133], v[10:11], v[52:53] op_sel:[0,1,0]
    v_pk_add_f32 v[134:135], v[134:135], v[138:139]
    v_pk_add_f32 v[30:31], v[30:31], v[142:143]
    v_pk_add_f32 v[134:135], v[134:135], v[30:31]
    v_pk_fma_f32 v[54:55], v[134:135], v[10:11], v[54:55] op_sel:[0,1,0]
    v_cvt_pk_bf16_f32 v52, v52, v53
    v_cvt_pk_bf16_f32 v53, v54, v55
    ds_write_b64 v250, v[52:53] offset:112
    s_waitcnt lgkmcnt(4)
    v_pk_add_f32 v[144:145], v[144:145], v[148:149]
    v_pk_add_f32 v[32:33], v[32:33], v[152:153]
    v_pk_add_f32 v[144:145], v[144:145], v[32:33]
    v_pk_fma_f32 v[56:57], v[144:145], v[10:11], v[56:57] op_sel:[0,1,0]
    v_pk_add_f32 v[146:147], v[146:147], v[150:151]
    v_pk_add_f32 v[34:35], v[34:35], v[154:155]
    v_pk_add_f32 v[146:147], v[146:147], v[34:35]
    v_pk_fma_f32 v[58:59], v[146:147], v[10:11], v[58:59] op_sel:[0,1,0]
    v_cvt_pk_bf16_f32 v56, v56, v57
    v_cvt_pk_bf16_f32 v57, v58, v59
    ds_write_b64 v251, v[56:57] offset:64
    s_waitcnt lgkmcnt(0)
    ds_read_b128 v[64:67], v252 offset:0
    ds_read_b128 v[68:71], v252 offset:1024
    ds_read_b128 v[72:75], v252 offset:2048
    s_waitcnt lgkmcnt(2)
    buffer_store_dwordx4 v[64:67], v253, s[32:35], s94 offen
    s_waitcnt lgkmcnt(1)
    buffer_store_dwordx4 v[68:71], v254, s[32:35], s94 offen
    s_waitcnt lgkmcnt(0)
    buffer_store_dwordx4 v[72:75], v255, s[32:35], s94 offen
    s_or_b32 s62, s2, s40
    s_cmp_eq_u32 s62, 0
    s_cbranch_scc0 Lnoe
    v_mov_b32 v15, 9207808
    v_mov_b32 v14, s46
    s_mov_b64 exec, 1
    buffer_store_dword v14, v15, s[12:15], 0 offen sc1
    s_mov_b64 exec, -1
Lnoe:
Lend:
    s_endpgm
Lfin:
.section .rodata,"a"
.p2align 6
.amdhsa_kernel gated_mix__spectral_gfnet__linear_attn_block__prompt_kernel
  .amdhsa_next_free_vgpr 512
  .amdhsa_next_free_sgpr 102
  .amdhsa_accum_offset 256
  .amdhsa_group_segment_fixed_size 0
  .amdhsa_kernarg_size 80
  .amdhsa_user_sgpr_count 2
  .amdhsa_user_sgpr_kernarg_segment_ptr 1
  .amdhsa_system_sgpr_workgroup_id_x 1
.end_amdhsa_kernel
.set cA0,16256
.set cA1,16256
.set cA2,16256
.set cA3,16256
.set cA4,16256
.set cA5,16256
.set cA6,16256
.set cA7,16255
.set cA8,16255
.set cA9,16255
.set cA10,16255
.set cA11,16255
.set cA12,16254
.set cA13,16254
.set cA14,16254
.set cA15,16253
.set cA16,16253
.set cA17,16252
.set cA18,16252
.set cA19,16252
.set cA20,16251
.set cA21,16251
.set cA22,16250
.set cA23,16250
.set cA24,16249
.set cA25,16248
.set cA26,16248
.set cA27,16247
.set cA28,16246
.set cA29,16246
.set cA30,16245
.set cA31,16244
.set cA32,16243
.set cA33,16243
.set cA34,16242
.set cA35,16241
.set cA36,16240
.set cA37,16239
.set cA38,16238
.set cA39,16237
.set cA40,16237
.set cA41,16236
.set cA42,16235
.set cA43,16234
.set cA44,16232
.set cA45,16231
.set cA46,16230
.set cA47,16229
.set cA48,16228
.set cA49,16227
.set cA50,16226
.set cA51,16225
.set cA52,16223
.set cA53,16222
.set cA54,16221
.set cA55,16220
.set cA56,16218
.set cA57,16217
.set cA58,16216
.set cA59,16214
.set cA60,16213
.set cA61,16211
.set cA62,16210
.set cA63,16209
.set cA64,16207
.set cA65,16206
.set cA66,16204
.set cA67,16203
.set cA68,16201
.set cA69,16199
.set cA70,16198
.set cA71,16196
.set cA72,16195
.set cA73,16193
.set cA74,16191
.set cA75,16190
.set cA76,16188
.set cA77,16186
.set cA78,16185
.set cA79,16183
.set cA80,16181
.set cA81,16179
.set cA82,16177
.set cA83,16176
.set cA84,16174
.set cA85,16172
.set cA86,16170
.set cA87,16168
.set cA88,16166
.set cA89,16164
.set cA90,16162
.set cA91,16160
.set cA92,16158
.set cA93,16157
.set cA94,16155
.set cA95,16152
.set cA96,16150
.set cA97,16148
.set cA98,16146
.set cA99,16144
.set cA100,16142
.set cA101,16140
.set cA102,16138
.set cA103,16136
.set cA104,16134
.set cA105,16132
.set cA106,16129
.set cA107,16127
.set cA108,16122
.set cA109,16118
.set cA110,16113
.set cA111,16109
.set cA112,16104
.set cA113,16100
.set cA114,16095
.set cA115,16091
.set cA116,16086
.set cA117,16082
.set cA118,16077
.set cA119,16073
.set cA120,16068
.set cA121,16063
.set cA122,16059
.set cA123,16054
.set cA124,16049
.set cA125,16044
.set cA126,16040
.set cA127,16035
.set cA128,16030
.set cA129,16025
.set cA130,16021
.set cA131,16016
.set cA132,16011
.set cA133,16006
.set cA134,16001
.set cA135,15993
.set cA136,15983
.set cA137,15973
.set cA138,15963
.set cA139,15954
.set cA140,15944
.set cA141,15934
.set cA142,15924
.set cA143,15914
.set cA144,15904
.set cA145,15894
.set cA146,15884
.set cA147,15874
.set cA148,15857
.set cA149,15837
.set cA150,15817
.set cA151,15797
.set cA152,15777
.set cA153,15757
.set cA154,15729
.set cA155,15689
.set cA156,15649
.set cA157,15601
.set cA158,15521
.set cA159,15393
.set cA160,0
.set cA161,48161
.set cA162,48289
.set cA163,48369
.set cA164,48417
.set cA165,48457
.set cA166,48497
.set cA167,48525
.set cA168,48545
.set cA169,48565
.set cA170,48585
.set cA171,48605
.set cA172,48625
.set cA173,48642
.set cA174,48652
.set cA175,48662
.set cA176,48672
.set cA177,48682
.set cA178,48692
.set cA179,48702
.set cA180,48712
.set cA181,48722
.set cA182,48731
.set cA183,48741
.set cA184,48751
.set cA185,48761
.set cA186,48769
.set cA187,48774
.set cA188,48779
.set cA189,48784
.set cA190,48789
.set cA191,48793
.set cA192,48798
.set cA193,48803
.set cA194,48808
.set cA195,48812
.set cA196,48817
.set cA197,48822
.set cA198,48827
.set cA199,48831
.set cA200,48836
.set cA201,48841
.set cA202,48845
.set cA203,48850
.set cA204,48854
.set cA205,48859
.set cA206,48863
.set cA207,48868
.set cA208,48872
.set cA209,48877
.set cA210,48881
.set cA211,48886
.set cA212,48890
.set cA213,48895
.set cA214,48897
.set cA215,48900
.set cA216,48902
.set cA217,48904
.set cA218,48906
.set cA219,48908
.set cA220,48910
.set cA221,48912
.set cA222,48914
.set cA223,48916
.set cA224,48918
.set cA225,48920
.set cA226,48923
.set cA227,48925
.set cA228,48926
.set cA229,48928
.set cA230,48930
.set cA231,48932
.set cA232,48934
.set cA233,48936
.set cA234,48938
.set cA235,48940
.set cA236,48942
.set cA237,48944
.set cA238,48945
.set cA239,48947
.set cA240,48949
.set cA241,48951
.set cA242,48953
.set cA243,48954
.set cA244,48956
.set cA245,48958
.set cA246,48959
.set cA247,48961
.set cA248,48963
.set cA249,48964
.set cA250,48966
.set cA251,48967
.set cA252,48969
.set cA253,48971
.set cA254,48972
.set cA255,48974
.set cA256,48975
.set cA257,48977
.set cA258,48978
.set cA259,48979
.set cA260,48981
.set cA261,48982
.set cA262,48984
.set cA263,48985
.set cA264,48986
.set cA265,48988
.set cA266,48989
.set cA267,48990
.set cA268,48991
.set cA269,48993
.set cA270,48994
.set cA271,48995
.set cA272,48996
.set cA273,48997
.set cA274,48998
.set cA275,48999
.set cA276,49000
.set cA277,49002
.set cA278,49003
.set cA279,49004
.set cA280,49005
.set cA281,49005
.set cA282,49006
.set cA283,49007
.set cA284,49008
.set cA285,49009
.set cA286,49010
.set cA287,49011
.set cA288,49011
.set cA289,49012
.set cA290,49013
.set cA291,49014
.set cA292,49014
.set cA293,49015
.set cA294,49016
.set cA295,49016
.set cA296,49017
.set cA297,49018
.set cA298,49018
.set cA299,49019
.set cA300,49019
.set cA301,49020
.set cA302,49020
.set cA303,49020
.set cA304,49021
.set cA305,49021
.set cA306,49022
.set cA307,49022
.set cA308,49022
.set cA309,49023
.set cA310,49023
.set cA311,49023
.set cA312,49023
.set cA313,49023
.set cA314,49024
.set cA315,49024
.set cA316,49024
.set cA317,49024
.set cA318,49024
.set cA319,49024
.set cA320,49024
.set cA321,49024
.set cA322,49024
.set cA323,49024
.set cA324,49024
.set cA325,49024
.set cA326,49024
.set cA327,49023
.set cA328,49023
.set cA329,49023
.set cA330,49023
.set cA331,49023
.set cA332,49022
.set cA333,49022
.set cA334,49022
.set cA335,49021
.set cA336,49021
.set cA337,49020
.set cA338,49020
.set cA339,49020
.set cA340,49019
.set cA341,49019
.set cA342,49018
.set cA343,49018
.set cA344,49017
.set cA345,49016
.set cA346,49016
.set cA347,49015
.set cA348,49014
.set cA349,49014
.set cA350,49013
.set cA351,49012
.set cA352,49011
.set cA353,49011
.set cA354,49010
.set cA355,49009
.set cA356,49008
.set cA357,49007
.set cA358,49006
.set cA359,49005
.set cA360,49005
.set cA361,49004
.set cA362,49003
.set cA363,49002
.set cA364,49000
.set cA365,48999
.set cA366,48998
.set cA367,48997
.set cA368,48996
.set cA369,48995
.set cA370,48994
.set cA371,48993
.set cA372,48991
.set cA373,48990
.set cA374,48989
.set cA375,48988
.set cA376,48986
.set cA377,48985
.set cA378,48984
.set cA379,48982
.set cA380,48981
.set cA381,48979
.set cA382,48978
.set cA383,48977
.set cA384,48975
.set cA385,48974
.set cA386,48972
.set cA387,48971
.set cA388,48969
.set cA389,48967
.set cA390,48966
.set cA391,48964
.set cA392,48963
.set cA393,48961
.set cA394,48959
.set cA395,48958
.set cA396,48956
.set cA397,48954
.set cA398,48953
.set cA399,48951
.set cA400,48949
.set cA401,48947
.set cA402,48945
.set cA403,48944
.set cA404,48942
.set cA405,48940
.set cA406,48938
.set cA407,48936
.set cA408,48934
.set cA409,48932
.set cA410,48930
.set cA411,48928
.set cA412,48926
.set cA413,48925
.set cA414,48923
.set cA415,48920
.set cA416,48918
.set cA417,48916
.set cA418,48914
.set cA419,48912
.set cA420,48910
.set cA421,48908
.set cA422,48906
.set cA423,48904
.set cA424,48902
.set cA425,48900
.set cA426,48897
.set cA427,48895
.set cA428,48890
.set cA429,48886
.set cA430,48881
.set cA431,48877
.set cA432,48872
.set cA433,48868
.set cA434,48863
.set cA435,48859
.set cA436,48854
.set cA437,48850
.set cA438,48845
.set cA439,48841
.set cA440,48836
.set cA441,48831
.set cA442,48827
.set cA443,48822
.set cA444,48817
.set cA445,48812
.set cA446,48808
.set cA447,48803
.set cA448,48798
.set cA449,48793
.set cA450,48789
.set cA451,48784
.set cA452,48779
.set cA453,48774
.set cA454,48769
.set cA455,48761
.set cA456,48751
.set cA457,48741
.set cA458,48731
.set cA459,48722
.set cA460,48712
.set cA461,48702
.set cA462,48692
.set cA463,48682
.set cA464,48672
.set cA465,48662
.set cA466,48652
.set cA467,48642
.set cA468,48625
.set cA469,48605
.set cA470,48585
.set cA471,48565
.set cA472,48545
.set cA473,48525
.set cA474,48497
.set cA475,48457
.set cA476,48417
.set cA477,48369
.set cA478,48289
.set cA479,48161
.set cA480,0
.set cA481,15393
.set cA482,15521
.set cA483,15601
.set cA484,15649
.set cA485,15689
.set cA486,15729
.set cA487,15757
.set cA488,15777
.set cA489,15797
.set cA490,15817
.set cA491,15837
.set cA492,15857
.set cA493,15874
.set cA494,15884
.set cA495,15894
.set cA496,15904
.set cA497,15914
.set cA498,15924
.set cA499,15934
.set cA500,15944
.set cA501,15954
.set cA502,15963
.set cA503,15973
.set cA504,15983
.set cA505,15993
.set cA506,16001
.set cA507,16006
.set cA508,16011
.set cA509,16016
.set cA510,16021
.set cA511,16025
.set cA512,16030
.set cA513,16035
.set cA514,16040
.set cA515,16044
.set cA516,16049
.set cA517,16054
.set cA518,16059
.set cA519,16063
.set cA520,16068
.set cA521,16073
.set cA522,16077
.set cA523,16082
.set cA524,16086
.set cA525,16091
.set cA526,16095
.set cA527,16100
.set cA528,16104
.set cA529,16109
.set cA530,16113
.set cA531,16118
.set cA532,16122
.set cA533,16127
.set cA534,16129
.set cA535,16132
.set cA536,16134
.set cA537,16136
.set cA538,16138
.set cA539,16140
.set cA540,16142
.set cA541,16144
.set cA542,16146
.set cA543,16148
.set cA544,16150
.set cA545,16152
.set cA546,16155
.set cA547,16157
.set cA548,16158
.set cA549,16160
.set cA550,16162
.set cA551,16164
.set cA552,16166
.set cA553,16168
.set cA554,16170
.set cA555,16172
.set cA556,16174
.set cA557,16176
.set cA558,16177
.set cA559,16179
.set cA560,16181
.set cA561,16183
.set cA562,16185
.set cA563,16186
.set cA564,16188
.set cA565,16190
.set cA566,16191
.set cA567,16193
.set cA568,16195
.set cA569,16196
.set cA570,16198
.set cA571,16199
.set cA572,16201
.set cA573,16203
.set cA574,16204
.set cA575,16206
.set cA576,16207
.set cA577,16209
.set cA578,16210
.set cA579,16211
.set cA580,16213
.set cA581,16214
.set cA582,16216
.set cA583,16217
.set cA584,16218
.set cA585,16220
.set cA586,16221
.set cA587,16222
.set cA588,16223
.set cA589,16225
.set cA590,16226
.set cA591,16227
.set cA592,16228
.set cA593,16229
.set cA594,16230
.set cA595,16231
.set cA596,16232
.set cA597,16234
.set cA598,16235
.set cA599,16236
.set cA600,16237
.set cA601,16237
.set cA602,16238
.set cA603,16239
.set cA604,16240
.set cA605,16241
.set cA606,16242
.set cA607,16243
.set cA608,16243
.set cA609,16244
.set cA610,16245
.set cA611,16246
.set cA612,16246
.set cA613,16247
.set cA614,16248
.set cA615,16248
.set cA616,16249
.set cA617,16250
.set cA618,16250
.set cA619,16251
.set cA620,16251
.set cA621,16252
.set cA622,16252
.set cA623,16252
.set cA624,16253
.set cA625,16253
.set cA626,16254
.set cA627,16254
.set cA628,16254
.set cA629,16255
.set cA630,16255
.set cA631,16255
.set cA632,16255
.set cA633,16255
.set cA634,16256
.set cA635,16256
.set cA636,16256
.set cA637,16256
.set cA638,16256
.set cA639,16256
.altmacro
.macro eA Z0_,Z1_,Z2_,Z3_,Z4_,Z5_,Z6_,Z7_,Z8_,Z9_,Z10_,Z11_,Z12_,Z13_,Z14_,Z15_,Z16_,Z17_,Z18_,Z19_,Z20_,Z21_,Z22_,Z23_,Z24_,Z25_,Z26_,Z27_,Z28_,Z29_,Z30_,Z31_,Z32_,Z33_,Z34_,Z35_,Z36_,Z37_,Z38_,Z39_
.short cA\Z0_,cA\Z1_,cA\Z2_,cA\Z3_,cA\Z4_,cA\Z5_,cA\Z6_,cA\Z7_,cA\Z8_,cA\Z9_,cA\Z10_,cA\Z11_,cA\Z12_,cA\Z13_,cA\Z14_,cA\Z15_,cA\Z16_,cA\Z17_,cA\Z18_,cA\Z19_,cA\Z20_,cA\Z21_,cA\Z22_,cA\Z23_,cA\Z24_,cA\Z25_,cA\Z26_,cA\Z27_,cA\Z28_,cA\Z29_,cA\Z30_,cA\Z31_,cA\Z32_,cA\Z33_,cA\Z34_,cA\Z35_,cA\Z36_,cA\Z37_,cA\Z38_,cA\Z39_
.endm
.p2align 8
.type tab_base,@object
tab_base:
.set tr,0
.rept 640
.set td,(tr&0x3e0)+8*((tr>>2)&3)+4*((tr>>4)&1)+(tr&3)
eA %(0*td%640),%(2*td%640),%(4*td%640),%(6*td%640),%(8*td%640),%(10*td%640),%(12*td%640),%(14*td%640),%(16*td%640),%(18*td%640),%(20*td%640),%(22*td%640),%(24*td%640),%(26*td%640),%(28*td%640),%(30*td%640),%(320*td%640),%((2*td+160)%640),%((4*td+160)%640),%((6*td+160)%640),%((8*td+160)%640),%((10*td+160)%640),%((12*td+160)%640),%((14*td+160)%640),%((16*td+160)%640),%((18*td+160)%640),%((20*td+160)%640),%((22*td+160)%640),%((24*td+160)%640),%((26*td+160)%640),%((28*td+160)%640),%((30*td+160)%640),%(32*td%640),%(34*td%640),%(36*td%640),%(38*td%640),%(40*td%640),%(42*td%640),%(44*td%640),%(46*td%640)
eA %(48*td%640),%(50*td%640),%(52*td%640),%(54*td%640),%(56*td%640),%(58*td%640),%(60*td%640),%(62*td%640),%((32*td+160)%640),%((34*td+160)%640),%((36*td+160)%640),%((38*td+160)%640),%((40*td+160)%640),%((42*td+160)%640),%((44*td+160)%640),%((46*td+160)%640),%((48*td+160)%640),%((50*td+160)%640),%((52*td+160)%640),%((54*td+160)%640),%((56*td+160)%640),%((58*td+160)%640),%((60*td+160)%640),%((62*td+160)%640),%(64*td%640),%(66*td%640),%(68*td%640),%(70*td%640),%(72*td%640),%(74*td%640),%(76*td%640),%(78*td%640),%(80*td%640),%(82*td%640),%(84*td%640),%(86*td%640),%(88*td%640),%(90*td%640),%(92*td%640),%(94*td%640)
.set tr,tr+1
.endr
.set tr,0
.rept 640
.set td,(tr&0x3e0)+8*((tr>>2)&3)+4*((tr>>4)&1)+(tr&3)
eA %((64*td+160)%640),%((66*td+160)%640),%((68*td+160)%640),%((70*td+160)%640),%((72*td+160)%640),%((74*td+160)%640),%((76*td+160)%640),%((78*td+160)%640),%((80*td+160)%640),%((82*td+160)%640),%((84*td+160)%640),%((86*td+160)%640),%((88*td+160)%640),%((90*td+160)%640),%((92*td+160)%640),%((94*td+160)%640),%(96*td%640),%(98*td%640),%(100*td%640),%(102*td%640),%(104*td%640),%(106*td%640),%(108*td%640),%(110*td%640),%(112*td%640),%(114*td%640),%(116*td%640),%(118*td%640),%(120*td%640),%(122*td%640),%(124*td%640),%(126*td%640),%((96*td+160)%640),%((98*td+160)%640),%((100*td+160)%640),%((102*td+160)%640),%((104*td+160)%640),%((106*td+160)%640),%((108*td+160)%640),%((110*td+160)%640)
eA %((112*td+160)%640),%((114*td+160)%640),%((116*td+160)%640),%((118*td+160)%640),%((120*td+160)%640),%((122*td+160)%640),%((124*td+160)%640),%((126*td+160)%640),%(128*td%640),%(130*td%640),%(132*td%640),%(134*td%640),%(136*td%640),%(138*td%640),%(140*td%640),%(142*td%640),%(144*td%640),%(146*td%640),%(148*td%640),%(150*td%640),%(152*td%640),%(154*td%640),%(156*td%640),%(158*td%640),%((128*td+160)%640),%((130*td+160)%640),%((132*td+160)%640),%((134*td+160)%640),%((136*td+160)%640),%((138*td+160)%640),%((140*td+160)%640),%((142*td+160)%640),%((144*td+160)%640),%((146*td+160)%640),%((148*td+160)%640),%((150*td+160)%640),%((152*td+160)%640),%((154*td+160)%640),%((156*td+160)%640),%((158*td+160)%640)
.set tr,tr+1
.endr
.set tr,0
.rept 640
.set td,(tr&0x3e0)+8*((tr>>2)&3)+4*((tr>>4)&1)+(tr&3)
eA %(160*td%640),%(162*td%640),%(164*td%640),%(166*td%640),%(168*td%640),%(170*td%640),%(172*td%640),%(174*td%640),%(176*td%640),%(178*td%640),%(180*td%640),%(182*td%640),%(184*td%640),%(186*td%640),%(188*td%640),%(190*td%640),%((160*td+160)%640),%((162*td+160)%640),%((164*td+160)%640),%((166*td+160)%640),%((168*td+160)%640),%((170*td+160)%640),%((172*td+160)%640),%((174*td+160)%640),%((176*td+160)%640),%((178*td+160)%640),%((180*td+160)%640),%((182*td+160)%640),%((184*td+160)%640),%((186*td+160)%640),%((188*td+160)%640),%((190*td+160)%640),%(192*td%640),%(194*td%640),%(196*td%640),%(198*td%640),%(200*td%640),%(202*td%640),%(204*td%640),%(206*td%640)
eA %(208*td%640),%(210*td%640),%(212*td%640),%(214*td%640),%(216*td%640),%(218*td%640),%(220*td%640),%(222*td%640),%((192*td+160)%640),%((194*td+160)%640),%((196*td+160)%640),%((198*td+160)%640),%((200*td+160)%640),%((202*td+160)%640),%((204*td+160)%640),%((206*td+160)%640),%((208*td+160)%640),%((210*td+160)%640),%((212*td+160)%640),%((214*td+160)%640),%((216*td+160)%640),%((218*td+160)%640),%((220*td+160)%640),%((222*td+160)%640),%(224*td%640),%(226*td%640),%(228*td%640),%(230*td%640),%(232*td%640),%(234*td%640),%(236*td%640),%(238*td%640),%(240*td%640),%(242*td%640),%(244*td%640),%(246*td%640),%(248*td%640),%(250*td%640),%(252*td%640),%(254*td%640)
.set tr,tr+1
.endr
.set tr,0
.rept 640
.set td,(tr&0x3e0)+8*((tr>>2)&3)+4*((tr>>4)&1)+(tr&3)
eA %((224*td+160)%640),%((226*td+160)%640),%((228*td+160)%640),%((230*td+160)%640),%((232*td+160)%640),%((234*td+160)%640),%((236*td+160)%640),%((238*td+160)%640),%((240*td+160)%640),%((242*td+160)%640),%((244*td+160)%640),%((246*td+160)%640),%((248*td+160)%640),%((250*td+160)%640),%((252*td+160)%640),%((254*td+160)%640),%(256*td%640),%(258*td%640),%(260*td%640),%(262*td%640),%(264*td%640),%(266*td%640),%(268*td%640),%(270*td%640),%(272*td%640),%(274*td%640),%(276*td%640),%(278*td%640),%(280*td%640),%(282*td%640),%(284*td%640),%(286*td%640),%((256*td+160)%640),%((258*td+160)%640),%((260*td+160)%640),%((262*td+160)%640),%((264*td+160)%640),%((266*td+160)%640),%((268*td+160)%640),%((270*td+160)%640)
eA %((272*td+160)%640),%((274*td+160)%640),%((276*td+160)%640),%((278*td+160)%640),%((280*td+160)%640),%((282*td+160)%640),%((284*td+160)%640),%((286*td+160)%640),%(288*td%640),%(290*td%640),%(292*td%640),%(294*td%640),%(296*td%640),%(298*td%640),%(300*td%640),%(302*td%640),%(304*td%640),%(306*td%640),%(308*td%640),%(310*td%640),%(312*td%640),%(314*td%640),%(316*td%640),%(318*td%640),%((288*td+160)%640),%((290*td+160)%640),%((292*td+160)%640),%((294*td+160)%640),%((296*td+160)%640),%((298*td+160)%640),%((300*td+160)%640),%((302*td+160)%640),%((304*td+160)%640),%((306*td+160)%640),%((308*td+160)%640),%((310*td+160)%640),%((312*td+160)%640),%((314*td+160)%640),%((316*td+160)%640),%((318*td+160)%640)
.set tr,tr+1
.endr
.set tr,0
.rept 640
.set td,(tr&0x3e0)+8*((tr>>2)&3)+4*((tr>>4)&1)+(tr&3)
eA %(1*td%640),%(3*td%640),%(5*td%640),%(7*td%640),%(9*td%640),%(11*td%640),%(13*td%640),%(15*td%640),%(17*td%640),%(19*td%640),%(21*td%640),%(23*td%640),%(25*td%640),%(27*td%640),%(29*td%640),%(31*td%640),%((1*td+160)%640),%((3*td+160)%640),%((5*td+160)%640),%((7*td+160)%640),%((9*td+160)%640),%((11*td+160)%640),%((13*td+160)%640),%((15*td+160)%640),%((17*td+160)%640),%((19*td+160)%640),%((21*td+160)%640),%((23*td+160)%640),%((25*td+160)%640),%((27*td+160)%640),%((29*td+160)%640),%((31*td+160)%640),%(33*td%640),%(35*td%640),%(37*td%640),%(39*td%640),%(41*td%640),%(43*td%640),%(45*td%640),%(47*td%640)
eA %(49*td%640),%(51*td%640),%(53*td%640),%(55*td%640),%(57*td%640),%(59*td%640),%(61*td%640),%(63*td%640),%((33*td+160)%640),%((35*td+160)%640),%((37*td+160)%640),%((39*td+160)%640),%((41*td+160)%640),%((43*td+160)%640),%((45*td+160)%640),%((47*td+160)%640),%((49*td+160)%640),%((51*td+160)%640),%((53*td+160)%640),%((55*td+160)%640),%((57*td+160)%640),%((59*td+160)%640),%((61*td+160)%640),%((63*td+160)%640),%(65*td%640),%(67*td%640),%(69*td%640),%(71*td%640),%(73*td%640),%(75*td%640),%(77*td%640),%(79*td%640),%(81*td%640),%(83*td%640),%(85*td%640),%(87*td%640),%(89*td%640),%(91*td%640),%(93*td%640),%(95*td%640)
.set tr,tr+1
.endr
.set tr,0
.rept 640
.set td,(tr&0x3e0)+8*((tr>>2)&3)+4*((tr>>4)&1)+(tr&3)
eA %((65*td+160)%640),%((67*td+160)%640),%((69*td+160)%640),%((71*td+160)%640),%((73*td+160)%640),%((75*td+160)%640),%((77*td+160)%640),%((79*td+160)%640),%((81*td+160)%640),%((83*td+160)%640),%((85*td+160)%640),%((87*td+160)%640),%((89*td+160)%640),%((91*td+160)%640),%((93*td+160)%640),%((95*td+160)%640),%(97*td%640),%(99*td%640),%(101*td%640),%(103*td%640),%(105*td%640),%(107*td%640),%(109*td%640),%(111*td%640),%(113*td%640),%(115*td%640),%(117*td%640),%(119*td%640),%(121*td%640),%(123*td%640),%(125*td%640),%(127*td%640),%((97*td+160)%640),%((99*td+160)%640),%((101*td+160)%640),%((103*td+160)%640),%((105*td+160)%640),%((107*td+160)%640),%((109*td+160)%640),%((111*td+160)%640)
eA %((113*td+160)%640),%((115*td+160)%640),%((117*td+160)%640),%((119*td+160)%640),%((121*td+160)%640),%((123*td+160)%640),%((125*td+160)%640),%((127*td+160)%640),%(129*td%640),%(131*td%640),%(133*td%640),%(135*td%640),%(137*td%640),%(139*td%640),%(141*td%640),%(143*td%640),%(145*td%640),%(147*td%640),%(149*td%640),%(151*td%640),%(153*td%640),%(155*td%640),%(157*td%640),%(159*td%640),%((129*td+160)%640),%((131*td+160)%640),%((133*td+160)%640),%((135*td+160)%640),%((137*td+160)%640),%((139*td+160)%640),%((141*td+160)%640),%((143*td+160)%640),%((145*td+160)%640),%((147*td+160)%640),%((149*td+160)%640),%((151*td+160)%640),%((153*td+160)%640),%((155*td+160)%640),%((157*td+160)%640),%((159*td+160)%640)
.set tr,tr+1
.endr
.set tr,0
.rept 640
.set td,(tr&0x3e0)+8*((tr>>2)&3)+4*((tr>>4)&1)+(tr&3)
eA %(161*td%640),%(163*td%640),%(165*td%640),%(167*td%640),%(169*td%640),%(171*td%640),%(173*td%640),%(175*td%640),%(177*td%640),%(179*td%640),%(181*td%640),%(183*td%640),%(185*td%640),%(187*td%640),%(189*td%640),%(191*td%640),%((161*td+160)%640),%((163*td+160)%640),%((165*td+160)%640),%((167*td+160)%640),%((169*td+160)%640),%((171*td+160)%640),%((173*td+160)%640),%((175*td+160)%640),%((177*td+160)%640),%((179*td+160)%640),%((181*td+160)%640),%((183*td+160)%640),%((185*td+160)%640),%((187*td+160)%640),%((189*td+160)%640),%((191*td+160)%640),%(193*td%640),%(195*td%640),%(197*td%640),%(199*td%640),%(201*td%640),%(203*td%640),%(205*td%640),%(207*td%640)
eA %(209*td%640),%(211*td%640),%(213*td%640),%(215*td%640),%(217*td%640),%(219*td%640),%(221*td%640),%(223*td%640),%((193*td+160)%640),%((195*td+160)%640),%((197*td+160)%640),%((199*td+160)%640),%((201*td+160)%640),%((203*td+160)%640),%((205*td+160)%640),%((207*td+160)%640),%((209*td+160)%640),%((211*td+160)%640),%((213*td+160)%640),%((215*td+160)%640),%((217*td+160)%640),%((219*td+160)%640),%((221*td+160)%640),%((223*td+160)%640),%(225*td%640),%(227*td%640),%(229*td%640),%(231*td%640),%(233*td%640),%(235*td%640),%(237*td%640),%(239*td%640),%(241*td%640),%(243*td%640),%(245*td%640),%(247*td%640),%(249*td%640),%(251*td%640),%(253*td%640),%(255*td%640)
.set tr,tr+1
.endr
.set tr,0
.rept 640
.set td,(tr&0x3e0)+8*((tr>>2)&3)+4*((tr>>4)&1)+(tr&3)
eA %((225*td+160)%640),%((227*td+160)%640),%((229*td+160)%640),%((231*td+160)%640),%((233*td+160)%640),%((235*td+160)%640),%((237*td+160)%640),%((239*td+160)%640),%((241*td+160)%640),%((243*td+160)%640),%((245*td+160)%640),%((247*td+160)%640),%((249*td+160)%640),%((251*td+160)%640),%((253*td+160)%640),%((255*td+160)%640),%(257*td%640),%(259*td%640),%(261*td%640),%(263*td%640),%(265*td%640),%(267*td%640),%(269*td%640),%(271*td%640),%(273*td%640),%(275*td%640),%(277*td%640),%(279*td%640),%(281*td%640),%(283*td%640),%(285*td%640),%(287*td%640),%((257*td+160)%640),%((259*td+160)%640),%((261*td+160)%640),%((263*td+160)%640),%((265*td+160)%640),%((267*td+160)%640),%((269*td+160)%640),%((271*td+160)%640)
eA %((273*td+160)%640),%((275*td+160)%640),%((277*td+160)%640),%((279*td+160)%640),%((281*td+160)%640),%((283*td+160)%640),%((285*td+160)%640),%((287*td+160)%640),%(289*td%640),%(291*td%640),%(293*td%640),%(295*td%640),%(297*td%640),%(299*td%640),%(301*td%640),%(303*td%640),%(305*td%640),%(307*td%640),%(309*td%640),%(311*td%640),%(313*td%640),%(315*td%640),%(317*td%640),%(319*td%640),%((289*td+160)%640),%((291*td+160)%640),%((293*td+160)%640),%((295*td+160)%640),%((297*td+160)%640),%((299*td+160)%640),%((301*td+160)%640),%((303*td+160)%640),%((305*td+160)%640),%((307*td+160)%640),%((309*td+160)%640),%((311*td+160)%640),%((313*td+160)%640),%((315*td+160)%640),%((317*td+160)%640),%((319*td+160)%640)
.set tr,tr+1
.endr
.long 0x3f80,0x3f80,0x3f80,0x3f80,0x3f80,0x3f7b,0x3f6d,0x3f55,0x3f80,0x3f6d,0x3f35,0x3ec4,0x3f80,0x3f55,0x3ec4,0xbe48
.long 0x3f80,0x3f35,0,0xbf35,0x3f80,0x3f0e,0xbec4,0xbf7b,0x3f80,0x3ec4,0xbf35,0xbf6d,0x3f80,0x3e48,0xbf6d,0xbf0e
.long 0x3f80,0,0xbf80,0,0x3f80,0xbe48,0xbf6d,0x3f0e,0x3f80,0xbec4,0xbf35,0x3f6d,0x3f80,0xbf0e,0xbec4,0x3f7b
.long 0x3f80,0xbf35,0,0x3f35,0x3f80,0xbf55,0x3ec4,0x3e48,0x3f80,0xbf6d,0x3f35,0xbec4,0x3f80,0xbf7b,0x3f6d,0xbf55
.long 0x3f80,0x3f80,0x3f80,0x3f80,0x3f35,0x3f0e,0x3ec4,0x3e48,0,0xbec4,0xbf35,0xbf6d,0xbf35,0xbf7b,0xbf6d,0xbf0e
.long 0xbf80,0xbf35,0,0x3f35,0xbf35,0x3e48,0x3f6d,0x3f55,0,0x3f6d,0x3f35,0xbec4,0x3f35,0x3f55,0xbec4,0xbf7b
.long 0x3f80,0,0xbf80,0,0x3f35,0xbf55,0xbec4,0x3f7b,0,0xbf6d,0x3f35,0x3ec4,0xbf35,0xbe48,0x3f6d,0xbf55
.long 0xbf80,0x3f35,0,0xbf35,0xbf35,0x3f7b,0xbf6d,0x3f0e,0,0x3ec4,0xbf35,0x3f6d,0x3f35,0xbf0e,0x3ec4,0xbe48
.long 0x3f80,0x3f80,0x3f80,0x3f80,0,0xbe48,0xbec4,0xbf0e,0xbf80,0xbf6d,0xbf35,0xbec4,0,0x3f0e,0x3f6d,0x3f7b
.long 0x3f80,0x3f35,0,0xbf35,0,0xbf55,0xbf6d,0xbe48,0xbf80,0xbec4,0x3f35,0x3f6d,0,0x3f7b,0x3ec4,0xbf55
.long 0x3f80,0,0xbf80,0,0,0xbf7b,0x3ec4,0x3f55,0xbf80,0x3ec4,0x3f35,0xbf6d,0,0x3f55,0xbf6d,0x3e48
.long 0x3f80,0xbf35,0,0x3f35,0,0xbf0e,0x3f6d,0xbf7b,0xbf80,0x3f6d,0xbf35,0x3ec4,0,0x3e48,0xbec4,0x3f0e
.long 0x3f80,0x3f80,0x3f80,0x3f80,0xbf35,0xbf55,0xbf6d,0xbf7b,0,0x3ec4,0x3f35,0x3f6d,0x3f35,0x3e48,0xbec4,0xbf55
.long 0xbf80,0xbf35,0,0x3f35,0x3f35,0x3f7b,0x3ec4,0xbf0e,0,0xbf6d,0xbf35,0x3ec4,0xbf35,0x3f0e,0x3f6d,0xbe48
.long 0x3f80,0,0xbf80,0,0xbf35,0xbf0e,0x3f6d,0x3e48,0,0x3f6d,0xbf35,0xbec4,0x3f35,0xbf7b,0x3ec4,0x3f0e
.long 0xbf80,0x3f35,0,0xbf35,0x3f35,0xbe48,0xbec4,0x3f55,0,0xbec4,0x3f35,0xbf6d,0xbf35,0x3f55,0xbf6d,0x3f7b
.long 0x3f80,0x3f80,0x3f80,0x3f80,0xbf80,0xbf7b,0xbf6d,0xbf55,0x3f80,0x3f6d,0x3f35,0x3ec4,0xbf80,0xbf55,0xbec4,0x3e48
.long 0x3f80,0x3f35,0,0xbf35,0xbf80,0xbf0e,0x3ec4,0x3f7b,0x3f80,0x3ec4,0xbf35,0xbf6d,0xbf80,0xbe48,0x3f6d,0x3f0e
.long 0x3f80,0,0xbf80,0,0xbf80,0x3e48,0x3f6d,0xbf0e,0x3f80,0xbec4,0xbf35,0x3f6d,0xbf80,0x3f0e,0x3ec4,0xbf7b
.long 0x3f80,0xbf35,0,0x3f35,0xbf80,0x3f55,0xbec4,0xbe48,0x3f80,0xbf6d,0x3f35,0xbec4,0xbf80,0x3f7b,0xbf6d,0x3f55
.long 0x3f80,0x3f80,0x3f80,0x3f80,0xbf35,0xbf0e,0xbec4,0xbe48,0,0xbec4,0xbf35,0xbf6d,0x3f35,0x3f7b,0x3f6d,0x3f0e
.long 0xbf80,0xbf35,0,0x3f35,0x3f35,0xbe48,0xbf6d,0xbf55,0,0x3f6d,0x3f35,0xbec4,0xbf35,0xbf55,0x3ec4,0x3f7b
.long 0x3f80,0,0xbf80,0,0xbf35,0x3f55,0x3ec4,0xbf7b,0,0xbf6d,0x3f35,0x3ec4,0x3f35,0x3e48,0xbf6d,0x3f55
.long 0xbf80,0x3f35,0,0xbf35,0x3f35,0xbf7b,0x3f6d,0xbf0e,0,0x3ec4,0xbf35,0x3f6d,0xbf35,0x3f0e,0xbec4,0x3e48
.long 0x3f80,0x3f80,0x3f80,0x3f80,0,0x3e48,0x3ec4,0x3f0e,0xbf80,0xbf6d,0xbf35,0xbec4,0,0xbf0e,0xbf6d,0xbf7b
.long 0x3f80,0x3f35,0,0xbf35,0,0x3f55,0x3f6d,0x3e48,0xbf80,0xbec4,0x3f35,0x3f6d,0,0xbf7b,0xbec4,0x3f55
.long 0x3f80,0,0xbf80,0,0,0x3f7b,0xbec4,0xbf55,0xbf80,0x3ec4,0x3f35,0xbf6d,0,0xbf55,0x3f6d,0xbe48
.long 0x3f80,0xbf35,0,0x3f35,0,0x3f0e,0xbf6d,0x3f7b,0xbf80,0x3f6d,0xbf35,0x3ec4,0,0xbe48,0x3ec4,0xbf0e
.long 0x3f80,0x3f80,0x3f80,0x3f80,0x3f35,0x3f55,0x3f6d,0x3f7b,0,0x3ec4,0x3f35,0x3f6d,0xbf35,0xbe48,0x3ec4,0x3f55
.long 0xbf80,0xbf35,0,0x3f35,0xbf35,0xbf7b,0xbec4,0x3f0e,0,0xbf6d,0xbf35,0x3ec4,0x3f35,0xbf0e,0xbf6d,0x3e48
.long 0x3f80,0,0xbf80,0,0x3f35,0x3f0e,0xbf6d,0xbe48,0,0x3f6d,0xbf35,0xbec4,0xbf35,0x3f7b,0xbec4,0xbf0e
.long 0xbf80,0x3f35,0,0xbf35,0xbf35,0x3e48,0x3ec4,0xbf55,0,0xbec4,0x3f35,0xbf6d,0x3f35,0xbf55,0x3f6d,0xbf7b
.long 0x3f800000,0x3f7f0000,0x3f7b0000,0x3f750000,0x3f800000,0x3f750000,0x3f550000,0x3f220000,0x3f800000,0x3f620000,0x3f0e0000,0x3dc90000,0x3f800000,0x3f460000,0x3e480000,0xbef10000
.long 0x3f800000,0x3f220000,0xbe480000,0xbf620000,0x3f800000,0x3ef10000,0xbf0e0000,0xbf7f0000,0x3f800000,0x3e950000,0xbf550000,0xbf460000,0x3f800000,0x3dc90000,0xbf7b0000,0xbe950000
.long 0x3f800000,0xbdc90000,0xbf7b0000,0x3e950000,0x3f800000,0xbe950000,0xbf550000,0x3f460000,0x3f800000,0xbef10000,0xbf0e0000,0x3f7f0000,0x3f800000,0xbf220000,0xbe480000,0x3f620000
.long 0x3f800000,0xbf460000,0x3e480000,0x3ef10000,0x3f800000,0xbf620000,0x3f0e0000,0xbdc90000,0x3f800000,0xbf750000,0x3f550000,0xbf220000,0x3f800000,0xbf7f0000,0x3f7b0000,0xbf750000
.long 0x3f6d0000,0x3f620000,0x3f550000,0x3f460000,0x3ec40000,0x3dc90000,0xbe480000,0xbef10000,0xbec40000,0xbf460000,0xbf7b0000,0xbf750000,0xbf6d0000,0xbf750000,0xbf0e0000,0x3dc90000
.long 0xbf6d0000,0xbe950000,0x3f0e0000,0x3f7f0000,0xbec40000,0x3f220000,0x3f7b0000,0x3e950000,0x3ec40000,0x3f7f0000,0x3e480000,0xbf620000,0x3f6d0000,0x3ef10000,0xbf550000,0xbf220000
.long 0x3f6d0000,0xbef10000,0xbf550000,0x3f220000,0x3ec40000,0xbf7f0000,0x3e480000,0x3f620000,0xbec40000,0xbf220000,0x3f7b0000,0xbe950000,0xbf6d0000,0x3e950000,0x3f0e0000,0xbf7f0000
.long 0xbf6d0000,0x3f750000,0xbf0e0000,0xbdc90000,0xbec40000,0x3f460000,0xbf7b0000,0x3f750000,0x3ec40000,0xbdc90000,0xbe480000,0x3ef10000,0x3f6d0000,0xbf620000,0x3f550000,0xbf460000
.long 0x3f350000,0x3f220000,0x3f0e0000,0x3ef10000,0xbf350000,0xbf620000,0xbf7b0000,0xbf7f0000,0xbf350000,0xbe950000,0x3e480000,0x3f220000,0x3f350000,0x3f7f0000,0x3f550000,0x3e950000
.long 0x3f350000,0xbdc90000,0xbf550000,0xbf750000,0xbf350000,0xbf750000,0xbe480000,0x3f460000,0xbf350000,0x3ef10000,0x3f7b0000,0x3dc90000,0x3f350000,0x3f460000,0xbf0e0000,0xbf620000
.long 0x3f350000,0xbf460000,0xbf0e0000,0x3f620000,0xbf350000,0xbef10000,0x3f7b0000,0xbdc90000,0xbf350000,0x3f750000,0xbe480000,0xbf460000,0x3f350000,0x3dc90000,0xbf550000,0x3f750000
.long 0x3f350000,0xbf7f0000,0x3f550000,0xbe950000,0xbf350000,0x3e950000,0x3e480000,0xbf220000,0xbf350000,0x3f620000,0xbf7b0000,0x3f7f0000,0x3f350000,0xbf220000,0x3f0e0000,0xbef10000
.long 0x3ec40000,0x3e950000,0x3e480000,0x3dc90000,0xbf6d0000,0xbf460000,0xbf0e0000,0xbe950000,0x3f6d0000,0x3f7f0000,0x3f550000,0x3ef10000,0xbec40000,0xbf620000,0xbf7b0000,0xbf220000
.long 0xbec40000,0x3ef10000,0x3f7b0000,0x3f460000,0x3f6d0000,0x3dc90000,0xbf550000,0xbf620000,0xbf6d0000,0xbf220000,0x3f0e0000,0x3f750000,0x3ec40000,0x3f750000,0xbe480000,0xbf7f0000
.long 0x3ec40000,0xbf750000,0xbe480000,0x3f7f0000,0xbf6d0000,0x3f220000,0x3f0e0000,0xbf750000,0x3f6d0000,0xbdc90000,0xbf550000,0x3f620000,0xbec40000,0xbef10000,0x3f7b0000,0xbf460000
.long 0xbec40000,0x3f620000,0xbf7b0000,0x3f220000,0x3f6d0000,0xbf7f0000,0x3f550000,0xbef10000,0xbf6d0000,0x3f460000,0xbf0e0000,0x3e950000,0x3ec40000,0xbe950000,0x3e480000,0xbdc90000
.long 0,0xbdc90000,0xbe480000,0xbe950000,0,0x3e950000,0x3f0e0000,0x3f460000,0,0xbef10000,0xbf550000,0xbf7f0000,0,0x3f220000,0x3f7b0000,0x3f620000
.long 0,0xbf460000,0xbf7b0000,0xbef10000,0,0x3f620000,0x3f550000,0xbdc90000,0,0xbf750000,0xbf0e0000,0x3f220000,0,0x3f7f0000,0x3e480000,0xbf750000
.long 0,0xbf7f0000,0x3e480000,0x3f750000,0,0x3f750000,0xbf0e0000,0xbf220000,0,0xbf620000,0x3f550000,0x3dc90000,0,0x3f460000,0xbf7b0000,0x3ef10000
.long 0,0xbf220000,0x3f7b0000,0xbf620000,0,0x3ef10000,0xbf550000,0x3f7f0000,0,0xbe950000,0x3f0e0000,0xbf460000,0,0x3dc90000,0xbe480000,0x3e950000
.long 0xbec40000,0xbef10000,0xbf0e0000,0xbf220000,0x3f6d0000,0x3f7f0000,0x3f7b0000,0x3f620000,0xbf6d0000,0xbf220000,0xbe480000,0x3e950000,0x3ec40000,0xbe950000,0xbf550000,0xbf7f0000
.long 0x3ec40000,0x3f750000,0x3f550000,0x3dc90000,0xbf6d0000,0xbf460000,0x3e480000,0x3f750000,0x3f6d0000,0xbdc90000,0xbf7b0000,0xbef10000,0xbec40000,0x3f620000,0x3f0e0000,0xbf460000
.long 0xbec40000,0xbf620000,0x3f0e0000,0x3f460000,0x3f6d0000,0x3dc90000,0xbf7b0000,0x3ef10000,0xbf6d0000,0x3f460000,0x3e480000,0xbf750000,0x3ec40000,0xbf750000,0x3f550000,0xbdc90000
.long 0x3ec40000,0x3e950000,0xbf550000,0x3f7f0000,0xbf6d0000,0x3f220000,0xbe480000,0xbe950000,0x3f6d0000,0xbf7f0000,0x3f7b0000,0xbf620000,0xbec40000,0x3ef10000,0xbf0e0000,0x3f220000
.long 0xbf350000,0xbf460000,0xbf550000,0xbf620000,0x3f350000,0x3ef10000,0x3e480000,0xbdc90000,0x3f350000,0x3f750000,0x3f7b0000,0x3f460000,0xbf350000,0xbdc90000,0x3f0e0000,0x3f750000
.long 0xbf350000,0xbf7f0000,0xbf0e0000,0x3e950000,0x3f350000,0xbe950000,0xbf7b0000,0xbf220000,0x3f350000,0x3f620000,0xbe480000,0xbf7f0000,0xbf350000,0x3f220000,0x3f550000,0xbef10000
.long 0xbf350000,0xbf220000,0x3f550000,0x3ef10000,0x3f350000,0xbf620000,0xbe480000,0x3f7f0000,0x3f350000,0x3e950000,0xbf7b0000,0x3f220000,0xbf350000,0x3f7f0000,0xbf0e0000,0xbe950000
.long 0xbf350000,0x3dc90000,0x3f0e0000,0xbf750000,0x3f350000,0xbf750000,0x3f7b0000,0xbf460000,0x3f350000,0xbef10000,0x3e480000,0x3dc90000,0xbf350000,0x3f460000,0xbf550000,0x3f620000
.long 0xbf6d0000,0xbf750000,0xbf7b0000,0xbf7f0000,0xbec40000,0xbf220000,0xbf550000,0xbf750000,0x3ec40000,0xbdc90000,0xbf0e0000,0xbf620000,0x3f6d0000,0x3ef10000,0xbe480000,0xbf460000
.long 0x3f6d0000,0x3f620000,0x3e480000,0xbf220000,0x3ec40000,0x3f7f0000,0x3f0e0000,0xbef10000,0xbec40000,0x3f460000,0x3f550000,0xbe950000,0xbf6d0000,0x3e950000,0x3f7b0000,0xbdc90000
.long 0xbf6d0000,0xbe950000,0x3f7b0000,0x3dc90000,0xbec40000,0xbf460000,0x3f550000,0x3e950000,0x3ec40000,0xbf7f0000,0x3f0e0000,0x3ef10000,0x3f6d0000,0xbf620000,0x3e480000,0x3f220000
.long 0x3f6d0000,0xbef10000,0xbe480000,0x3f460000,0x3ec40000,0x3dc90000,0xbf0e0000,0x3f620000,0xbec40000,0x3f220000,0xbf550000,0x3f750000,0xbf6d0000,0x3f750000,0xbf7b0000,0x3f7f0000
.long 0x3f80,0xbf80,0x3f80,0xbf80,0,0x3e48,0x3ec4,0x3f0e,0,0x3ec4,0x3f35,0x3f6d,0,0x3f0e,0x3f6d,0x3f7b
.long 0,0x3f35,0x3f80,0x3f35,0,0x3f55,0x3f6d,0x3e48,0,0x3f6d,0x3f35,0xbec4,0,0x3f7b,0x3ec4,0xbf55
.long 0,0x3f80,0,0xbf80,0,0x3f7b,0xbec4,0xbf55,0,0x3f6d,0xbf35,0xbec4,0,0x3f55,0xbf6d,0x3e48
.long 0,0x3f35,0xbf80,0x3f35,0,0x3f0e,0xbf6d,0x3f7b,0,0x3ec4,0xbf35,0x3f6d,0,0x3e48,0xbec4,0x3f0e
.long 0x3f80,0xbf80,0x3f80,0xbf80,0x3f35,0x3f55,0x3f6d,0x3f7b,0x3f80,0x3f6d,0x3f35,0x3ec4,0x3f35,0x3e48,0xbec4,0xbf55
.long 0,0xbf35,0xbf80,0xbf35,0xbf35,0xbf7b,0xbec4,0x3f0e,0xbf80,0xbec4,0x3f35,0x3f6d,0xbf35,0x3f0e,0x3f6d,0xbe48
.long 0,0x3f80,0,0xbf80,0x3f35,0x3f0e,0xbf6d,0xbe48,0x3f80,0xbec4,0xbf35,0x3f6d,0x3f35,0xbf7b,0x3ec4,0x3f0e
.long 0,0xbf35,0x3f80,0xbf35,0xbf35,0x3e48,0x3ec4,0xbf55,0xbf80,0x3f6d,0xbf35,0x3ec4,0xbf35,0x3f55,0xbf6d,0x3f7b
.long 0x3f80,0xbf80,0x3f80,0xbf80,0x3f80,0x3f7b,0x3f6d,0x3f55,0,0xbec4,0xbf35,0xbf6d,0xbf80,0xbf55,0xbec4,0x3e48
.long 0,0x3f35,0x3f80,0x3f35,0x3f80,0x3f0e,0xbec4,0xbf7b,0,0xbf6d,0xbf35,0x3ec4,0xbf80,0xbe48,0x3f6d,0x3f0e
.long 0,0x3f80,0,0xbf80,0x3f80,0xbe48,0xbf6d,0x3f0e,0,0xbf6d,0x3f35,0x3ec4,0xbf80,0x3f0e,0x3ec4,0xbf7b
.long 0,0x3f35,0xbf80,0x3f35,0x3f80,0xbf55,0x3ec4,0x3e48,0,0xbec4,0x3f35,0xbf6d,0xbf80,0x3f7b,0xbf6d,0x3f55
.long 0x3f80,0xbf80,0x3f80,0xbf80,0x3f35,0x3f0e,0x3ec4,0x3e48,0xbf80,0xbf6d,0xbf35,0xbec4,0x3f35,0x3f7b,0x3f6d,0x3f0e
.long 0,0xbf35,0xbf80,0xbf35,0xbf35,0x3e48,0x3f6d,0x3f55,0x3f80,0x3ec4,0xbf35,0xbf6d,0xbf35,0xbf55,0x3ec4,0x3f7b
.long 0,0x3f80,0,0xbf80,0x3f35,0xbf55,0xbec4,0x3f7b,0xbf80,0x3ec4,0x3f35,0xbf6d,0x3f35,0x3e48,0xbf6d,0x3f55
.long 0,0xbf35,0x3f80,0xbf35,0xbf35,0x3f7b,0xbf6d,0x3f0e,0x3f80,0xbf6d,0x3f35,0xbec4,0xbf35,0x3f0e,0xbec4,0x3e48
.long 0x3f80,0xbf80,0x3f80,0xbf80,0,0xbe48,0xbec4,0xbf0e,0,0x3ec4,0x3f35,0x3f6d,0,0xbf0e,0xbf6d,0xbf7b
.long 0,0x3f35,0x3f80,0x3f35,0,0xbf55,0xbf6d,0xbe48,0,0x3f6d,0x3f35,0xbec4,0,0xbf7b,0xbec4,0x3f55
.long 0,0x3f80,0,0xbf80,0,0xbf7b,0x3ec4,0x3f55,0,0x3f6d,0xbf35,0xbec4,0,0xbf55,0x3f6d,0xbe48
.long 0,0x3f35,0xbf80,0x3f35,0,0xbf0e,0x3f6d,0xbf7b,0,0x3ec4,0xbf35,0x3f6d,0,0xbe48,0x3ec4,0xbf0e
.long 0x3f80,0xbf80,0x3f80,0xbf80,0xbf35,0xbf55,0xbf6d,0xbf7b,0x3f80,0x3f6d,0x3f35,0x3ec4,0xbf35,0xbe48,0x3ec4,0x3f55
.long 0,0xbf35,0xbf80,0xbf35,0x3f35,0x3f7b,0x3ec4,0xbf0e,0xbf80,0xbec4,0x3f35,0x3f6d,0x3f35,0xbf0e,0xbf6d,0x3e48
.long 0,0x3f80,0,0xbf80,0xbf35,0xbf0e,0x3f6d,0x3e48,0x3f80,0xbec4,0xbf35,0x3f6d,0xbf35,0x3f7b,0xbec4,0xbf0e
.long 0,0xbf35,0x3f80,0xbf35,0x3f35,0xbe48,0xbec4,0x3f55,0xbf80,0x3f6d,0xbf35,0x3ec4,0x3f35,0xbf55,0x3f6d,0xbf7b
.long 0x3f80,0xbf80,0x3f80,0xbf80,0xbf80,0xbf7b,0xbf6d,0xbf55,0,0xbec4,0xbf35,0xbf6d,0x3f80,0x3f55,0x3ec4,0xbe48
.long 0,0x3f35,0x3f80,0x3f35,0xbf80,0xbf0e,0x3ec4,0x3f7b,0,0xbf6d,0xbf35,0x3ec4,0x3f80,0x3e48,0xbf6d,0xbf0e
.long 0,0x3f80,0,0xbf80,0xbf80,0x3e48,0x3f6d,0xbf0e,0,0xbf6d,0x3f35,0x3ec4,0x3f80,0xbf0e,0xbec4,0x3f7b
.long 0,0x3f35,0xbf80,0x3f35,0xbf80,0x3f55,0xbec4,0xbe48,0,0xbec4,0x3f35,0xbf6d,0x3f80,0xbf7b,0x3f6d,0xbf55
.long 0x3f80,0xbf80,0x3f80,0xbf80,0xbf35,0xbf0e,0xbec4,0xbe48,0xbf80,0xbf6d,0xbf35,0xbec4,0xbf35,0xbf7b,0xbf6d,0xbf0e
.long 0,0xbf35,0xbf80,0xbf35,0x3f35,0xbe48,0xbf6d,0xbf55,0x3f80,0x3ec4,0xbf35,0xbf6d,0x3f35,0x3f55,0xbec4,0xbf7b
.long 0,0x3f80,0,0xbf80,0xbf35,0x3f55,0x3ec4,0xbf7b,0xbf80,0x3ec4,0x3f35,0xbf6d,0xbf35,0xbe48,0x3f6d,0xbf55
.long 0,0xbf35,0x3f80,0xbf35,0x3f35,0xbf7b,0x3f6d,0xbf0e,0x3f80,0xbf6d,0x3f35,0xbec4,0x3f35,0xbf0e,0x3ec4,0xbe48
.long 0,0x3dc90000,0x3e480000,0x3e950000,0,0x3e950000,0x3f0e0000,0x3f460000,0,0x3ef10000,0x3f550000,0x3f7f0000,0,0x3f220000,0x3f7b0000,0x3f620000
.long 0,0x3f460000,0x3f7b0000,0x3ef10000,0,0x3f620000,0x3f550000,0xbdc90000,0,0x3f750000,0x3f0e0000,0xbf220000,0,0x3f7f0000,0x3e480000,0xbf750000
.long 0,0x3f7f0000,0xbe480000,0xbf750000,0,0x3f750000,0xbf0e0000,0xbf220000,0,0x3f620000,0xbf550000,0xbdc90000,0,0x3f460000,0xbf7b0000,0x3ef10000
.long 0,0x3f220000,0xbf7b0000,0x3f620000,0,0x3ef10000,0xbf550000,0x3f7f0000,0,0x3e950000,0xbf0e0000,0x3f460000,0,0x3dc90000,0xbe480000,0x3e950000
.long 0x3ec40000,0x3ef10000,0x3f0e0000,0x3f220000,0x3f6d0000,0x3f7f0000,0x3f7b0000,0x3f620000,0x3f6d0000,0x3f220000,0x3e480000,0xbe950000,0x3ec40000,0xbe950000,0xbf550000,0xbf7f0000
.long 0xbec40000,0xbf750000,0xbf550000,0xbdc90000,0xbf6d0000,0xbf460000,0x3e480000,0x3f750000,0xbf6d0000,0x3dc90000,0x3f7b0000,0x3ef10000,0xbec40000,0x3f620000,0x3f0e0000,0xbf460000
.long 0x3ec40000,0x3f620000,0xbf0e0000,0xbf460000,0x3f6d0000,0x3dc90000,0xbf7b0000,0x3ef10000,0x3f6d0000,0xbf460000,0xbe480000,0x3f750000,0x3ec40000,0xbf750000,0x3f550000,0xbdc90000
.long 0xbec40000,0xbe950000,0x3f550000,0xbf7f0000,0xbf6d0000,0x3f220000,0xbe480000,0xbe950000,0xbf6d0000,0x3f7f0000,0xbf7b0000,0x3f620000,0xbec40000,0x3ef10000,0xbf0e0000,0x3f220000
.long 0x3f350000,0x3f460000,0x3f550000,0x3f620000,0x3f350000,0x3ef10000,0x3e480000,0xbdc90000,0xbf350000,0xbf750000,0xbf7b0000,0xbf460000,0xbf350000,0xbdc90000,0x3f0e0000,0x3f750000
.long 0x3f350000,0x3f7f0000,0x3f0e0000,0xbe950000,0x3f350000,0xbe950000,0xbf7b0000,0xbf220000,0xbf350000,0xbf620000,0x3e480000,0x3f7f0000,0xbf350000,0x3f220000,0x3f550000,0xbef10000
.long 0x3f350000,0x3f220000,0xbf550000,0xbef10000,0x3f350000,0xbf620000,0xbe480000,0x3f7f0000,0xbf350000,0xbe950000,0x3f7b0000,0xbf220000,0xbf350000,0x3f7f0000,0xbf0e0000,0xbe950000
.long 0x3f350000,0xbdc90000,0xbf0e0000,0x3f750000,0x3f350000,0xbf750000,0x3f7b0000,0xbf460000,0xbf350000,0x3ef10000,0xbe480000,0xbdc90000,0xbf350000,0x3f460000,0xbf550000,0x3f620000
.long 0x3f6d0000,0x3f750000,0x3f7b0000,0x3f7f0000,0xbec40000,0xbf220000,0xbf550000,0xbf750000,0xbec40000,0x3dc90000,0x3f0e0000,0x3f620000,0x3f6d0000,0x3ef10000,0xbe480000,0xbf460000
.long 0xbf6d0000,0xbf620000,0xbe480000,0x3f220000,0x3ec40000,0x3f7f0000,0x3f0e0000,0xbef10000,0x3ec40000,0xbf460000,0xbf550000,0x3e950000,0xbf6d0000,0x3e950000,0x3f7b0000,0xbdc90000
.long 0x3f6d0000,0x3e950000,0xbf7b0000,0xbdc90000,0xbec40000,0xbf460000,0x3f550000,0x3e950000,0xbec40000,0x3f7f0000,0xbf0e0000,0xbef10000,0x3f6d0000,0xbf620000,0x3e480000,0x3f220000
.long 0xbf6d0000,0x3ef10000,0x3e480000,0xbf460000,0x3ec40000,0x3dc90000,0xbf0e0000,0x3f620000,0x3ec40000,0xbf220000,0x3f550000,0xbf750000,0xbf6d0000,0x3f750000,0xbf7b0000,0x3f7f0000
.long 0x3f800000,0x3f7f0000,0x3f7b0000,0x3f750000,0xbf800000,0xbf750000,0xbf550000,0xbf220000,0x3f800000,0x3f620000,0x3f0e0000,0x3dc90000,0xbf800000,0xbf460000,0xbe480000,0x3ef10000
.long 0x3f800000,0x3f220000,0xbe480000,0xbf620000,0xbf800000,0xbef10000,0x3f0e0000,0x3f7f0000,0x3f800000,0x3e950000,0xbf550000,0xbf460000,0xbf800000,0xbdc90000,0x3f7b0000,0x3e950000
.long 0x3f800000,0xbdc90000,0xbf7b0000,0x3e950000,0xbf800000,0x3e950000,0x3f550000,0xbf460000,0x3f800000,0xbef10000,0xbf0e0000,0x3f7f0000,0xbf800000,0x3f220000,0x3e480000,0xbf620000
.long 0x3f800000,0xbf460000,0x3e480000,0x3ef10000,0xbf800000,0x3f620000,0xbf0e0000,0x3dc90000,0x3f800000,0xbf750000,0x3f550000,0xbf220000,0xbf800000,0x3f7f0000,0xbf7b0000,0x3f750000
.long 0x3f6d0000,0x3f620000,0x3f550000,0x3f460000,0xbec40000,0xbdc90000,0x3e480000,0x3ef10000,0xbec40000,0xbf460000,0xbf7b0000,0xbf750000,0x3f6d0000,0x3f750000,0x3f0e0000,0xbdc90000
.long 0xbf6d0000,0xbe950000,0x3f0e0000,0x3f7f0000,0x3ec40000,0xbf220000,0xbf7b0000,0xbe950000,0x3ec40000,0x3f7f0000,0x3e480000,0xbf620000,0xbf6d0000,0xbef10000,0x3f550000,0x3f220000
.long 0x3f6d0000,0xbef10000,0xbf550000,0x3f220000,0xbec40000,0x3f7f0000,0xbe480000,0xbf620000,0xbec40000,0xbf220000,0x3f7b0000,0xbe950000,0x3f6d0000,0xbe950000,0xbf0e0000,0x3f7f0000
.long 0xbf6d0000,0x3f750000,0xbf0e0000,0xbdc90000,0x3ec40000,0xbf460000,0x3f7b0000,0xbf750000,0x3ec40000,0xbdc90000,0xbe480000,0x3ef10000,0xbf6d0000,0x3f620000,0xbf550000,0x3f460000
.long 0x3f350000,0x3f220000,0x3f0e0000,0x3ef10000,0x3f350000,0x3f620000,0x3f7b0000,0x3f7f0000,0xbf350000,0xbe950000,0x3e480000,0x3f220000,0xbf350000,0xbf7f0000,0xbf550000,0xbe950000
.long 0x3f350000,0xbdc90000,0xbf550000,0xbf750000,0x3f350000,0x3f750000,0x3e480000,0xbf460000,0xbf350000,0x3ef10000,0x3f7b0000,0x3dc90000,0xbf350000,0xbf460000,0x3f0e0000,0x3f620000
.long 0x3f350000,0xbf460000,0xbf0e0000,0x3f620000,0x3f350000,0x3ef10000,0xbf7b0000,0x3dc90000,0xbf350000,0x3f750000,0xbe480000,0xbf460000,0xbf350000,0xbdc90000,0x3f550000,0xbf750000
.long 0x3f350000,0xbf7f0000,0x3f550000,0xbe950000,0x3f350000,0xbe950000,0xbe480000,0x3f220000,0xbf350000,0x3f620000,0xbf7b0000,0x3f7f0000,0xbf350000,0x3f220000,0xbf0e0000,0x3ef10000
.long 0x3ec40000,0x3e950000,0x3e480000,0x3dc90000,0x3f6d0000,0x3f460000,0x3f0e0000,0x3e950000,0x3f6d0000,0x3f7f0000,0x3f550000,0x3ef10000,0x3ec40000,0x3f620000,0x3f7b0000,0x3f220000
.long 0xbec40000,0x3ef10000,0x3f7b0000,0x3f460000,0xbf6d0000,0xbdc90000,0x3f550000,0x3f620000,0xbf6d0000,0xbf220000,0x3f0e0000,0x3f750000,0xbec40000,0xbf750000,0x3e480000,0x3f7f0000
.long 0x3ec40000,0xbf750000,0xbe480000,0x3f7f0000,0x3f6d0000,0xbf220000,0xbf0e0000,0x3f750000,0x3f6d0000,0xbdc90000,0xbf550000,0x3f620000,0x3ec40000,0x3ef10000,0xbf7b0000,0x3f460000
.long 0xbec40000,0x3f620000,0xbf7b0000,0x3f220000,0xbf6d0000,0x3f7f0000,0xbf550000,0x3ef10000,0xbf6d0000,0x3f460000,0xbf0e0000,0x3e950000,0xbec40000,0x3e950000,0xbe480000,0x3dc90000
.long 0x3f803f80,0x3f803f80,0x3f80,0,0x3f7b3f80,0x3f553f6d,0x3e48bf80,0x3f0e3ec4,0x3f6d3f80,0x3ec43f35,0x3ec43f80,0x3f6d3f35,0x3f553f80,0xbe483ec4,0x3f0ebf80,0x3f7b3f6d
.long 0x3f353f80,0xbf350000,0x3f353f80,0x3f353f80,0x3f0e3f80,0xbf7bbec4,0x3f55bf80,0x3e483f6d,0x3ec43f80,0xbf6dbf35,0x3f6d3f80,0xbec43f35,0x3e483f80,0xbf0ebf6d,0x3f7bbf80,0xbf553ec4
.long 0x3f80,0xbf80,0x3f803f80,0xbf800000,0xbe483f80,0x3f0ebf6d,0x3f7bbf80,0xbf55bec4,0xbec43f80,0x3f6dbf35,0x3f6d3f80,0xbec4bf35,0xbf0e3f80,0x3f7bbec4,0x3f55bf80,0x3e48bf6d
.long 0xbf353f80,0x3f350000,0x3f353f80,0x3f35bf80,0xbf553f80,0x3e483ec4,0x3f0ebf80,0x3f7bbf6d,0xbf6d3f80,0xbec43f35,0x3ec43f80,0x3f6dbf35,0xbf7b3f80,0xbf553f6d,0x3e48bf80,0x3f0ebec4
.long 0x3f803f80,0x3f803f80,0,0,0x3f0e3f35,0x3e483ec4,0x3f553f35,0x3f7b3f6d,0xbec40000,0xbf6dbf35,0x3f6d3f80,0x3ec43f35,0xbf7bbf35,0xbf0ebf6d,0x3e483f35,0xbf55bec4
.long 0xbf35bf80,0x3f350000,0xbf350000,0xbf35bf80,0x3e48bf35,0x3f553f6d,0xbf7bbf35,0x3f0ebec4,0x3f6d0000,0xbec43f35,0xbec4bf80,0x3f6d3f35,0x3f553f35,0xbf7bbec4,0x3f0ebf35,0xbe483f6d
.long 0x3f80,0xbf80,0x3f800000,0xbf800000,0xbf553f35,0x3f7bbec4,0x3f0e3f35,0xbe48bf6d,0xbf6d0000,0x3ec43f35,0xbec43f80,0x3f6dbf35,0xbe48bf35,0xbf553f6d,0xbf7b3f35,0x3f0e3ec4
.long 0x3f35bf80,0xbf350000,0xbf350000,0xbf353f80,0x3f7bbf35,0x3f0ebf6d,0x3e48bf35,0xbf553ec4,0x3ec40000,0x3f6dbf35,0x3f6dbf80,0x3ec4bf35,0xbf0e3f35,0xbe483ec4,0x3f55bf35,0x3f7bbf6d
.long 0x3f803f80,0x3f803f80,0,0,0xbe480000,0xbf0ebec4,0x3f7b3f80,0x3f553f6d,0xbf6dbf80,0xbec4bf35,0xbec40000,0xbf6dbf35,0x3f0e0000,0x3f7b3f6d,0xbf55bf80,0x3e48bec4
.long 0x3f353f80,0xbf350000,0x3f350000,0x3f353f80,0xbf550000,0xbe48bf6d,0x3f0e3f80,0xbf7bbec4,0xbec4bf80,0x3f6d3f35,0xbf6d0000,0x3ec4bf35,0x3f7b0000,0xbf553ec4,0xbe48bf80,0x3f0e3f6d
.long 0x3f80,0xbf80,0x3f800000,0xbf800000,0xbf7b0000,0x3f553ec4,0xbe483f80,0x3f0ebf6d,0x3ec4bf80,0xbf6d3f35,0xbf6d0000,0x3ec43f35,0x3f550000,0x3e48bf6d,0x3f0ebf80,0xbf7b3ec4
.long 0xbf353f80,0x3f350000,0x3f350000,0x3f35bf80,0xbf0e0000,0xbf7b3f6d,0xbf553f80,0x3e483ec4,0x3f6dbf80,0x3ec4bf35,0xbec40000,0xbf6d3f35,0x3e480000,0x3f0ebec4,0x3f7bbf80,0x3f55bf6d
.long 0x3f803f80,0x3f803f80,0,0,0xbf55bf35,0xbf7bbf6d,0x3f0e3f35,0x3e483ec4,0x3ec40000,0x3f6d3f35,0xbf6dbf80,0xbec4bf35,0x3e483f35,0xbf55bec4,0x3f7b3f35,0x3f0e3f6d
.long 0xbf35bf80,0x3f350000,0xbf350000,0xbf35bf80,0x3f7b3f35,0xbf0e3ec4,0x3e48bf35,0x3f553f6d,0xbf6d0000,0x3ec4bf35,0x3ec43f80,0xbf6dbf35,0x3f0ebf35,0xbe483f6d,0xbf55bf35,0x3f7b3ec4
.long 0x3f80,0xbf80,0x3f800000,0xbf800000,0xbf0ebf35,0x3e483f6d,0xbf553f35,0x3f7bbec4,0x3f6d0000,0xbec4bf35,0x3ec4bf80,0xbf6d3f35,0xbf7b3f35,0x3f0e3ec4,0x3e483f35,0x3f55bf6d
.long 0x3f35bf80,0xbf350000,0xbf350000,0xbf353f80,0xbe483f35,0x3f55bec4,0x3f7bbf35,0x3f0ebf6d,0xbec40000,0xbf6d3f35,0xbf6d3f80,0xbec43f35,0x3f55bf35,0x3f7bbf6d,0x3f0ebf35,0x3e48bec4
.long 0,0,0,0,0,0,0,0,0,0,0,0,0,0,0,0
.long 0,0,0,0,0,0,0,0,0,0,0,0,0,0,0,0
.long 0,0,0,0,0,0,0,0,0,0,0,0,0,0,0,0
.long 0,0,0,0,0,0,0,0,0,0,0,0,0,0,0,0
.long 0,0,0,0,0,0,0,0,0,0,0,0,0,0,0,0
.long 0,0,0,0,0,0,0,0,0,0,0,0,0,0,0,0
.long 0,0,0,0,0,0,0,0,0,0,0,0,0,0,0,0
.long 0,0,0,0,0,0,0,0,0,0,0,0,0,0,0,0
.long 0,0,0,0,0,0,0,0,0,0,0,0,0,0,0,0
.long 0,0,0,0,0,0,0,0,0,0,0,0,0,0,0,0
.long 0,0,0,0,0,0,0,0,0,0,0,0,0,0,0,0
.long 0,0,0,0,0,0,0,0,0,0,0,0,0,0,0,0
.long 0,0,0,0,0,0,0,0,0,0,0,0,0,0,0,0
.long 0,0,0,0,0,0,0,0,0,0,0,0,0,0,0,0
.long 0,0,0,0,0,0,0,0,0,0,0,0,0,0,0,0
.long 0,0,0,0,0,0,0,0,0,0,0,0,0,0,0,0
.long 0xbf803f80,0xbf803f80,0x3f80,0,0xbf7b3f80,0xbf553f6d,0xbe48bf80,0xbf0e3ec4,0xbf6d3f80,0xbec43f35,0xbec43f80,0xbf6d3f35,0xbf553f80,0x3e483ec4,0xbf0ebf80,0xbf7b3f6d
.long 0xbf353f80,0x3f350000,0xbf353f80,0xbf353f80,0xbf0e3f80,0x3f7bbec4,0xbf55bf80,0xbe483f6d,0xbec43f80,0x3f6dbf35,0xbf6d3f80,0x3ec43f35,0xbe483f80,0x3f0ebf6d,0xbf7bbf80,0x3f553ec4
.long 0x3f80,0xbf80,0xbf803f80,0x3f800000,0x3e483f80,0xbf0ebf6d,0xbf7bbf80,0x3f55bec4,0x3ec43f80,0xbf6dbf35,0xbf6d3f80,0x3ec4bf35,0x3f0e3f80,0xbf7bbec4,0xbf55bf80,0xbe48bf6d
.long 0x3f353f80,0xbf350000,0xbf353f80,0xbf35bf80,0x3f553f80,0xbe483ec4,0xbf0ebf80,0xbf7bbf6d,0x3f6d3f80,0x3ec43f35,0xbec43f80,0xbf6dbf35,0x3f7b3f80,0x3f553f6d,0xbe48bf80,0xbf0ebec4
.long 0xbf803f80,0xbf803f80,0,0,0xbf0e3f35,0xbe483ec4,0xbf553f35,0xbf7b3f6d,0x3ec40000,0x3f6dbf35,0xbf6d3f80,0xbec43f35,0x3f7bbf35,0x3f0ebf6d,0xbe483f35,0x3f55bec4
.long 0x3f35bf80,0xbf350000,0x3f350000,0x3f35bf80,0xbe48bf35,0xbf553f6d,0x3f7bbf35,0xbf0ebec4,0xbf6d0000,0x3ec43f35,0x3ec4bf80,0xbf6d3f35,0xbf553f35,0x3f7bbec4,0xbf0ebf35,0x3e483f6d
.long 0x3f80,0xbf80,0xbf800000,0x3f800000,0x3f553f35,0xbf7bbec4,0xbf0e3f35,0x3e48bf6d,0x3f6d0000,0xbec43f35,0x3ec43f80,0xbf6dbf35,0x3e48bf35,0x3f553f6d,0x3f7b3f35,0xbf0e3ec4
.long 0xbf35bf80,0x3f350000,0x3f350000,0x3f353f80,0xbf7bbf35,0xbf0ebf6d,0xbe48bf35,0x3f553ec4,0xbec40000,0xbf6dbf35,0xbf6dbf80,0xbec4bf35,0x3f0e3f35,0x3e483ec4,0xbf55bf35,0xbf7bbf6d
.long 0xbf803f80,0xbf803f80,0,0,0x3e480000,0x3f0ebec4,0xbf7b3f80,0xbf553f6d,0x3f6dbf80,0x3ec4bf35,0x3ec40000,0x3f6dbf35,0xbf0e0000,0xbf7b3f6d,0x3f55bf80,0xbe48bec4
.long 0xbf353f80,0x3f350000,0xbf350000,0xbf353f80,0x3f550000,0x3e48bf6d,0xbf0e3f80,0x3f7bbec4,0x3ec4bf80,0xbf6d3f35,0x3f6d0000,0xbec4bf35,0xbf7b0000,0x3f553ec4,0x3e48bf80,0xbf0e3f6d
.long 0x3f80,0xbf80,0xbf800000,0x3f800000,0x3f7b0000,0xbf553ec4,0x3e483f80,0xbf0ebf6d,0xbec4bf80,0x3f6d3f35,0x3f6d0000,0xbec43f35,0xbf550000,0xbe48bf6d,0xbf0ebf80,0x3f7b3ec4
.long 0x3f353f80,0xbf350000,0xbf350000,0xbf35bf80,0x3f0e0000,0x3f7b3f6d,0x3f553f80,0xbe483ec4,0xbf6dbf80,0xbec4bf35,0x3ec40000,0x3f6d3f35,0xbe480000,0xbf0ebec4,0xbf7bbf80,0xbf55bf6d
.long 0xbf803f80,0xbf803f80,0,0,0x3f55bf35,0x3f7bbf6d,0xbf0e3f35,0xbe483ec4,0xbec40000,0xbf6d3f35,0x3f6dbf80,0x3ec4bf35,0xbe483f35,0x3f55bec4,0xbf7b3f35,0xbf0e3f6d
.long 0x3f35bf80,0xbf350000,0x3f350000,0x3f35bf80,0xbf7b3f35,0x3f0e3ec4,0xbe48bf35,0xbf553f6d,0x3f6d0000,0xbec4bf35,0xbec43f80,0x3f6dbf35,0xbf0ebf35,0x3e483f6d,0x3f55bf35,0xbf7b3ec4
.long 0x3f80,0xbf80,0xbf800000,0x3f800000,0x3f0ebf35,0xbe483f6d,0x3f553f35,0xbf7bbec4,0xbf6d0000,0x3ec4bf35,0xbec4bf80,0x3f6d3f35,0x3f7b3f35,0xbf0e3ec4,0xbe483f35,0xbf55bf6d
.long 0xbf35bf80,0x3f350000,0x3f350000,0x3f353f80,0x3e483f35,0xbf55bec4,0xbf7bbf35,0xbf0ebf6d,0x3ec40000,0x3f6d3f35,0x3f6d3f80,0x3ec43f35,0xbf55bf35,0xbf7bbf6d,0xbf0ebf35,0xbe48bec4
.long 0,0,0,0,0,0,0,0,0,0,0,0,0,0,0,0
.long 0,0,0,0,0,0,0,0,0,0,0,0,0,0,0,0
.long 0,0,0,0,0,0,0,0,0,0,0,0,0,0,0,0
.long 0,0,0,0,0,0,0,0,0,0,0,0,0,0,0,0
.long 0,0,0,0,0,0,0,0,0,0,0,0,0,0,0,0
.long 0,0,0,0,0,0,0,0,0,0,0,0,0,0,0,0
.long 0,0,0,0,0,0,0,0,0,0,0,0,0,0,0,0
.long 0,0,0,0,0,0,0,0,0,0,0,0,0,0,0,0
.long 0,0,0,0,0,0,0,0,0,0,0,0,0,0,0,0
.long 0,0,0,0,0,0,0,0,0,0,0,0,0,0,0,0
.long 0,0,0,0,0,0,0,0,0,0,0,0,0,0,0,0
.long 0,0,0,0,0,0,0,0,0,0,0,0,0,0,0,0
.long 0,0,0,0,0,0,0,0,0,0,0,0,0,0,0,0
.long 0,0,0,0,0,0,0,0,0,0,0,0,0,0,0,0
.long 0,0,0,0,0,0,0,0,0,0,0,0,0,0,0,0
.long 0,0,0,0,0,0,0,0,0,0,0,0,0,0,0,0
.long 0,0,0,0,0,0,0,0,0,0,0,0,0,0,0,0
.long 0,0,0,0,0,0,0,0,0,0,0,0,0,0,0,0
.long 0,0,0,0,0,0,0,0,0,0,0,0,0,0,0,0
.long 0,0,0,0,0,0,0,0,0,0,0,0,0,0,0,0
.long 0,0,0,0,0,0,0,0,0,0,0,0,0,0,0,0
.long 0,0,0,0,0,0,0,0,0,0,0,0,0,0,0,0
.long 0,0,0,0,0,0,0,0,0,0,0,0,0,0,0,0
.long 0,0,0,0,0,0,0,0,0,0,0,0,0,0,0,0
.long 0,0,0,0,0,0,0,0,0,0,0,0,0,0,0,0
.long 0,0,0,0,0,0,0,0,0,0,0,0,0,0,0,0
.long 0,0,0,0,0,0,0,0,0,0,0,0,0,0,0,0
.long 0,0,0,0,0,0,0,0,0,0,0,0,0,0,0,0
.long 0,0,0,0,0,0,0,0,0,0,0,0,0,0,0,0
.long 0,0,0,0,0,0,0,0,0,0,0,0,0,0,0,0
.long 0,0,0,0,0,0,0,0,0,0,0,0,0,0,0,0
.long 0,0,0,0,0,0,0,0,0,0,0,0,0,0,0,0
.long 0x3f803f80,0x3f803f80,0,0,0x3f753f7f,0x3f463f62,0x3e953dc9,0x3f223ef1,0x3f553f7b,0x3e483f0e,0x3f0e3e48,0x3f7b3f55,0x3f223f75,0xbef13dc9,0x3f463e95,0x3f623f7f
.long 0x3ec43f6d,0xbf6dbec4,0x3f6d3ec4,0x3ec43f6d,0x3dc93f62,0xbf75bf46,0x3f7f3ef1,0xbe953f22,0xbe483f55,0xbf0ebf7b,0x3f7b3f0e,0xbf553e48,0xbef13f46,0x3dc9bf75,0x3f623f22,0xbf7fbe95
.long 0xbf353f35,0x3f35bf35,0x3f353f35,0xbf35bf35,0xbf623f22,0x3f7fbe95,0x3ef13f46,0xbdc9bf75,0xbf7b3f0e,0x3f553e48,0x3e483f55,0x3f0ebf7b,0xbf7f3ef1,0x3e953f22,0xbdc93f62,0x3f75bf46
.long 0xbf6d3ec4,0xbec43f6d,0xbec43f6d,0x3f6dbec4,0xbf463e95,0xbf623f7f,0xbf223f75,0x3ef13dc9,0xbf0e3e48,0xbf7b3f55,0xbf553f7b,0xbe483f0e,0xbe953dc9,0xbf223ef1,0xbf753f7f,0xbf463f62
.long 0x3f803f80,0x3f803f80,0,0,0x3ef13f22,0x3dc93e95,0x3f623f46,0x3f7f3f75,0xbf0ebe48,0xbf7bbf55,0x3f553f7b,0x3e483f0e,0xbf7fbf62,0xbe95bf46,0xbdc93ef1,0xbf75bf22
.long 0xbec4bf6d,0x3f6d3ec4,0xbf6dbec4,0xbec4bf6d,0x3f22be95,0x3ef13f7f,0xbf46bf75,0x3f623dc9,0x3f7b3f0e,0xbf553e48,0x3e48bf55,0x3f0e3f7b,0x3e953f7f,0xbf22bf62,0x3f75bdc9,0xbf463ef1
.long 0xbf353f35,0x3f35bf35,0x3f353f35,0xbf35bf35,0xbf75bdc9,0x3f463ef1,0xbe953f7f,0x3f22bf62,0xbe48bf55,0xbf0e3f7b,0xbf7b3f0e,0x3f553e48,0x3f46bf75,0xbf623dc9,0xbf22be95,0xbef13f7f
.long 0x3f6dbec4,0x3ec4bf6d,0x3ec4bf6d,0xbf6d3ec4,0x3dc93ef1,0x3f75bf22,0x3f7fbf62,0x3e95bf46,0xbf553f7b,0xbe483f0e,0x3f0ebe48,0x3f7bbf55,0xbf623f46,0xbf7f3f75,0xbef13f22,0xbdc93e95
.long 0x3f803f80,0x3f803f80,0,0,0xbe95bdc9,0xbf22bef1,0x3f753f7f,0x3f463f62,0xbf55bf7b,0xbe48bf0e,0xbf0ebe48,0xbf7bbf55,0x3f463e95,0x3f623f7f,0xbf22bf75,0x3ef1bdc9
.long 0x3ec43f6d,0xbf6dbec4,0x3f6d3ec4,0x3ec43f6d,0xbf7fbef1,0x3e95bf22,0x3dc93f62,0xbf75bf46,0x3e48bf55,0x3f0e3f7b,0xbf7bbf0e,0x3f55be48,0x3f623f22,0xbf7fbe95,0x3ef1bf46,0xbdc93f75
.long 0xbf353f35,0x3f35bf35,0x3f353f35,0xbf35bf35,0xbef1bf46,0x3dc93f75,0xbf623f22,0x3f7fbe95,0x3f7bbf0e,0xbf55be48,0xbe48bf55,0xbf0e3f7b,0xbdc93f62,0x3f75bf46,0x3f7fbef1,0xbe95bf22
.long 0xbf6d3ec4,0xbec43f6d,0xbec43f6d,0x3f6dbec4,0x3f22bf75,0xbef1bdc9,0xbf463e95,0xbf623f7f,0x3f0ebe48,0x3f7bbf55,0x3f55bf7b,0x3e48bf0e,0xbf753f7f,0xbf463f62,0x3e95bdc9,0x3f22bef1
.long 0x3f803f80,0x3f803f80,0,0,0xbf62bf46,0xbf7fbf75,0x3ef13f22,0x3dc93e95,0x3f0e3e48,0x3f7b3f55,0xbf55bf7b,0xbe48bf0e,0xbdc93ef1,0xbf75bf22,0x3f7f3f62,0x3e953f46
.long 0xbec4bf6d,0x3f6d3ec4,0xbf6dbec4,0xbec4bf6d,0x3f463f75,0xbf62bdc9,0x3f22be95,0x3ef13f7f,0xbf7bbf0e,0x3f55be48,0xbe483f55,0xbf0ebf7b,0x3f75bdc9,0xbf463ef1,0xbe95bf7f,0x3f223f62
.long 0xbf353f35,0x3f35bf35,0x3f353f35,0xbf35bf35,0x3e95bf7f,0xbf223f62,0xbf75bdc9,0x3f463ef1,0x3e483f55,0x3f0ebf7b,0x3f7bbf0e,0xbf55be48,0xbf22be95,0xbef13f7f,0xbf463f75,0x3f62bdc9
.long 0x3f6dbec4,0x3ec4bf6d,0x3ec4bf6d,0xbf6d3ec4,0xbf7f3f62,0xbe953f46,0x3dc93ef1,0x3f75bf22,0x3f55bf7b,0x3e48bf0e,0xbf0e3e48,0xbf7b3f55,0xbef13f22,0xbdc93e95,0x3f62bf46,0x3f7fbf75
.long 0,0,0,0,0,0,0,0,0,0,0,0,0,0,0,0
.long 0,0,0,0,0,0,0,0,0,0,0,0,0,0,0,0
.long 0,0,0,0,0,0,0,0,0,0,0,0,0,0,0,0
.long 0,0,0,0,0,0,0,0,0,0,0,0,0,0,0,0
.long 0,0,0,0,0,0,0,0,0,0,0,0,0,0,0,0
.long 0,0,0,0,0,0,0,0,0,0,0,0,0,0,0,0
.long 0,0,0,0,0,0,0,0,0,0,0,0,0,0,0,0
.long 0,0,0,0,0,0,0,0,0,0,0,0,0,0,0,0
.long 0,0,0,0,0,0,0,0,0,0,0,0,0,0,0,0
.long 0,0,0,0,0,0,0,0,0,0,0,0,0,0,0,0
.long 0,0,0,0,0,0,0,0,0,0,0,0,0,0,0,0
.long 0,0,0,0,0,0,0,0,0,0,0,0,0,0,0,0
.long 0,0,0,0,0,0,0,0,0,0,0,0,0,0,0,0
.long 0,0,0,0,0,0,0,0,0,0,0,0,0,0,0,0
.long 0,0,0,0,0,0,0,0,0,0,0,0,0,0,0,0
.long 0,0,0,0,0,0,0,0,0,0,0,0,0,0,0,0
.long 0,0,0xbf803f80,0xbf803f80,0x3e95bdc9,0x3f22bef1,0xbf753f7f,0xbf463f62,0x3f0ebe48,0x3f7bbf55,0xbf553f7b,0xbe483f0e,0x3f46be95,0x3f62bf7f,0xbf223f75,0x3ef13dc9
.long 0x3f6dbec4,0x3ec4bf6d,0xbec43f6d,0x3f6dbec4,0x3f7fbef1,0xbe95bf22,0xbdc93f62,0x3f75bf46,0x3f7bbf0e,0xbf55be48,0x3e483f55,0x3f0ebf7b,0x3f62bf22,0xbf7f3e95,0x3ef13f46,0xbdc9bf75
.long 0x3f35bf35,0xbf353f35,0x3f353f35,0xbf35bf35,0x3ef1bf46,0xbdc93f75,0x3f623f22,0xbf7fbe95,0x3e48bf55,0x3f0e3f7b,0x3f7b3f0e,0xbf553e48,0xbdc9bf62,0x3f753f46,0x3f7f3ef1,0xbe953f22
.long 0xbec4bf6d,0x3f6d3ec4,0x3f6d3ec4,0x3ec43f6d,0xbf22bf75,0x3ef1bdc9,0x3f463e95,0x3f623f7f,0xbf55bf7b,0xbe48bf0e,0x3f0e3e48,0x3f7b3f55,0xbf75bf7f,0xbf46bf62,0x3e953dc9,0x3f223ef1
.long 0,0,0xbf803f80,0xbf803f80,0x3f62bf46,0x3f7fbf75,0xbef13f22,0xbdc93e95,0x3f55bf7b,0x3e48bf0e,0x3f0ebe48,0x3f7bbf55,0xbdc9bef1,0xbf753f22,0x3f7fbf62,0x3e95bf46
.long 0xbf6d3ec4,0xbec43f6d,0x3ec4bf6d,0xbf6d3ec4,0xbf463f75,0x3f62bdc9,0xbf22be95,0xbef13f7f,0x3e483f55,0x3f0ebf7b,0xbf7b3f0e,0x3f553e48,0x3f753dc9,0xbf46bef1,0xbe953f7f,0x3f22bf62
.long 0x3f35bf35,0xbf353f35,0x3f353f35,0xbf35bf35,0xbe95bf7f,0x3f223f62,0x3f75bdc9,0xbf463ef1,0xbf7bbf0e,0x3f55be48,0x3e48bf55,0x3f0e3f7b,0xbf223e95,0xbef1bf7f,0xbf46bf75,0x3f623dc9
.long 0x3ec43f6d,0xbf6dbec4,0xbf6dbec4,0xbec4bf6d,0x3f7f3f62,0x3e953f46,0xbdc93ef1,0xbf75bf22,0x3f0e3e48,0x3f7b3f55,0x3f553f7b,0x3e483f0e,0xbef1bf22,0xbdc9be95,0x3f623f46,0x3f7f3f75
.long 0,0,0xbf803f80,0xbf803f80,0x3f75bf7f,0x3f46bf62,0x3e95bdc9,0x3f22bef1,0xbf0e3e48,0xbf7b3f55,0x3f55bf7b,0x3e48bf0e,0xbf223f75,0x3ef13dc9,0xbf463e95,0xbf623f7f
.long 0x3f6dbec4,0x3ec4bf6d,0xbec43f6d,0x3f6dbec4,0x3dc9bf62,0xbf753f46,0x3f7fbef1,0xbe95bf22,0xbf7b3f0e,0x3f553e48,0xbe48bf55,0xbf0e3f7b,0x3ef13f46,0xbdc9bf75,0xbf623f22,0x3f7fbe95
.long 0x3f35bf35,0xbf353f35,0x3f353f35,0xbf35bf35,0xbf62bf22,0x3f7f3e95,0x3ef1bf46,0xbdc93f75,0xbe483f55,0xbf0ebf7b,0xbf7bbf0e,0x3f55be48,0x3f7f3ef1,0xbe953f22,0x3dc93f62,0xbf75bf46
.long 0xbec4bf6d,0x3f6d3ec4,0x3f6d3ec4,0x3ec43f6d,0xbf46be95,0xbf62bf7f,0xbf22bf75,0x3ef1bdc9,0x3f553f7b,0x3e483f0e,0xbf0ebe48,0xbf7bbf55,0x3e953dc9,0x3f223ef1,0x3f753f7f,0x3f463f62
.long 0,0,0xbf803f80,0xbf803f80,0x3ef1bf22,0x3dc9be95,0x3f62bf46,0x3f7fbf75,0xbf553f7b,0xbe483f0e,0xbf0e3e48,0xbf7b3f55,0x3f7fbf62,0x3e95bf46,0x3dc93ef1,0x3f75bf22
.long 0xbf6d3ec4,0xbec43f6d,0x3ec4bf6d,0xbf6d3ec4,0x3f223e95,0x3ef1bf7f,0xbf463f75,0x3f62bdc9,0xbe48bf55,0xbf0e3f7b,0x3f7bbf0e,0xbf55be48,0xbe953f7f,0x3f22bf62,0xbf75bdc9,0x3f463ef1
.long 0x3f35bf35,0xbf353f35,0x3f353f35,0xbf35bf35,0xbf753dc9,0x3f46bef1,0xbe95bf7f,0x3f223f62,0x3f7b3f0e,0xbf553e48,0xbe483f55,0xbf0ebf7b,0xbf46bf75,0x3f623dc9,0x3f22be95,0x3ef13f7f
.long 0x3ec43f6d,0xbf6dbec4,0xbf6dbec4,0xbec4bf6d,0x3dc9bef1,0x3f753f22,0x3f7f3f62,0x3e953f46,0xbf0ebe48,0xbf7bbf55,0xbf55bf7b,0xbe48bf0e,0x3f623f46,0x3f7f3f75,0x3ef13f22,0x3dc93e95
.long 0x3f803f80,0x3f803f80,0x3f803f80,0x3f803f80,0xbf803f80,0xbf803f80,0xbf803f80,0xbf803f80,0x3f7f3f80,0x3f753f7b,0xbdc90000,0xbe95be48,0x3dc90000,0x3e953e48,0x3f7f3f80,0x3f753f7b
.long 0x3f7b3f80,0x3f553f6d,0xbf7bbf80,0xbf55bf6d,0x3e480000,0x3f0e3ec4,0xbe480000,0xbf0ebec4,0x3f753f80,0x3f223f55,0x3e950000,0x3f463f0e,0x3e950000,0x3f463f0e,0xbf75bf80,0xbf22bf55
.long 0x3f6d3f80,0x3ec43f35,0x3f6d3f80,0x3ec43f35,0x3ec40000,0x3f6d3f35,0x3ec40000,0x3f6d3f35,0x3f623f80,0x3dc93f0e,0xbef10000,0xbf7fbf55,0x3ef10000,0x3f7f3f55,0x3f623f80,0x3dc93f0e
.long 0x3f553f80,0xbe483ec4,0xbf55bf80,0x3e48bec4,0x3f0e0000,0x3f7b3f6d,0xbf0e0000,0xbf7bbf6d,0x3f463f80,0xbef13e48,0x3f220000,0x3f623f7b,0x3f220000,0x3f623f7b,0xbf46bf80,0x3ef1be48
.long 0x3f803f80,0x3f803f80,0x3f803f80,0x3f803f80,0xbf803f80,0xbf803f80,0xbf803f80,0xbf803f80,0x3f623f6d,0x3f463f55,0xbef1bec4,0xbf22bf0e,0x3ef13ec4,0x3f223f0e,0x3f623f6d,0x3f463f55
.long 0x3f0e3f35,0x3e483ec4,0xbf0ebf35,0xbe48bec4,0x3f553f35,0x3f7b3f6d,0xbf55bf35,0xbf7bbf6d,0x3dc93ec4,0xbef1be48,0x3f7f3f6d,0x3f623f7b,0x3f7f3f6d,0x3f623f7b,0xbdc9bec4,0x3ef13e48
.long 0xbec40000,0xbf6dbf35,0xbec40000,0xbf6dbf35,0x3f6d3f80,0x3ec43f35,0x3f6d3f80,0x3ec43f35,0xbf46bec4,0xbf75bf7b,0xbf22bf6d,0x3e95be48,0x3f223f6d,0xbe953e48,0xbf46bec4,0xbf75bf7b
.long 0xbf7bbf35,0xbf0ebf6d,0x3f7b3f35,0x3f0e3f6d,0x3e483f35,0xbf55bec4,0xbe48bf35,0x3f553ec4,0xbf75bf6d,0x3dc9bf0e,0xbe953ec4,0xbf7fbf55,0xbe953ec4,0xbf7fbf55,0x3f753f6d,0xbdc93f0e
.long 0x3f803f80,0x3f803f80,0x3f803f80,0x3f803f80,0xbf803f80,0xbf803f80,0xbf803f80,0xbf803f80,0x3f223f35,0x3ef13f0e,0xbf46bf35,0xbf62bf55,0x3f463f35,0x3f623f55,0x3f223f35,0x3ef13f0e
.long 0xbe480000,0xbf0ebec4,0x3e480000,0x3f0e3ec4,0x3f7b3f80,0x3f553f6d,0xbf7bbf80,0xbf55bf6d,0xbf62bf35,0xbf7fbf7b,0x3ef13f35,0xbdc93e48,0x3ef13f35,0xbdc93e48,0x3f623f35,0x3f7f3f7b
.long 0xbf6dbf80,0xbec4bf35,0xbf6dbf80,0xbec4bf35,0xbec40000,0xbf6dbf35,0xbec40000,0xbf6dbf35,0xbe95bf35,0x3f223e48,0x3f753f35,0x3f463f7b,0xbf75bf35,0xbf46bf7b,0xbe95bf35,0x3f223e48
.long 0x3f0e0000,0x3f7b3f6d,0xbf0e0000,0xbf7bbf6d,0xbf55bf80,0x3e48bec4,0x3f553f80,0xbe483ec4,0x3f7f3f35,0x3e953f55,0xbdc9bf35,0x3f753f0e,0xbdc9bf35,0x3f753f0e,0xbf7fbf35,0xbe95bf55
.long 0x3f803f80,0x3f803f80,0x3f803f80,0x3f803f80,0xbf803f80,0xbf803f80,0xbf803f80,0xbf803f80,0x3e953ec4,0x3dc93e48,0xbf75bf6d,0xbf7fbf7b,0x3f753f6d,0x3f7f3f7b,0x3e953ec4,0x3dc93e48
.long 0xbf55bf35,0xbf7bbf6d,0x3f553f35,0x3f7b3f6d,0x3f0e3f35,0x3e483ec4,0xbf0ebf35,0xbe48bec4,0xbf46bf6d,0xbe95bf0e,0xbf22bec4,0xbf75bf55,0xbf22bec4,0xbf75bf55,0x3f463f6d,0x3e953f0e
.long 0x3ec40000,0x3f6d3f35,0x3ec40000,0x3f6d3f35,0xbf6dbf80,0xbec4bf35,0xbf6dbf80,0xbec4bf35,0x3f7f3f6d,0x3ef13f55,0xbdc93ec4,0xbf62bf0e,0x3dc9bec4,0x3f623f0e,0x3f7f3f6d,0x3ef13f55
.long 0x3e483f35,0xbf55bec4,0xbe48bf35,0x3f553ec4,0x3f7b3f35,0x3f0e3f6d,0xbf7bbf35,0xbf0ebf6d,0xbf62bec4,0xbf22bf7b,0x3ef13f6d,0xbf46be48,0x3ef13f6d,0xbf46be48,0x3f623ec4,0x3f223f7b
.long 0x3f803f80,0x3f803f80,0x3f803f80,0x3f803f80,0xbf803f80,0xbf803f80,0xbf803f80,0xbf803f80,0xbf7fbf80,0xbf75bf7b,0x3dc90000,0x3e953e48,0xbdc90000,0xbe95be48,0xbf7fbf80,0xbf75bf7b
.long 0x3f7b3f80,0x3f553f6d,0xbf7bbf80,0xbf55bf6d,0x3e480000,0x3f0e3ec4,0xbe480000,0xbf0ebec4,0xbf75bf80,0xbf22bf55,0xbe950000,0xbf46bf0e,0xbe950000,0xbf46bf0e,0x3f753f80,0x3f223f55
.long 0x3f6d3f80,0x3ec43f35,0x3f6d3f80,0x3ec43f35,0x3ec40000,0x3f6d3f35,0x3ec40000,0x3f6d3f35,0xbf62bf80,0xbdc9bf0e,0x3ef10000,0x3f7f3f55,0xbef10000,0xbf7fbf55,0xbf62bf80,0xbdc9bf0e
.long 0x3f553f80,0xbe483ec4,0xbf55bf80,0x3e48bec4,0x3f0e0000,0x3f7b3f6d,0xbf0e0000,0xbf7bbf6d,0xbf46bf80,0x3ef1be48,0xbf220000,0xbf62bf7b,0xbf220000,0xbf62bf7b,0x3f463f80,0xbef13e48
.long 0x3f803f80,0x3f803f80,0x3f803f80,0x3f803f80,0xbf803f80,0xbf803f80,0xbf803f80,0xbf803f80,0xbf62bf6d,0xbf46bf55,0x3ef13ec4,0x3f223f0e,0xbef1bec4,0xbf22bf0e,0xbf62bf6d,0xbf46bf55
.long 0x3f0e3f35,0x3e483ec4,0xbf0ebf35,0xbe48bec4,0x3f553f35,0x3f7b3f6d,0xbf55bf35,0xbf7bbf6d,0xbdc9bec4,0x3ef13e48,0xbf7fbf6d,0xbf62bf7b,0xbf7fbf6d,0xbf62bf7b,0x3dc93ec4,0xbef1be48
.long 0xbec40000,0xbf6dbf35,0xbec40000,0xbf6dbf35,0x3f6d3f80,0x3ec43f35,0x3f6d3f80,0x3ec43f35,0x3f463ec4,0x3f753f7b,0x3f223f6d,0xbe953e48,0xbf22bf6d,0x3e95be48,0x3f463ec4,0x3f753f7b
.long 0xbf7bbf35,0xbf0ebf6d,0x3f7b3f35,0x3f0e3f6d,0x3e483f35,0xbf55bec4,0xbe48bf35,0x3f553ec4,0x3f753f6d,0xbdc93f0e,0x3e95bec4,0x3f7f3f55,0x3e95bec4,0x3f7f3f55,0xbf75bf6d,0x3dc9bf0e
.long 0x3f803f80,0x3f803f80,0x3f803f80,0x3f803f80,0xbf803f80,0xbf803f80,0xbf803f80,0xbf803f80,0xbf22bf35,0xbef1bf0e,0x3f463f35,0x3f623f55,0xbf46bf35,0xbf62bf55,0xbf22bf35,0xbef1bf0e
.long 0xbe480000,0xbf0ebec4,0x3e480000,0x3f0e3ec4,0x3f7b3f80,0x3f553f6d,0xbf7bbf80,0xbf55bf6d,0x3f623f35,0x3f7f3f7b,0xbef1bf35,0x3dc9be48,0xbef1bf35,0x3dc9be48,0xbf62bf35,0xbf7fbf7b
.long 0xbf6dbf80,0xbec4bf35,0xbf6dbf80,0xbec4bf35,0xbec40000,0xbf6dbf35,0xbec40000,0xbf6dbf35,0x3e953f35,0xbf22be48,0xbf75bf35,0xbf46bf7b,0x3f753f35,0x3f463f7b,0x3e953f35,0xbf22be48
.long 0x3f0e0000,0x3f7b3f6d,0xbf0e0000,0xbf7bbf6d,0xbf55bf80,0x3e48bec4,0x3f553f80,0xbe483ec4,0xbf7fbf35,0xbe95bf55,0x3dc93f35,0xbf75bf0e,0x3dc93f35,0xbf75bf0e,0x3f7f3f35,0x3e953f55
.long 0x3f803f80,0x3f803f80,0x3f803f80,0x3f803f80,0xbf803f80,0xbf803f80,0xbf803f80,0xbf803f80,0xbe95bec4,0xbdc9be48,0x3f753f6d,0x3f7f3f7b,0xbf75bf6d,0xbf7fbf7b,0xbe95bec4,0xbdc9be48
.long 0xbf55bf35,0xbf7bbf6d,0x3f553f35,0x3f7b3f6d,0x3f0e3f35,0x3e483ec4,0xbf0ebf35,0xbe48bec4,0x3f463f6d,0x3e953f0e,0x3f223ec4,0x3f753f55,0x3f223ec4,0x3f753f55,0xbf46bf6d,0xbe95bf0e
.long 0x3ec40000,0x3f6d3f35,0x3ec40000,0x3f6d3f35,0xbf6dbf80,0xbec4bf35,0xbf6dbf80,0xbec4bf35,0xbf7fbf6d,0xbef1bf55,0x3dc9bec4,0x3f623f0e,0xbdc93ec4,0xbf62bf0e,0xbf7fbf6d,0xbef1bf55
.long 0x3e483f35,0xbf55bec4,0xbe48bf35,0x3f553ec4,0x3f7b3f35,0x3f0e3f6d,0xbf7bbf35,0xbf0ebf6d,0x3f623ec4,0x3f223f7b,0xbef1bf6d,0x3f463e48,0xbef1bf6d,0x3f463e48,0xbf62bec4,0xbf22bf7b
.long 0x3f353f80,0xbf350000,0x3f353f80,0xbf350000,0x3f350000,0x3f353f80,0x3f350000,0x3f353f80,0x3f223f80,0xbf62be48,0xbf460000,0xbef1bf7b,0x3f460000,0x3ef13f7b,0x3f223f80,0xbf62be48
.long 0x3f0e3f80,0xbf7bbec4,0xbf0ebf80,0x3f7b3ec4,0x3f550000,0x3e483f6d,0xbf550000,0xbe48bf6d,0x3ef13f80,0xbf7fbf0e,0x3f620000,0xbdc93f55,0x3f620000,0xbdc93f55,0xbef1bf80,0x3f7f3f0e
.long 0x3ec43f80,0xbf6dbf35,0x3ec43f80,0xbf6dbf35,0x3f6d0000,0xbec43f35,0x3f6d0000,0xbec43f35,0x3e953f80,0xbf46bf55,0xbf750000,0x3f22bf0e,0x3f750000,0xbf223f0e,0x3e953f80,0xbf46bf55
.long 0x3e483f80,0xbf0ebf6d,0xbe48bf80,0x3f0e3f6d,0x3f7b0000,0xbf553ec4,0xbf7b0000,0x3f55bec4,0x3dc93f80,0xbe95bf7b,0x3f7f0000,0xbf753e48,0x3f7f0000,0xbf753e48,0xbdc9bf80,0x3e953f7b
.long 0xbf35bf80,0x3f350000,0xbf35bf80,0x3f350000,0xbf350000,0xbf35bf80,0xbf350000,0xbf35bf80,0xbe95bf6d,0x3f7f3f0e,0x3f753ec4,0x3dc93f55,0xbf75bec4,0xbdc9bf55,0xbe95bf6d,0x3f7f3f0e
.long 0x3e48bf35,0x3f553f6d,0xbe483f35,0xbf55bf6d,0xbf7bbf35,0x3f0ebec4,0x3f7b3f35,0xbf0e3ec4,0x3f22bec4,0x3e953f7b,0xbf46bf6d,0x3f753e48,0xbf46bf6d,0x3f753e48,0xbf223ec4,0xbe95bf7b
.long 0x3f6d0000,0xbec43f35,0x3f6d0000,0xbec43f35,0xbec4bf80,0x3f6d3f35,0xbec4bf80,0x3f6d3f35,0x3f7f3ec4,0xbf623e48,0xbdc93f6d,0xbef1bf7b,0x3dc9bf6d,0x3ef13f7b,0x3f7f3ec4,0xbf623e48
.long 0x3f553f35,0xbf7bbec4,0xbf55bf35,0x3f7b3ec4,0x3f0ebf35,0xbe483f6d,0xbf0e3f35,0x3e48bf6d,0x3ef13f6d,0xbf22bf55,0x3f62bec4,0xbf463f0e,0x3f62bec4,0xbf463f0e,0xbef1bf6d,0x3f223f55
.long 0x3f353f80,0xbf350000,0x3f353f80,0xbf350000,0x3f350000,0x3f353f80,0x3f350000,0x3f353f80,0xbdc93f35,0xbf75bf55,0xbf7fbf35,0x3e95bf0e,0x3f7f3f35,0xbe953f0e,0xbdc93f35,0xbf75bf55
.long 0xbf550000,0xbe48bf6d,0x3f550000,0x3e483f6d,0x3f0e3f80,0xbf7bbec4,0xbf0ebf80,0x3f7b3ec4,0xbf75bf35,0x3f46be48,0xbe953f35,0xbf22bf7b,0xbe953f35,0xbf22bf7b,0x3f753f35,0xbf463e48
.long 0xbec4bf80,0x3f6d3f35,0xbec4bf80,0x3f6d3f35,0xbf6d0000,0x3ec4bf35,0xbf6d0000,0x3ec4bf35,0x3ef1bf35,0x3dc93f7b,0x3f623f35,0xbf7fbe48,0xbf62bf35,0x3f7f3e48,0x3ef1bf35,0x3dc93f7b
.long 0x3f7b0000,0xbf553ec4,0xbf7b0000,0x3f55bec4,0xbe48bf80,0x3f0e3f6d,0x3e483f80,0xbf0ebf6d,0x3f463f35,0xbf62bf0e,0x3f22bf35,0xbef13f55,0x3f22bf35,0xbef13f55,0xbf46bf35,0x3f623f0e
.long 0xbf35bf80,0x3f350000,0xbf35bf80,0x3f350000,0xbf350000,0xbf35bf80,0xbf350000,0xbf35bf80,0x3ef1bec4,0x3f463f7b,0x3f623f6d,0xbf223e48,0xbf62bf6d,0x3f22be48,0x3ef1bec4,0x3f463f7b
.long 0x3f7b3f35,0xbf0e3ec4,0xbf7bbf35,0x3f0ebec4,0x3e48bf35,0x3f553f6d,0xbe483f35,0xbf55bf6d,0x3dc93f6d,0xbf62bf55,0x3f7f3ec4,0xbef13f0e,0x3f7f3ec4,0xbef13f0e,0xbdc9bf6d,0x3f623f55
.long 0xbf6d0000,0x3ec4bf35,0xbf6d0000,0x3ec4bf35,0x3ec43f80,0xbf6dbf35,0x3ec43f80,0xbf6dbf35,0xbf22bf6d,0x3f753f0e,0x3f46bec4,0xbe953f55,0xbf463ec4,0x3e95bf55,0xbf22bf6d,0x3f753f0e
.long 0x3f0ebf35,0xbe483f6d,0xbf0e3f35,0x3e48bf6d,0xbf55bf35,0x3f7b3ec4,0x3f553f35,0xbf7bbec4,0x3f753ec4,0xbf7fbe48,0x3e95bf6d,0xbdc93f7b,0x3e95bf6d,0xbdc93f7b,0xbf75bec4,0x3f7f3e48
.long 0x3f353f80,0xbf350000,0x3f353f80,0xbf350000,0x3f350000,0x3f353f80,0x3f350000,0x3f353f80,0xbf22bf80,0x3f623e48,0x3f460000,0x3ef13f7b,0xbf460000,0xbef1bf7b,0xbf22bf80,0x3f623e48
.long 0x3f0e3f80,0xbf7bbec4,0xbf0ebf80,0x3f7b3ec4,0x3f550000,0x3e483f6d,0xbf550000,0xbe48bf6d,0xbef1bf80,0x3f7f3f0e,0xbf620000,0x3dc9bf55,0xbf620000,0x3dc9bf55,0x3ef13f80,0xbf7fbf0e
.long 0x3ec43f80,0xbf6dbf35,0x3ec43f80,0xbf6dbf35,0x3f6d0000,0xbec43f35,0x3f6d0000,0xbec43f35,0xbe95bf80,0x3f463f55,0x3f750000,0xbf223f0e,0xbf750000,0x3f22bf0e,0xbe95bf80,0x3f463f55
.long 0x3e483f80,0xbf0ebf6d,0xbe48bf80,0x3f0e3f6d,0x3f7b0000,0xbf553ec4,0xbf7b0000,0x3f55bec4,0xbdc9bf80,0x3e953f7b,0xbf7f0000,0x3f75be48,0xbf7f0000,0x3f75be48,0x3dc93f80,0xbe95bf7b
.long 0xbf35bf80,0x3f350000,0xbf35bf80,0x3f350000,0xbf350000,0xbf35bf80,0xbf350000,0xbf35bf80,0x3e953f6d,0xbf7fbf0e,0xbf75bec4,0xbdc9bf55,0x3f753ec4,0x3dc93f55,0x3e953f6d,0xbf7fbf0e
.long 0x3e48bf35,0x3f553f6d,0xbe483f35,0xbf55bf6d,0xbf7bbf35,0x3f0ebec4,0x3f7b3f35,0xbf0e3ec4,0xbf223ec4,0xbe95bf7b,0x3f463f6d,0xbf75be48,0x3f463f6d,0xbf75be48,0x3f22bec4,0x3e953f7b
.long 0x3f6d0000,0xbec43f35,0x3f6d0000,0xbec43f35,0xbec4bf80,0x3f6d3f35,0xbec4bf80,0x3f6d3f35,0xbf7fbec4,0x3f62be48,0x3dc9bf6d,0x3ef13f7b,0xbdc93f6d,0xbef1bf7b,0xbf7fbec4,0x3f62be48
.long 0x3f553f35,0xbf7bbec4,0xbf55bf35,0x3f7b3ec4,0x3f0ebf35,0xbe483f6d,0xbf0e3f35,0x3e48bf6d,0xbef1bf6d,0x3f223f55,0xbf623ec4,0x3f46bf0e,0xbf623ec4,0x3f46bf0e,0x3ef13f6d,0xbf22bf55
.long 0x3f353f80,0xbf350000,0x3f353f80,0xbf350000,0x3f350000,0x3f353f80,0x3f350000,0x3f353f80,0x3dc9bf35,0x3f753f55,0x3f7f3f35,0xbe953f0e,0xbf7fbf35,0x3e95bf0e,0x3dc9bf35,0x3f753f55
.long 0xbf550000,0xbe48bf6d,0x3f550000,0x3e483f6d,0x3f0e3f80,0xbf7bbec4,0xbf0ebf80,0x3f7b3ec4,0x3f753f35,0xbf463e48,0x3e95bf35,0x3f223f7b,0x3e95bf35,0x3f223f7b,0xbf75bf35,0x3f46be48
.long 0xbec4bf80,0x3f6d3f35,0xbec4bf80,0x3f6d3f35,0xbf6d0000,0x3ec4bf35,0xbf6d0000,0x3ec4bf35,0xbef13f35,0xbdc9bf7b,0xbf62bf35,0x3f7f3e48,0x3f623f35,0xbf7fbe48,0xbef13f35,0xbdc9bf7b
.long 0x3f7b0000,0xbf553ec4,0xbf7b0000,0x3f55bec4,0xbe48bf80,0x3f0e3f6d,0x3e483f80,0xbf0ebf6d,0xbf46bf35,0x3f623f0e,0xbf223f35,0x3ef1bf55,0xbf223f35,0x3ef1bf55,0x3f463f35,0xbf62bf0e
.long 0xbf35bf80,0x3f350000,0xbf35bf80,0x3f350000,0xbf350000,0xbf35bf80,0xbf350000,0xbf35bf80,0xbef13ec4,0xbf46bf7b,0xbf62bf6d,0x3f22be48,0x3f623f6d,0xbf223e48,0xbef13ec4,0xbf46bf7b
.long 0x3f7b3f35,0xbf0e3ec4,0xbf7bbf35,0x3f0ebec4,0x3e48bf35,0x3f553f6d,0xbe483f35,0xbf55bf6d,0xbdc9bf6d,0x3f623f55,0xbf7fbec4,0x3ef1bf0e,0xbf7fbec4,0x3ef1bf0e,0x3dc93f6d,0xbf62bf55
.long 0xbf6d0000,0x3ec4bf35,0xbf6d0000,0x3ec4bf35,0x3ec43f80,0xbf6dbf35,0x3ec43f80,0xbf6dbf35,0x3f223f6d,0xbf75bf0e,0xbf463ec4,0x3e95bf55,0x3f46bec4,0xbe953f55,0x3f223f6d,0xbf75bf0e
.long 0x3f0ebf35,0xbe483f6d,0xbf0e3f35,0x3e48bf6d,0xbf55bf35,0x3f7b3ec4,0x3f553f35,0xbf7bbec4,0xbf75bec4,0x3f7f3e48,0xbe953f6d,0x3dc9bf7b,0xbe953f6d,0x3dc9bf7b,0x3f753ec4,0xbf7fbe48
.long 0x3f80,0xbf80,0x3f80,0xbf80,0x3f800000,0xbf800000,0x3f800000,0xbf800000,0xbdc93f80,0x3e95bf7b,0xbf7f0000,0x3f753e48,0x3f7f0000,0xbf75be48,0xbdc93f80,0x3e95bf7b
.long 0xbe483f80,0x3f0ebf6d,0x3e48bf80,0xbf0e3f6d,0x3f7b0000,0xbf55bec4,0xbf7b0000,0x3f553ec4,0xbe953f80,0x3f46bf55,0x3f750000,0xbf22bf0e,0x3f750000,0xbf22bf0e,0x3e95bf80,0xbf463f55
.long 0xbec43f80,0x3f6dbf35,0xbec43f80,0x3f6dbf35,0x3f6d0000,0xbec4bf35,0x3f6d0000,0xbec4bf35,0xbef13f80,0x3f7fbf0e,0xbf620000,0x3dc93f55,0x3f620000,0xbdc9bf55,0xbef13f80,0x3f7fbf0e
.long 0xbf0e3f80,0x3f7bbec4,0x3f0ebf80,0xbf7b3ec4,0x3f550000,0x3e48bf6d,0xbf550000,0xbe483f6d,0xbf223f80,0x3f62be48,0x3f460000,0x3ef1bf7b,0x3f460000,0x3ef1bf7b,0x3f22bf80,0xbf623e48
.long 0x3f80,0xbf80,0x3f80,0xbf80,0x3f800000,0xbf800000,0x3f800000,0xbf800000,0xbef13f6d,0x3f22bf55,0xbf62bec4,0x3f463f0e,0x3f623ec4,0xbf46bf0e,0xbef13f6d,0x3f22bf55
.long 0xbf553f35,0x3f7bbec4,0x3f55bf35,0xbf7b3ec4,0x3f0e3f35,0xbe48bf6d,0xbf0ebf35,0x3e483f6d,0xbf7f3ec4,0x3f623e48,0x3dc93f6d,0x3ef1bf7b,0x3dc93f6d,0x3ef1bf7b,0x3f7fbec4,0xbf62be48
.long 0xbf6d0000,0x3ec43f35,0xbf6d0000,0x3ec43f35,0xbec43f80,0x3f6dbf35,0xbec43f80,0x3f6dbf35,0xbf22bec4,0xbe953f7b,0x3f46bf6d,0xbf753e48,0xbf463f6d,0x3f75be48,0xbf22bec4,0xbe953f7b
.long 0xbe48bf35,0xbf553f6d,0x3e483f35,0x3f55bf6d,0xbf7b3f35,0x3f0e3ec4,0x3f7bbf35,0xbf0ebec4,0x3e95bf6d,0xbf7f3f0e,0xbf753ec4,0xbdc93f55,0xbf753ec4,0xbdc93f55,0xbe953f6d,0x3f7fbf0e
.long 0x3f80,0xbf80,0x3f80,0xbf80,0x3f800000,0xbf800000,0x3f800000,0xbf800000,0xbf463f35,0x3f62bf0e,0xbf22bf35,0x3ef13f55,0x3f223f35,0xbef1bf55,0xbf463f35,0x3f62bf0e
.long 0xbf7b0000,0x3f553ec4,0x3f7b0000,0xbf55bec4,0xbe483f80,0x3f0ebf6d,0x3e48bf80,0xbf0e3f6d,0xbef1bf35,0xbdc93f7b,0xbf623f35,0x3f7fbe48,0xbf623f35,0x3f7fbe48,0x3ef13f35,0x3dc9bf7b
.long 0x3ec4bf80,0xbf6d3f35,0x3ec4bf80,0xbf6d3f35,0xbf6d0000,0x3ec43f35,0xbf6d0000,0x3ec43f35,0x3f75bf35,0xbf46be48,0x3e953f35,0x3f22bf7b,0xbe95bf35,0xbf223f7b,0x3f75bf35,0xbf46be48
.long 0x3f550000,0x3e48bf6d,0xbf550000,0xbe483f6d,0x3f0ebf80,0xbf7b3ec4,0xbf0e3f80,0x3f7bbec4,0x3dc93f35,0x3f75bf55,0x3f7fbf35,0xbe95bf0e,0x3f7fbf35,0xbe95bf0e,0xbdc9bf35,0xbf753f55
.long 0x3f80,0xbf80,0x3f80,0xbf80,0x3f800000,0xbf800000,0x3f800000,0xbf800000,0xbf753ec4,0x3f7fbe48,0xbe95bf6d,0x3dc93f7b,0x3e953f6d,0xbdc9bf7b,0xbf753ec4,0x3f7fbe48
.long 0xbf0ebf35,0x3e483f6d,0x3f0e3f35,0xbe48bf6d,0xbf553f35,0x3f7bbec4,0x3f55bf35,0xbf7b3ec4,0x3f22bf6d,0xbf753f0e,0xbf46bec4,0x3e953f55,0xbf46bec4,0x3e953f55,0xbf223f6d,0x3f75bf0e
.long 0x3f6d0000,0xbec4bf35,0x3f6d0000,0xbec4bf35,0x3ec4bf80,0xbf6d3f35,0x3ec4bf80,0xbf6d3f35,0xbdc93f6d,0x3f62bf55,0xbf7f3ec4,0x3ef13f0e,0x3f7fbec4,0xbef1bf0e,0xbdc93f6d,0x3f62bf55
.long 0xbf7b3f35,0x3f0e3ec4,0x3f7bbf35,0xbf0ebec4,0x3e483f35,0x3f55bf6d,0xbe48bf35,0xbf553f6d,0xbef1bec4,0xbf463f7b,0xbf623f6d,0x3f223e48,0xbf623f6d,0x3f223e48,0x3ef13ec4,0x3f46bf7b
.long 0x3f80,0xbf80,0x3f80,0xbf80,0x3f800000,0xbf800000,0x3f800000,0xbf800000,0x3dc9bf80,0xbe953f7b,0x3f7f0000,0xbf75be48,0xbf7f0000,0x3f753e48,0x3dc9bf80,0xbe953f7b
.long 0xbe483f80,0x3f0ebf6d,0x3e48bf80,0xbf0e3f6d,0x3f7b0000,0xbf55bec4,0xbf7b0000,0x3f553ec4,0x3e95bf80,0xbf463f55,0xbf750000,0x3f223f0e,0xbf750000,0x3f223f0e,0xbe953f80,0x3f46bf55
.long 0xbec43f80,0x3f6dbf35,0xbec43f80,0x3f6dbf35,0x3f6d0000,0xbec4bf35,0x3f6d0000,0xbec4bf35,0x3ef1bf80,0xbf7f3f0e,0x3f620000,0xbdc9bf55,0xbf620000,0x3dc93f55,0x3ef1bf80,0xbf7f3f0e
.long 0xbf0e3f80,0x3f7bbec4,0x3f0ebf80,0xbf7b3ec4,0x3f550000,0x3e48bf6d,0xbf550000,0xbe483f6d,0x3f22bf80,0xbf623e48,0xbf460000,0xbef13f7b,0xbf460000,0xbef13f7b,0xbf223f80,0x3f62be48
.long 0x3f80,0xbf80,0x3f80,0xbf80,0x3f800000,0xbf800000,0x3f800000,0xbf800000,0x3ef1bf6d,0xbf223f55,0x3f623ec4,0xbf46bf0e,0xbf62bec4,0x3f463f0e,0x3ef1bf6d,0xbf223f55
.long 0xbf553f35,0x3f7bbec4,0x3f55bf35,0xbf7b3ec4,0x3f0e3f35,0xbe48bf6d,0xbf0ebf35,0x3e483f6d,0x3f7fbec4,0xbf62be48,0xbdc9bf6d,0xbef13f7b,0xbdc9bf6d,0xbef13f7b,0xbf7f3ec4,0x3f623e48
.long 0xbf6d0000,0x3ec43f35,0xbf6d0000,0x3ec43f35,0xbec43f80,0x3f6dbf35,0xbec43f80,0x3f6dbf35,0x3f223ec4,0x3e95bf7b,0xbf463f6d,0x3f75be48,0x3f46bf6d,0xbf753e48,0x3f223ec4,0x3e95bf7b
.long 0xbe48bf35,0xbf553f6d,0x3e483f35,0x3f55bf6d,0xbf7b3f35,0x3f0e3ec4,0x3f7bbf35,0xbf0ebec4,0xbe953f6d,0x3f7fbf0e,0x3f75bec4,0x3dc9bf55,0x3f75bec4,0x3dc9bf55,0x3e95bf6d,0xbf7f3f0e
.long 0x3f80,0xbf80,0x3f80,0xbf80,0x3f800000,0xbf800000,0x3f800000,0xbf800000,0x3f46bf35,0xbf623f0e,0x3f223f35,0xbef1bf55,0xbf22bf35,0x3ef13f55,0x3f46bf35,0xbf623f0e
.long 0xbf7b0000,0x3f553ec4,0x3f7b0000,0xbf55bec4,0xbe483f80,0x3f0ebf6d,0x3e48bf80,0xbf0e3f6d,0x3ef13f35,0x3dc9bf7b,0x3f62bf35,0xbf7f3e48,0x3f62bf35,0xbf7f3e48,0xbef1bf35,0xbdc93f7b
.long 0x3ec4bf80,0xbf6d3f35,0x3ec4bf80,0xbf6d3f35,0xbf6d0000,0x3ec43f35,0xbf6d0000,0x3ec43f35,0xbf753f35,0x3f463e48,0xbe95bf35,0xbf223f7b,0x3e953f35,0x3f22bf7b,0xbf753f35,0x3f463e48
.long 0x3f550000,0x3e48bf6d,0xbf550000,0xbe483f6d,0x3f0ebf80,0xbf7b3ec4,0xbf0e3f80,0x3f7bbec4,0xbdc9bf35,0xbf753f55,0xbf7f3f35,0x3e953f0e,0xbf7f3f35,0x3e953f0e,0x3dc93f35,0x3f75bf55
.long 0x3f80,0xbf80,0x3f80,0xbf80,0x3f800000,0xbf800000,0x3f800000,0xbf800000,0x3f75bec4,0xbf7f3e48,0x3e953f6d,0xbdc9bf7b,0xbe95bf6d,0x3dc93f7b,0x3f75bec4,0xbf7f3e48
.long 0xbf0ebf35,0x3e483f6d,0x3f0e3f35,0xbe48bf6d,0xbf553f35,0x3f7bbec4,0x3f55bf35,0xbf7b3ec4,0xbf223f6d,0x3f75bf0e,0x3f463ec4,0xbe95bf55,0x3f463ec4,0xbe95bf55,0x3f22bf6d,0xbf753f0e
.long 0x3f6d0000,0xbec4bf35,0x3f6d0000,0xbec4bf35,0x3ec4bf80,0xbf6d3f35,0x3ec4bf80,0xbf6d3f35,0x3dc9bf6d,0xbf623f55,0x3f7fbec4,0xbef1bf0e,0xbf7f3ec4,0x3ef13f0e,0x3dc9bf6d,0xbf623f55
.long 0xbf7b3f35,0x3f0e3ec4,0x3f7bbf35,0xbf0ebec4,0x3e483f35,0x3f55bf6d,0xbe48bf35,0xbf553f6d,0x3ef13ec4,0x3f46bf7b,0x3f62bf6d,0xbf22be48,0x3f62bf6d,0xbf22be48,0xbef1bec4,0xbf463f7b
.long 0xbf353f80,0x3f350000,0xbf353f80,0x3f350000,0x3f350000,0x3f35bf80,0x3f350000,0x3f35bf80,0xbf463f80,0x3ef13e48,0xbf220000,0xbf623f7b,0x3f220000,0x3f62bf7b,0xbf463f80,0x3ef13e48
.long 0xbf553f80,0x3e483ec4,0x3f55bf80,0xbe48bec4,0x3f0e0000,0x3f7bbf6d,0xbf0e0000,0xbf7b3f6d,0xbf623f80,0xbdc93f0e,0x3ef10000,0x3f7fbf55,0x3ef10000,0x3f7fbf55,0x3f62bf80,0x3dc9bf0e
.long 0xbf6d3f80,0xbec43f35,0xbf6d3f80,0xbec43f35,0x3ec40000,0x3f6dbf35,0x3ec40000,0x3f6dbf35,0xbf753f80,0xbf223f55,0xbe950000,0xbf463f0e,0x3e950000,0x3f46bf0e,0xbf753f80,0xbf223f55
.long 0xbf7b3f80,0xbf553f6d,0x3f7bbf80,0x3f55bf6d,0x3e480000,0x3f0ebec4,0xbe480000,0xbf0e3ec4,0xbf7f3f80,0xbf753f7b,0x3dc90000,0x3e95be48,0x3dc90000,0x3e95be48,0x3f7fbf80,0x3f75bf7b
.long 0x3f35bf80,0xbf350000,0x3f35bf80,0xbf350000,0xbf350000,0xbf353f80,0xbf350000,0xbf353f80,0x3f75bf6d,0xbdc9bf0e,0x3e953ec4,0x3f7fbf55,0xbe95bec4,0xbf7f3f55,0x3f75bf6d,0xbdc9bf0e
.long 0x3f7bbf35,0x3f0ebf6d,0xbf7b3f35,0xbf0e3f6d,0x3e48bf35,0xbf553ec4,0xbe483f35,0x3f55bec4,0x3f46bec4,0x3f75bf7b,0x3f22bf6d,0xbe95be48,0x3f22bf6d,0xbe95be48,0xbf463ec4,0xbf753f7b
.long 0x3ec40000,0x3f6dbf35,0x3ec40000,0x3f6dbf35,0x3f6dbf80,0x3ec4bf35,0x3f6dbf80,0x3ec4bf35,0xbdc93ec4,0x3ef1be48,0xbf7f3f6d,0xbf623f7b,0x3f7fbf6d,0x3f62bf7b,0xbdc93ec4,0x3ef1be48
.long 0xbf0e3f35,0xbe483ec4,0x3f0ebf35,0x3e48bec4,0x3f55bf35,0x3f7bbf6d,0xbf553f35,0xbf7b3f6d,0xbf623f6d,0xbf463f55,0x3ef1bec4,0x3f22bf0e,0x3ef1bec4,0x3f22bf0e,0x3f62bf6d,0x3f46bf55
.long 0xbf353f80,0x3f350000,0xbf353f80,0x3f350000,0x3f350000,0x3f35bf80,0x3f350000,0x3f35bf80,0xbf7f3f35,0xbe953f55,0x3dc9bf35,0xbf753f0e,0xbdc93f35,0x3f75bf0e,0xbf7f3f35,0xbe953f55
.long 0xbf0e0000,0xbf7b3f6d,0x3f0e0000,0x3f7bbf6d,0xbf553f80,0x3e483ec4,0x3f55bf80,0xbe48bec4,0x3e95bf35,0xbf223e48,0xbf753f35,0xbf463f7b,0xbf753f35,0xbf463f7b,0xbe953f35,0x3f22be48
.long 0x3f6dbf80,0x3ec4bf35,0x3f6dbf80,0x3ec4bf35,0xbec40000,0xbf6d3f35,0xbec40000,0xbf6d3f35,0x3f62bf35,0x3f7fbf7b,0xbef13f35,0x3dc93e48,0x3ef1bf35,0xbdc9be48,0x3f62bf35,0x3f7fbf7b
.long 0x3e480000,0x3f0ebec4,0xbe480000,0xbf0e3ec4,0x3f7bbf80,0x3f55bf6d,0xbf7b3f80,0xbf553f6d,0xbf223f35,0xbef13f0e,0x3f46bf35,0x3f62bf55,0x3f46bf35,0x3f62bf55,0x3f22bf35,0x3ef1bf0e
.long 0x3f35bf80,0xbf350000,0x3f35bf80,0xbf350000,0xbf350000,0xbf353f80,0xbf350000,0xbf353f80,0x3f62bec4,0x3f22bf7b,0xbef13f6d,0x3f46be48,0x3ef1bf6d,0xbf463e48,0x3f62bec4,0x3f22bf7b
.long 0xbe483f35,0x3f55bec4,0x3e48bf35,0xbf553ec4,0x3f7bbf35,0x3f0ebf6d,0xbf7b3f35,0xbf0e3f6d,0xbf7f3f6d,0xbef13f55,0x3dc93ec4,0x3f62bf0e,0x3dc93ec4,0x3f62bf0e,0x3f7fbf6d,0x3ef1bf55
.long 0xbec40000,0xbf6d3f35,0xbec40000,0xbf6d3f35,0xbf6d3f80,0xbec43f35,0xbf6d3f80,0xbec43f35,0x3f46bf6d,0x3e95bf0e,0x3f22bec4,0x3f75bf55,0xbf223ec4,0xbf753f55,0x3f46bf6d,0x3e95bf0e
.long 0x3f55bf35,0x3f7bbf6d,0xbf553f35,0xbf7b3f6d,0x3f0ebf35,0x3e48bec4,0xbf0e3f35,0xbe483ec4,0xbe953ec4,0xbdc93e48,0x3f75bf6d,0x3f7fbf7b,0x3f75bf6d,0x3f7fbf7b,0x3e95bec4,0x3dc9be48
.long 0xbf353f80,0x3f350000,0xbf353f80,0x3f350000,0x3f350000,0x3f35bf80,0x3f350000,0x3f35bf80,0x3f46bf80,0xbef1be48,0x3f220000,0x3f62bf7b,0xbf220000,0xbf623f7b,0x3f46bf80,0xbef1be48
.long 0xbf553f80,0x3e483ec4,0x3f55bf80,0xbe48bec4,0x3f0e0000,0x3f7bbf6d,0xbf0e0000,0xbf7b3f6d,0x3f62bf80,0x3dc9bf0e,0xbef10000,0xbf7f3f55,0xbef10000,0xbf7f3f55,0xbf623f80,0xbdc93f0e
.long 0xbf6d3f80,0xbec43f35,0xbf6d3f80,0xbec43f35,0x3ec40000,0x3f6dbf35,0x3ec40000,0x3f6dbf35,0x3f75bf80,0x3f22bf55,0x3e950000,0x3f46bf0e,0xbe950000,0xbf463f0e,0x3f75bf80,0x3f22bf55
.long 0xbf7b3f80,0xbf553f6d,0x3f7bbf80,0x3f55bf6d,0x3e480000,0x3f0ebec4,0xbe480000,0xbf0e3ec4,0x3f7fbf80,0x3f75bf7b,0xbdc90000,0xbe953e48,0xbdc90000,0xbe953e48,0xbf7f3f80,0xbf753f7b
.long 0x3f35bf80,0xbf350000,0x3f35bf80,0xbf350000,0xbf350000,0xbf353f80,0xbf350000,0xbf353f80,0xbf753f6d,0x3dc93f0e,0xbe95bec4,0xbf7f3f55,0x3e953ec4,0x3f7fbf55,0xbf753f6d,0x3dc93f0e
.long 0x3f7bbf35,0x3f0ebf6d,0xbf7b3f35,0xbf0e3f6d,0x3e48bf35,0xbf553ec4,0xbe483f35,0x3f55bec4,0xbf463ec4,0xbf753f7b,0xbf223f6d,0x3e953e48,0xbf223f6d,0x3e953e48,0x3f46bec4,0x3f75bf7b
.long 0x3ec40000,0x3f6dbf35,0x3ec40000,0x3f6dbf35,0x3f6dbf80,0x3ec4bf35,0x3f6dbf80,0x3ec4bf35,0x3dc9bec4,0xbef13e48,0x3f7fbf6d,0x3f62bf7b,0xbf7f3f6d,0xbf623f7b,0x3dc9bec4,0xbef13e48
.long 0xbf0e3f35,0xbe483ec4,0x3f0ebf35,0x3e48bec4,0x3f55bf35,0x3f7bbf6d,0xbf553f35,0xbf7b3f6d,0x3f62bf6d,0x3f46bf55,0xbef13ec4,0xbf223f0e,0xbef13ec4,0xbf223f0e,0xbf623f6d,0xbf463f55
.long 0xbf353f80,0x3f350000,0xbf353f80,0x3f350000,0x3f350000,0x3f35bf80,0x3f350000,0x3f35bf80,0x3f7fbf35,0x3e95bf55,0xbdc93f35,0x3f75bf0e,0x3dc9bf35,0xbf753f0e,0x3f7fbf35,0x3e95bf55
.long 0xbf0e0000,0xbf7b3f6d,0x3f0e0000,0x3f7bbf6d,0xbf553f80,0x3e483ec4,0x3f55bf80,0xbe48bec4,0xbe953f35,0x3f22be48,0x3f75bf35,0x3f46bf7b,0x3f75bf35,0x3f46bf7b,0x3e95bf35,0xbf223e48
.long 0x3f6dbf80,0x3ec4bf35,0x3f6dbf80,0x3ec4bf35,0xbec40000,0xbf6d3f35,0xbec40000,0xbf6d3f35,0xbf623f35,0xbf7f3f7b,0x3ef1bf35,0xbdc9be48,0xbef13f35,0x3dc93e48,0xbf623f35,0xbf7f3f7b
.long 0x3e480000,0x3f0ebec4,0xbe480000,0xbf0e3ec4,0x3f7bbf80,0x3f55bf6d,0xbf7b3f80,0xbf553f6d,0x3f22bf35,0x3ef1bf0e,0xbf463f35,0xbf623f55,0xbf463f35,0xbf623f55,0xbf223f35,0xbef13f0e
.long 0x3f35bf80,0xbf350000,0x3f35bf80,0xbf350000,0xbf350000,0xbf353f80,0xbf350000,0xbf353f80,0xbf623ec4,0xbf223f7b,0x3ef1bf6d,0xbf463e48,0xbef13f6d,0x3f46be48,0xbf623ec4,0xbf223f7b
.long 0xbe483f35,0x3f55bec4,0x3e48bf35,0xbf553ec4,0x3f7bbf35,0x3f0ebf6d,0xbf7b3f35,0xbf0e3f6d,0x3f7fbf6d,0x3ef1bf55,0xbdc9bec4,0xbf623f0e,0xbdc9bec4,0xbf623f0e,0xbf7f3f6d,0xbef13f55
.long 0xbec40000,0xbf6d3f35,0xbec40000,0xbf6d3f35,0xbf6d3f80,0xbec43f35,0xbf6d3f80,0xbec43f35,0xbf463f6d,0xbe953f0e,0xbf223ec4,0xbf753f55,0x3f22bec4,0x3f75bf55,0xbf463f6d,0xbe953f0e
.long 0x3f55bf35,0x3f7bbf6d,0xbf553f35,0xbf7b3f6d,0x3f0ebf35,0x3e48bec4,0xbf0e3f35,0xbe483ec4,0x3e95bec4,0x3dc9be48,0xbf753f6d,0xbf7f3f7b,0xbf753f6d,0xbf7f3f7b,0xbe953ec4,0xbdc93e48
.long 0x3f803f80,0x3f80,0x3f80,0x3f80,0xbf803f80,0x3dc93f7f,0x3f353f35,0x3f463f22,0x3f803f80,0x3e483f7b,0x3f800000,0x3f7bbe48,0xbf803f80,0x3e953f75,0x3f35bf35,0x3ef1bf62
.long 0x3f803f80,0x3ec43f6d,0xbf80,0xbec4bf6d,0xbf803f80,0x3ef13f62,0xbf35bf35,0xbf75be95,0x3f803f80,0x3f0e3f55,0xbf800000,0xbf553f0e,0xbf803f80,0x3f223f46,0xbf353f35,0xbdc93f7f
.long 0x3f803f80,0x3f353f35,0x3f80,0x3f353f35,0xbf803f80,0x3f463f22,0x3f353f35,0x3f7fbdc9,0x3f803f80,0x3f553f0e,0x3f800000,0x3f0ebf55,0xbf803f80,0x3f623ef1,0x3f35bf35,0xbe95bf75
.long 0x3f803f80,0x3f6d3ec4,0xbf80,0xbf6dbec4,0xbf803f80,0x3f753e95,0xbf35bf35,0xbf623ef1,0x3f803f80,0x3f7b3e48,0xbf800000,0xbe483f7b,0xbf803f80,0x3f7f3dc9,0xbf353f35,0x3f223f46
.long 0x3f80,0x3f80,0x3f80,0x3f80,0x3e483f7b,0x3e953f75,0x3f553f0e,0x3f623ef1,0x3ec43f6d,0x3f0e3f55,0x3f6dbec4,0x3f55bf0e,0x3f0e3f55,0x3f463f22,0x3e48bf7b,0xbdc9bf7f
.long 0x3f353f35,0x3f6d3ec4,0xbf35bf35,0xbf6dbec4,0x3f553f0e,0x3f7f3dc9,0xbf7b3e48,0xbf463f22,0x3f6d3ec4,0x3f7bbe48,0xbec43f6d,0x3e483f7b,0x3f7b3e48,0x3f62bef1,0x3f0e3f55,0x3f753e95
.long 0x3f800000,0x3f35bf35,0x3f800000,0x3f35bf35,0x3f7bbe48,0x3ef1bf62,0x3f0ebf55,0xbe95bf75,0x3f6dbec4,0x3e48bf7b,0xbec4bf6d,0xbf7bbe48,0x3f55bf0e,0xbdc9bf7f,0xbf7bbe48,0xbf223f46
.long 0x3f35bf35,0xbec4bf6d,0xbf353f35,0x3ec43f6d,0x3f0ebf55,0xbf22bf46,0x3e483f7b,0x3f7f3dc9,0x3ec4bf6d,0xbf55bf0e,0x3f6d3ec4,0x3f0ebf55,0x3e48bf7b,0xbf75be95,0x3f55bf0e,0xbef1bf62
.long 0x3f80,0x3f80,0x3f80,0x3f80,0x3ec43f6d,0x3ef13f62,0x3f6d3ec4,0x3f753e95,0x3f353f35,0x3f553f0e,0x3f35bf35,0x3f0ebf55,0x3f6d3ec4,0x3f7f3dc9,0xbec4bf6d,0xbf22bf46
.long 0x3f800000,0x3f6dbec4,0xbf800000,0xbf6d3ec4,0x3f6dbec4,0x3f22bf46,0xbec43f6d,0x3dc93f7f,0x3f35bf35,0x3e48bf7b,0x3f353f35,0x3f7b3e48,0x3ec4bf6d,0xbe95bf75,0x3f6dbec4,0x3ef1bf62
.long 0xbf80,0xbf35bf35,0xbf80,0xbf35bf35,0xbec4bf6d,0xbf75be95,0xbf6dbec4,0xbf623ef1,0xbf35bf35,0xbf7b3e48,0xbf353f35,0x3e483f7b,0xbf6dbec4,0xbf463f22,0x3ec43f6d,0x3f7f3dc9
.long 0xbf800000,0xbec43f6d,0x3f800000,0x3ec4bf6d,0xbf6d3ec4,0x3dc93f7f,0x3ec4bf6d,0xbf46bf22,0xbf353f35,0x3f0e3f55,0xbf35bf35,0xbf553f0e,0xbec43f6d,0x3f623ef1,0xbf6d3ec4,0x3e953f75
.long 0x3f80,0x3f80,0x3f80,0x3f80,0x3f0e3f55,0x3f223f46,0x3f7b3e48,0x3f7f3dc9,0x3f6d3ec4,0x3f7b3e48,0x3ec4bf6d,0x3e48bf7b,0x3f7bbe48,0x3f62bef1,0xbf55bf0e,0xbf75be95
.long 0x3f35bf35,0x3ec4bf6d,0xbf353f35,0xbec43f6d,0x3e48bf7b,0xbe95bf75,0x3f0e3f55,0x3f623ef1,0xbec4bf6d,0xbf55bf0e,0x3f6dbec4,0x3f0ebf55,0xbf55bf0e,0xbf7f3dc9,0xbe48bf7b,0xbf46bf22
.long 0xbf800000,0xbf353f35,0xbf800000,0xbf353f35,0xbf553f0e,0xbdc93f7f,0xbe483f7b,0x3f223f46,0xbec43f6d,0x3f0e3f55,0x3f6d3ec4,0x3f55bf0e,0x3e483f7b,0x3f753e95,0x3f0ebf55,0xbef1bf62
.long 0x3f353f35,0x3f6dbec4,0xbf35bf35,0xbf6d3ec4,0x3f7b3e48,0x3ef1bf62,0xbf553f0e,0x3e953f75,0x3f6dbec4,0xbe48bf7b,0x3ec43f6d,0x3f7bbe48,0x3f0ebf55,0xbf46bf22,0x3f7bbe48,0xbdc9bf7f
.long 0x3f80,0x3f80,0x3f80,0x3f80,0x3f800000,0x3f7fbdc9,0x3f35bf35,0x3f22bf46,0xbf80,0xbe48bf7b,0xbf800000,0xbf7b3e48,0xbf800000,0xbf753e95,0x3f353f35,0x3f623ef1
.long 0x3f80,0x3ec43f6d,0xbf80,0xbec4bf6d,0x3f800000,0x3f62bef1,0xbf353f35,0xbe953f75,0xbf80,0xbf0ebf55,0x3f800000,0x3f55bf0e,0xbf800000,0xbf463f22,0xbf35bf35,0xbf7fbdc9
.long 0x3f80,0x3f353f35,0x3f80,0x3f353f35,0x3f800000,0x3f22bf46,0x3f35bf35,0xbdc9bf7f,0xbf80,0xbf55bf0e,0xbf800000,0xbf0e3f55,0xbf800000,0xbef13f62,0x3f353f35,0x3f75be95
.long 0x3f80,0x3f6d3ec4,0xbf80,0xbf6dbec4,0x3f800000,0x3e95bf75,0xbf353f35,0x3ef13f62,0xbf80,0xbf7bbe48,0x3f800000,0x3e48bf7b,0xbf800000,0xbdc93f7f,0xbf35bf35,0xbf463f22
.long 0x3f80,0x3f80,0x3f80,0x3f80,0x3f7bbe48,0x3f75be95,0x3f0ebf55,0x3ef1bf62,0xbec4bf6d,0xbf0ebf55,0xbf6d3ec4,0xbf553f0e,0xbf553f0e,0xbf223f46,0x3f7b3e48,0x3f7fbdc9
.long 0x3f353f35,0x3f6d3ec4,0xbf35bf35,0xbf6dbec4,0x3f0ebf55,0x3dc9bf7f,0x3e483f7b,0x3f223f46,0xbf6dbec4,0xbf7b3e48,0x3ec4bf6d,0xbe48bf7b,0xbe483f7b,0x3ef13f62,0xbf553f0e,0xbe953f75
.long 0x3f800000,0x3f35bf35,0x3f800000,0x3f35bf35,0xbe48bf7b,0xbf62bef1,0xbf55bf0e,0xbf753e95,0xbf6d3ec4,0xbe483f7b,0x3ec43f6d,0x3f7b3e48,0x3f0e3f55,0x3f7fbdc9,0x3e48bf7b,0xbf46bf22
.long 0x3f35bf35,0xbec4bf6d,0xbf353f35,0x3ec43f6d,0xbf55bf0e,0xbf463f22,0x3f7bbe48,0x3dc9bf7f,0xbec43f6d,0x3f553f0e,0xbf6dbec4,0xbf0e3f55,0x3f7b3e48,0x3e95bf75,0x3f0e3f55,0x3f62bef1
.long 0x3f80,0x3f80,0x3f80,0x3f80,0x3f6dbec4,0x3f62bef1,0x3ec4bf6d,0x3e95bf75,0xbf35bf35,0xbf55bf0e,0xbf353f35,0xbf0e3f55,0xbec43f6d,0xbdc93f7f,0x3f6dbec4,0x3f46bf22
.long 0x3f800000,0x3f6dbec4,0xbf800000,0xbf6d3ec4,0xbec4bf6d,0xbf46bf22,0x3f6d3ec4,0x3f7fbdc9,0xbf353f35,0xbe483f7b,0xbf35bf35,0xbf7bbe48,0x3f6d3ec4,0x3f75be95,0x3ec43f6d,0x3f623ef1
.long 0xbf80,0xbf35bf35,0xbf80,0xbf35bf35,0xbf6d3ec4,0xbe953f75,0xbec43f6d,0x3ef13f62,0x3f353f35,0x3f7bbe48,0x3f35bf35,0xbe48bf7b,0x3ec4bf6d,0xbf22bf46,0xbf6d3ec4,0xbdc93f7f
.long 0xbf800000,0xbec43f6d,0x3f800000,0x3ec4bf6d,0x3ec43f6d,0x3f7fbdc9,0xbf6dbec4,0xbf223f46,0x3f35bf35,0xbf0ebf55,0x3f353f35,0x3f55bf0e,0xbf6dbec4,0xbef13f62,0xbec4bf6d,0xbf753e95
.long 0x3f80,0x3f80,0x3f80,0x3f80,0x3f55bf0e,0x3f46bf22,0x3e48bf7b,0x3dc9bf7f,0xbf6dbec4,0xbf7bbe48,0xbec43f6d,0xbe483f7b,0x3e483f7b,0x3ef13f62,0x3f0ebf55,0x3e95bf75
.long 0x3f35bf35,0x3ec4bf6d,0xbf353f35,0xbec43f6d,0xbf7bbe48,0xbf753e95,0x3f55bf0e,0x3ef1bf62,0x3ec43f6d,0x3f553f0e,0xbf6d3ec4,0xbf0e3f55,0x3f0ebf55,0xbdc9bf7f,0x3f7bbe48,0x3f22bf46
.long 0xbf800000,0xbf353f35,0xbf800000,0xbf353f35,0x3f0e3f55,0x3f7f3dc9,0x3f7b3e48,0x3f46bf22,0x3ec4bf6d,0xbf0ebf55,0xbf6dbec4,0xbf553f0e,0xbf7b3e48,0xbe953f75,0x3f553f0e,0x3f62bef1
.long 0x3f353f35,0x3f6dbec4,0xbf35bf35,0xbf6d3ec4,0x3e48bf7b,0xbf62bef1,0x3f0e3f55,0x3f75be95,0xbf6d3ec4,0x3e483f7b,0xbec4bf6d,0xbf7b3e48,0x3f553f0e,0x3f22bf46,0x3e483f7b,0x3f7fbdc9
.long 0x3f803f80,0x3f800000,0x3f80,0x3f800000,0xbf803f80,0x3f7fbdc9,0x3f353f35,0x3f22bf46,0x3f803f80,0x3f7bbe48,0x3f800000,0xbe48bf7b,0xbf803f80,0x3f75be95,0x3f35bf35,0xbf62bef1
.long 0x3f803f80,0x3f6dbec4,0xbf80,0xbf6d3ec4,0xbf803f80,0x3f62bef1,0xbf35bf35,0xbe953f75,0x3f803f80,0x3f55bf0e,0xbf800000,0x3f0e3f55,0xbf803f80,0x3f46bf22,0xbf353f35,0x3f7f3dc9
.long 0x3f803f80,0x3f35bf35,0x3f80,0x3f35bf35,0xbf803f80,0x3f22bf46,0x3f353f35,0xbdc9bf7f,0x3f803f80,0x3f0ebf55,0x3f800000,0xbf55bf0e,0xbf803f80,0x3ef1bf62,0x3f35bf35,0xbf753e95
.long 0x3f803f80,0x3ec4bf6d,0xbf80,0xbec43f6d,0xbf803f80,0x3e95bf75,0xbf35bf35,0x3ef13f62,0x3f803f80,0x3e48bf7b,0xbf800000,0x3f7b3e48,0xbf803f80,0x3dc9bf7f,0xbf353f35,0x3f46bf22
.long 0xbf80,0xbf800000,0xbf80,0xbf800000,0xbe48bf7b,0xbf753e95,0xbf55bf0e,0xbef13f62,0xbec4bf6d,0xbf553f0e,0xbf6d3ec4,0x3f0e3f55,0xbf0ebf55,0xbf223f46,0xbe483f7b,0x3f7fbdc9
.long 0xbf35bf35,0xbec43f6d,0x3f353f35,0x3ec4bf6d,0xbf55bf0e,0xbdc93f7f,0x3f7bbe48,0xbf22bf46,0xbf6dbec4,0x3e483f7b,0x3ec4bf6d,0xbf7b3e48,0xbf7bbe48,0x3ef13f62,0xbf0ebf55,0xbe953f75
.long 0xbf800000,0x3f353f35,0xbf800000,0x3f353f35,0xbf7b3e48,0x3f623ef1,0xbf0e3f55,0x3f75be95,0xbf6d3ec4,0x3f7b3e48,0x3ec43f6d,0x3e48bf7b,0xbf553f0e,0x3f7fbdc9,0x3f7b3e48,0xbf46bf22
.long 0xbf353f35,0x3f6dbec4,0x3f35bf35,0xbf6d3ec4,0xbf0e3f55,0x3f46bf22,0xbe48bf7b,0xbdc93f7f,0xbec43f6d,0x3f0ebf55,0xbf6dbec4,0x3f553f0e,0xbe483f7b,0x3e95bf75,0xbf553f0e,0x3f62bef1
.long 0x3f80,0x3f800000,0x3f80,0x3f800000,0x3ec43f6d,0x3f62bef1,0x3f6d3ec4,0x3e95bf75,0x3f353f35,0x3f0ebf55,0x3f35bf35,0xbf55bf0e,0x3f6d3ec4,0x3dc9bf7f,0xbec4bf6d,0xbf463f22
.long 0x3f800000,0xbec4bf6d,0xbf800000,0x3ec43f6d,0x3f6dbec4,0xbf46bf22,0xbec43f6d,0x3f7fbdc9,0x3f35bf35,0xbf7bbe48,0x3f353f35,0x3e48bf7b,0x3ec4bf6d,0xbf753e95,0x3f6dbec4,0xbf62bef1
.long 0xbf80,0xbf353f35,0xbf80,0xbf353f35,0xbec4bf6d,0xbe953f75,0xbf6dbec4,0x3ef13f62,0xbf35bf35,0x3e483f7b,0xbf353f35,0x3f7bbe48,0xbf6dbec4,0x3f223f46,0x3ec43f6d,0x3dc9bf7f
.long 0xbf800000,0x3f6d3ec4,0x3f800000,0xbf6dbec4,0xbf6d3ec4,0x3f7fbdc9,0x3ec4bf6d,0xbf223f46,0xbf353f35,0x3f55bf0e,0xbf35bf35,0x3f0e3f55,0xbec43f6d,0x3ef1bf62,0xbf6d3ec4,0x3f75be95
.long 0xbf80,0xbf800000,0xbf80,0xbf800000,0xbf0ebf55,0xbf463f22,0xbf7bbe48,0xbdc93f7f,0xbf6dbec4,0xbe483f7b,0xbec43f6d,0x3f7b3e48,0xbf7b3e48,0x3ef13f62,0x3f553f0e,0x3e95bf75
.long 0xbf353f35,0x3f6d3ec4,0x3f35bf35,0xbf6dbec4,0xbe483f7b,0x3f75be95,0xbf0ebf55,0xbef13f62,0x3ec43f6d,0x3f0ebf55,0xbf6d3ec4,0x3f553f0e,0x3f553f0e,0xbdc9bf7f,0x3e483f7b,0x3f22bf46
.long 0x3f800000,0xbf35bf35,0x3f800000,0xbf35bf35,0x3f55bf0e,0xbf7fbdc9,0x3e48bf7b,0xbf463f22,0x3ec4bf6d,0xbf553f0e,0xbf6dbec4,0x3f0e3f55,0xbe48bf7b,0xbe953f75,0xbf0e3f55,0x3f62bef1
.long 0xbf35bf35,0x3ec43f6d,0x3f353f35,0xbec4bf6d,0xbf7bbe48,0x3f623ef1,0x3f55bf0e,0xbf753e95,0xbf6d3ec4,0x3f7bbe48,0xbec4bf6d,0x3e483f7b,0xbf0e3f55,0x3f22bf46,0xbf7b3e48,0x3f7fbdc9
.long 0x3f80,0x3f800000,0x3f80,0x3f800000,0x3f800000,0xbdc9bf7f,0x3f35bf35,0xbf46bf22,0xbf80,0xbf7b3e48,0xbf800000,0x3e483f7b,0xbf800000,0x3e953f75,0x3f353f35,0x3ef1bf62
.long 0x3f80,0x3f6dbec4,0xbf80,0xbf6d3ec4,0x3f800000,0xbef1bf62,0xbf353f35,0x3f753e95,0xbf80,0xbf553f0e,0x3f800000,0xbf0ebf55,0xbf800000,0x3f223f46,0xbf35bf35,0xbdc93f7f
.long 0x3f80,0x3f35bf35,0x3f80,0x3f35bf35,0x3f800000,0xbf46bf22,0x3f35bf35,0xbf7f3dc9,0xbf80,0xbf0e3f55,0xbf800000,0x3f553f0e,0xbf800000,0x3f623ef1,0x3f353f35,0xbe95bf75
.long 0x3f80,0x3ec4bf6d,0xbf80,0xbec43f6d,0x3f800000,0xbf75be95,0xbf353f35,0x3f62bef1,0xbf80,0xbe483f7b,0x3f800000,0xbf7bbe48,0xbf800000,0x3f7f3dc9,0xbf35bf35,0x3f223f46
.long 0xbf80,0xbf800000,0xbf80,0xbf800000,0xbf7b3e48,0x3e953f75,0xbf0e3f55,0x3f623ef1,0x3ec43f6d,0x3f55bf0e,0x3f6dbec4,0xbf0ebf55,0x3f55bf0e,0xbf46bf22,0xbf7bbe48,0x3dc93f7f
.long 0xbf35bf35,0xbec43f6d,0x3f353f35,0x3ec4bf6d,0xbf0e3f55,0x3f7f3dc9,0xbe48bf7b,0xbf463f22,0x3f6d3ec4,0xbe48bf7b,0xbec43f6d,0x3f7bbe48,0x3e48bf7b,0xbf623ef1,0x3f55bf0e,0xbf75be95
.long 0xbf800000,0x3f353f35,0xbf800000,0x3f353f35,0x3e483f7b,0x3ef1bf62,0x3f553f0e,0xbe95bf75,0x3f6dbec4,0xbf7bbe48,0xbec4bf6d,0xbe483f7b,0xbf0ebf55,0x3dc93f7f,0xbe483f7b,0x3f22bf46
.long 0xbf353f35,0x3f6dbec4,0x3f35bf35,0xbf6d3ec4,0x3f553f0e,0xbf22bf46,0xbf7b3e48,0x3f7f3dc9,0x3ec4bf6d,0xbf0e3f55,0x3f6d3ec4,0xbf55bf0e,0xbf7bbe48,0x3f753e95,0xbf0ebf55,0x3ef13f62
.long 0x3f80,0x3f800000,0x3f80,0x3f800000,0x3f6dbec4,0xbef1bf62,0x3ec4bf6d,0xbf75be95,0xbf35bf35,0xbf0e3f55,0xbf353f35,0x3f553f0e,0xbec43f6d,0x3f7f3dc9,0x3f6dbec4,0xbf22bf46
.long 0x3f800000,0xbec4bf6d,0xbf800000,0x3ec43f6d,0xbec4bf6d,0xbf223f46,0x3f6d3ec4,0xbdc9bf7f,0xbf353f35,0x3f7b3e48,0xbf35bf35,0xbe483f7b,0x3f6d3ec4,0xbe95bf75,0x3ec43f6d,0x3ef1bf62
.long 0xbf80,0xbf353f35,0xbf80,0xbf353f35,0xbf6d3ec4,0x3f753e95,0xbec43f6d,0x3f62bef1,0x3f353f35,0xbe48bf7b,0x3f35bf35,0xbf7b3e48,0x3ec4bf6d,0xbf463f22,0xbf6d3ec4,0x3f7f3dc9
.long 0xbf800000,0x3f6d3ec4,0x3f800000,0xbf6dbec4,0x3ec43f6d,0xbdc9bf7f,0xbf6dbec4,0x3f463f22,0x3f35bf35,0xbf553f0e,0x3f353f35,0xbf0ebf55,0xbf6dbec4,0x3f623ef1,0xbec4bf6d,0x3e953f75
.long 0xbf80,0xbf800000,0xbf80,0xbf800000,0xbf553f0e,0x3f223f46,0xbe483f7b,0x3f7f3dc9,0x3f6d3ec4,0x3e48bf7b,0x3ec4bf6d,0xbf7bbe48,0xbe48bf7b,0xbf623ef1,0xbf0e3f55,0x3f753e95
.long 0xbf353f35,0x3f6d3ec4,0x3f35bf35,0xbf6dbec4,0x3f7b3e48,0xbe95bf75,0xbf553f0e,0x3f623ef1,0xbec4bf6d,0xbf0e3f55,0x3f6dbec4,0xbf55bf0e,0xbf0e3f55,0x3f7fbdc9,0xbf7b3e48,0x3f463f22
.long 0x3f800000,0xbf35bf35,0x3f800000,0xbf35bf35,0xbf0ebf55,0xbdc93f7f,0xbf7bbe48,0x3f223f46,0xbec43f6d,0x3f55bf0e,0x3f6d3ec4,0xbf0ebf55,0x3f7bbe48,0xbf75be95,0xbf55bf0e,0x3ef13f62
.long 0xbf35bf35,0x3ec43f6d,0x3f353f35,0xbec4bf6d,0xbe483f7b,0x3ef1bf62,0xbf0ebf55,0x3e953f75,0x3f6dbec4,0xbf7b3e48,0x3ec43f6d,0xbe48bf7b,0xbf55bf0e,0x3f463f22,0xbe48bf7b,0x3dc93f7f
.long 0x3f803f80,0xbf80,0x3f80,0xbf80,0xbf803f80,0xbdc9bf7f,0x3f353f35,0xbf46bf22,0x3f803f80,0xbe48bf7b,0x3f800000,0xbf7b3e48,0xbf803f80,0xbe95bf75,0x3f35bf35,0xbef13f62
.long 0x3f803f80,0xbec4bf6d,0xbf80,0x3ec43f6d,0xbf803f80,0xbef1bf62,0xbf35bf35,0x3f753e95,0x3f803f80,0xbf0ebf55,0xbf800000,0x3f55bf0e,0xbf803f80,0xbf22bf46,0xbf353f35,0x3dc9bf7f
.long 0x3f803f80,0xbf35bf35,0x3f80,0xbf35bf35,0xbf803f80,0xbf46bf22,0x3f353f35,0xbf7f3dc9,0x3f803f80,0xbf55bf0e,0x3f800000,0xbf0e3f55,0xbf803f80,0xbf62bef1,0x3f35bf35,0x3e953f75
.long 0x3f803f80,0xbf6dbec4,0xbf80,0x3f6d3ec4,0xbf803f80,0xbf75be95,0xbf35bf35,0x3f62bef1,0x3f803f80,0xbf7bbe48,0xbf800000,0x3e48bf7b,0xbf803f80,0xbf7fbdc9,0xbf353f35,0xbf22bf46
.long 0x3f80,0xbf80,0x3f80,0xbf80,0x3e483f7b,0xbe95bf75,0x3f553f0e,0xbf62bef1,0x3ec43f6d,0xbf0ebf55,0x3f6dbec4,0xbf553f0e,0x3f0e3f55,0xbf46bf22,0x3e48bf7b,0x3dc93f7f
.long 0x3f353f35,0xbf6dbec4,0xbf35bf35,0x3f6d3ec4,0x3f553f0e,0xbf7fbdc9,0xbf7b3e48,0x3f46bf22,0x3f6d3ec4,0xbf7b3e48,0xbec43f6d,0xbe48bf7b,0x3f7b3e48,0xbf623ef1,0x3f0e3f55,0xbf75be95
.long 0x3f800000,0xbf353f35,0x3f800000,0xbf353f35,0x3f7bbe48,0xbef13f62,0x3f0ebf55,0x3e953f75,0x3f6dbec4,0xbe483f7b,0xbec4bf6d,0x3f7b3e48,0x3f55bf0e,0x3dc93f7f,0xbf7bbe48,0x3f22bf46
.long 0x3f35bf35,0x3ec43f6d,0xbf353f35,0xbec4bf6d,0x3f0ebf55,0x3f223f46,0x3e483f7b,0xbf7fbdc9,0x3ec4bf6d,0x3f553f0e,0x3f6d3ec4,0xbf0e3f55,0x3e48bf7b,0x3f753e95,0x3f55bf0e,0x3ef13f62
.long 0x3f80,0xbf80,0x3f80,0xbf80,0x3ec43f6d,0xbef1bf62,0x3f6d3ec4,0xbf75be95,0x3f353f35,0xbf55bf0e,0x3f35bf35,0xbf0e3f55,0x3f6d3ec4,0xbf7fbdc9,0xbec4bf6d,0x3f223f46
.long 0x3f800000,0xbf6d3ec4,0xbf800000,0x3f6dbec4,0x3f6dbec4,0xbf223f46,0xbec43f6d,0xbdc9bf7f,0x3f35bf35,0xbe483f7b,0x3f353f35,0xbf7bbe48,0x3ec4bf6d,0x3e953f75,0x3f6dbec4,0xbef13f62
.long 0xbf80,0x3f353f35,0xbf80,0x3f353f35,0xbec4bf6d,0x3f753e95,0xbf6dbec4,0x3f62bef1,0xbf35bf35,0x3f7bbe48,0xbf353f35,0xbe48bf7b,0xbf6dbec4,0x3f46bf22,0x3ec43f6d,0xbf7fbdc9
.long 0xbf800000,0x3ec4bf6d,0x3f800000,0xbec43f6d,0xbf6d3ec4,0xbdc9bf7f,0x3ec4bf6d,0x3f463f22,0xbf353f35,0xbf0ebf55,0xbf35bf35,0x3f55bf0e,0xbec43f6d,0xbf62bef1,0xbf6d3ec4,0xbe95bf75
.long 0x3f80,0xbf80,0x3f80,0xbf80,0x3f0e3f55,0xbf22bf46,0x3f7b3e48,0xbf7fbdc9,0x3f6d3ec4,0xbf7bbe48,0x3ec4bf6d,0xbe483f7b,0x3f7bbe48,0xbf623ef1,0xbf55bf0e,0x3f753e95
.long 0x3f35bf35,0xbec43f6d,0xbf353f35,0x3ec4bf6d,0x3e48bf7b,0x3e953f75,0x3f0e3f55,0xbf62bef1,0xbec4bf6d,0x3f553f0e,0x3f6dbec4,0xbf0e3f55,0xbf55bf0e,0x3f7fbdc9,0xbe48bf7b,0x3f463f22
.long 0xbf800000,0x3f35bf35,0xbf800000,0x3f35bf35,0xbf553f0e,0x3dc9bf7f,0xbe483f7b,0xbf22bf46,0xbec43f6d,0xbf0ebf55,0x3f6d3ec4,0xbf553f0e,0x3e483f7b,0xbf75be95,0x3f0ebf55,0x3ef13f62
.long 0x3f353f35,0xbf6d3ec4,0xbf35bf35,0x3f6dbec4,0x3f7b3e48,0xbef13f62,0xbf553f0e,0xbe95bf75,0x3f6dbec4,0x3e483f7b,0x3ec43f6d,0xbf7b3e48,0x3f0ebf55,0x3f463f22,0x3f7bbe48,0x3dc93f7f
.long 0x3f80,0xbf80,0x3f80,0xbf80,0x3f800000,0xbf7f3dc9,0x3f35bf35,0xbf223f46,0xbf80,0x3e483f7b,0xbf800000,0x3f7bbe48,0xbf800000,0x3f75be95,0x3f353f35,0xbf62bef1
.long 0x3f80,0xbec4bf6d,0xbf80,0x3ec43f6d,0x3f800000,0xbf623ef1,0xbf353f35,0x3e95bf75,0xbf80,0x3f0e3f55,0x3f800000,0xbf553f0e,0xbf800000,0x3f46bf22,0xbf35bf35,0x3f7f3dc9
.long 0x3f80,0xbf35bf35,0x3f80,0xbf35bf35,0x3f800000,0xbf223f46,0x3f35bf35,0x3dc93f7f,0xbf80,0x3f553f0e,0xbf800000,0x3f0ebf55,0xbf800000,0x3ef1bf62,0x3f353f35,0xbf753e95
.long 0x3f80,0xbf6dbec4,0xbf80,0x3f6d3ec4,0x3f800000,0xbe953f75,0xbf353f35,0xbef1bf62,0xbf80,0x3f7b3e48,0x3f800000,0xbe483f7b,0xbf800000,0x3dc9bf7f,0xbf35bf35,0x3f46bf22
.long 0x3f80,0xbf80,0x3f80,0xbf80,0x3f7bbe48,0xbf753e95,0x3f0ebf55,0xbef13f62,0xbec4bf6d,0x3f0e3f55,0xbf6d3ec4,0x3f55bf0e,0xbf553f0e,0x3f22bf46,0x3f7b3e48,0xbf7f3dc9
.long 0x3f353f35,0xbf6dbec4,0xbf35bf35,0x3f6d3ec4,0x3f0ebf55,0xbdc93f7f,0x3e483f7b,0xbf22bf46,0xbf6dbec4,0x3f7bbe48,0x3ec4bf6d,0x3e483f7b,0xbe483f7b,0xbef1bf62,0xbf553f0e,0x3e95bf75
.long 0x3f800000,0xbf353f35,0x3f800000,0xbf353f35,0xbe48bf7b,0x3f623ef1,0xbf55bf0e,0x3f75be95,0xbf6d3ec4,0x3e48bf7b,0x3ec43f6d,0xbf7bbe48,0x3f0e3f55,0xbf7f3dc9,0x3e48bf7b,0x3f463f22
.long 0x3f35bf35,0x3ec43f6d,0xbf353f35,0xbec4bf6d,0xbf55bf0e,0x3f46bf22,0x3f7bbe48,0xbdc93f7f,0xbec43f6d,0xbf55bf0e,0xbf6dbec4,0x3f0ebf55,0x3f7b3e48,0xbe953f75,0x3f0e3f55,0xbf623ef1
.long 0x3f80,0xbf80,0x3f80,0xbf80,0x3f6dbec4,0xbf623ef1,0x3ec4bf6d,0xbe953f75,0xbf35bf35,0x3f553f0e,0xbf353f35,0x3f0ebf55,0xbec43f6d,0x3dc9bf7f,0x3f6dbec4,0xbf463f22
.long 0x3f800000,0xbf6d3ec4,0xbf800000,0x3f6dbec4,0xbec4bf6d,0x3f463f22,0x3f6d3ec4,0xbf7f3dc9,0xbf353f35,0x3e48bf7b,0xbf35bf35,0x3f7b3e48,0x3f6d3ec4,0xbf753e95,0x3ec43f6d,0xbf62bef1
.long 0xbf80,0x3f353f35,0xbf80,0x3f353f35,0xbf6d3ec4,0x3e95bf75,0xbec43f6d,0xbef1bf62,0x3f353f35,0xbf7b3e48,0x3f35bf35,0x3e483f7b,0x3ec4bf6d,0x3f223f46,0xbf6d3ec4,0x3dc9bf7f
.long 0xbf800000,0x3ec4bf6d,0x3f800000,0xbec43f6d,0x3ec43f6d,0xbf7f3dc9,0xbf6dbec4,0x3f22bf46,0x3f35bf35,0x3f0e3f55,0x3f353f35,0xbf553f0e,0xbf6dbec4,0x3ef1bf62,0xbec4bf6d,0x3f75be95
.long 0x3f80,0xbf80,0x3f80,0xbf80,0x3f55bf0e,0xbf463f22,0x3e48bf7b,0xbdc93f7f,0xbf6dbec4,0x3f7b3e48,0xbec43f6d,0x3e48bf7b,0x3e483f7b,0xbef1bf62,0x3f0ebf55,0xbe953f75
.long 0x3f35bf35,0xbec43f6d,0xbf353f35,0x3ec4bf6d,0xbf7bbe48,0x3f75be95,0x3f55bf0e,0xbef13f62,0x3ec43f6d,0xbf55bf0e,0xbf6d3ec4,0x3f0ebf55,0x3f0ebf55,0x3dc93f7f,0x3f7bbe48,0xbf223f46
.long 0xbf800000,0x3f35bf35,0xbf800000,0x3f35bf35,0x3f0e3f55,0xbf7fbdc9,0x3f7b3e48,0xbf463f22,0x3ec4bf6d,0x3f0e3f55,0xbf6dbec4,0x3f55bf0e,0xbf7b3e48,0x3e95bf75,0x3f553f0e,0xbf623ef1
.long 0x3f353f35,0xbf6d3ec4,0xbf35bf35,0x3f6dbec4,0x3e48bf7b,0x3f623ef1,0x3f0e3f55,0xbf753e95,0xbf6d3ec4,0xbe48bf7b,0xbec4bf6d,0x3f7bbe48,0x3f553f0e,0xbf223f46,0x3e483f7b,0xbf7f3dc9
.long 0x3f803f80,0xbf800000,0x3f80,0xbf800000,0xbf803f80,0xbf7f3dc9,0x3f353f35,0xbf223f46,0x3f803f80,0xbf7b3e48,0x3f800000,0x3e483f7b,0xbf803f80,0xbf753e95,0x3f35bf35,0x3f623ef1
.long 0x3f803f80,0xbf6d3ec4,0xbf80,0x3f6dbec4,0xbf803f80,0xbf623ef1,0xbf35bf35,0x3e95bf75,0x3f803f80,0xbf553f0e,0xbf800000,0xbf0ebf55,0xbf803f80,0xbf463f22,0xbf353f35,0xbf7fbdc9
.long 0x3f803f80,0xbf353f35,0x3f80,0xbf353f35,0xbf803f80,0xbf223f46,0x3f353f35,0x3dc93f7f,0x3f803f80,0xbf0e3f55,0x3f800000,0x3f553f0e,0xbf803f80,0xbef13f62,0x3f35bf35,0x3f75be95
.long 0x3f803f80,0xbec43f6d,0xbf80,0x3ec4bf6d,0xbf803f80,0xbe953f75,0xbf35bf35,0xbef1bf62,0x3f803f80,0xbe483f7b,0xbf800000,0xbf7bbe48,0xbf803f80,0xbdc93f7f,0xbf353f35,0xbf463f22
.long 0xbf80,0x3f800000,0xbf80,0x3f800000,0xbe48bf7b,0x3f75be95,0xbf55bf0e,0x3ef1bf62,0xbec4bf6d,0x3f55bf0e,0xbf6d3ec4,0xbf0ebf55,0xbf0ebf55,0x3f22bf46,0xbe483f7b,0xbf7f3dc9
.long 0xbf35bf35,0x3ec4bf6d,0x3f353f35,0xbec43f6d,0xbf55bf0e,0x3dc9bf7f,0x3f7bbe48,0x3f223f46,0xbf6dbec4,0xbe48bf7b,0x3ec4bf6d,0x3f7bbe48,0xbf7bbe48,0xbef1bf62,0xbf0ebf55,0x3e95bf75
.long 0xbf800000,0xbf35bf35,0xbf800000,0xbf35bf35,0xbf7b3e48,0xbf62bef1,0xbf0e3f55,0xbf753e95,0xbf6d3ec4,0xbf7bbe48,0x3ec43f6d,0xbe483f7b,0xbf553f0e,0xbf7f3dc9,0x3f7b3e48,0x3f463f22
.long 0xbf353f35,0xbf6d3ec4,0x3f35bf35,0x3f6dbec4,0xbf0e3f55,0xbf463f22,0xbe48bf7b,0x3dc9bf7f,0xbec43f6d,0xbf0e3f55,0xbf6dbec4,0xbf55bf0e,0xbe483f7b,0xbe953f75,0xbf553f0e,0xbf623ef1
.long 0x3f80,0xbf800000,0x3f80,0xbf800000,0x3ec43f6d,0xbf623ef1,0x3f6d3ec4,0xbe953f75,0x3f353f35,0xbf0e3f55,0x3f35bf35,0x3f553f0e,0x3f6d3ec4,0xbdc93f7f,0xbec4bf6d,0x3f46bf22
.long 0x3f800000,0x3ec43f6d,0xbf800000,0xbec4bf6d,0x3f6dbec4,0x3f463f22,0xbec43f6d,0xbf7f3dc9,0x3f35bf35,0x3f7b3e48,0x3f353f35,0xbe483f7b,0x3ec4bf6d,0x3f75be95,0x3f6dbec4,0x3f623ef1
.long 0xbf80,0x3f35bf35,0xbf80,0x3f35bf35,0xbec4bf6d,0x3e95bf75,0xbf6dbec4,0xbef1bf62,0xbf35bf35,0xbe48bf7b,0xbf353f35,0xbf7b3e48,0xbf6dbec4,0xbf22bf46,0x3ec43f6d,0xbdc93f7f
.long 0xbf800000,0xbf6dbec4,0x3f800000,0x3f6d3ec4,0xbf6d3ec4,0xbf7f3dc9,0x3ec4bf6d,0x3f22bf46,0xbf353f35,0xbf553f0e,0xbf35bf35,0xbf0ebf55,0xbec43f6d,0xbef13f62,0xbf6d3ec4,0xbf753e95
.long 0xbf80,0x3f800000,0xbf80,0x3f800000,0xbf0ebf55,0x3f46bf22,0xbf7bbe48,0x3dc9bf7f,0xbf6dbec4,0x3e48bf7b,0xbec43f6d,0xbf7bbe48,0xbf7b3e48,0xbef1bf62,0x3f553f0e,0xbe953f75
.long 0xbf353f35,0xbf6dbec4,0x3f35bf35,0x3f6d3ec4,0xbe483f7b,0xbf753e95,0xbf0ebf55,0x3ef1bf62,0x3ec43f6d,0xbf0e3f55,0xbf6d3ec4,0xbf55bf0e,0x3f553f0e,0x3dc93f7f,0x3e483f7b,0xbf223f46
.long 0x3f800000,0x3f353f35,0x3f800000,0x3f353f35,0x3f55bf0e,0x3f7f3dc9,0x3e48bf7b,0x3f46bf22,0x3ec4bf6d,0x3f55bf0e,0xbf6dbec4,0xbf0ebf55,0xbe48bf7b,0x3e95bf75,0xbf0e3f55,0xbf623ef1
.long 0xbf35bf35,0xbec4bf6d,0x3f353f35,0x3ec43f6d,0xbf7bbe48,0xbf62bef1,0x3f55bf0e,0x3f75be95,0xbf6d3ec4,0xbf7b3e48,0xbec4bf6d,0xbe48bf7b,0xbf0e3f55,0xbf223f46,0xbf7b3e48,0xbf7f3dc9
.long 0x3f80,0xbf800000,0x3f80,0xbf800000,0x3f800000,0x3dc93f7f,0x3f35bf35,0x3f463f22,0xbf80,0x3f7bbe48,0xbf800000,0xbe48bf7b,0xbf800000,0xbe95bf75,0x3f353f35,0xbef13f62
.long 0x3f80,0xbf6d3ec4,0xbf80,0x3f6dbec4,0x3f800000,0x3ef13f62,0xbf353f35,0xbf75be95,0xbf80,0x3f55bf0e,0x3f800000,0x3f0e3f55,0xbf800000,0xbf22bf46,0xbf35bf35,0x3dc9bf7f
.long 0x3f80,0xbf353f35,0x3f80,0xbf353f35,0x3f800000,0x3f463f22,0x3f35bf35,0x3f7fbdc9,0xbf80,0x3f0ebf55,0xbf800000,0xbf55bf0e,0xbf800000,0xbf62bef1,0x3f353f35,0x3e953f75
.long 0x3f80,0xbec43f6d,0xbf80,0x3ec4bf6d,0x3f800000,0x3f753e95,0xbf353f35,0xbf623ef1,0xbf80,0x3e48bf7b,0x3f800000,0x3f7b3e48,0xbf800000,0xbf7fbdc9,0xbf35bf35,0xbf22bf46
.long 0xbf80,0x3f800000,0xbf80,0x3f800000,0xbf7b3e48,0xbe95bf75,0xbf0e3f55,0xbf62bef1,0x3ec43f6d,0xbf553f0e,0x3f6dbec4,0x3f0e3f55,0x3f55bf0e,0x3f463f22,0xbf7bbe48,0xbdc9bf7f
.long 0xbf35bf35,0x3ec4bf6d,0x3f353f35,0xbec43f6d,0xbf0e3f55,0xbf7fbdc9,0xbe48bf7b,0x3f46bf22,0x3f6d3ec4,0x3e483f7b,0xbec43f6d,0xbf7b3e48,0x3e48bf7b,0x3f62bef1,0x3f55bf0e,0x3f753e95
.long 0xbf800000,0xbf35bf35,0xbf800000,0xbf35bf35,0x3e483f7b,0xbef13f62,0x3f553f0e,0x3e953f75,0x3f6dbec4,0x3f7b3e48,0xbec4bf6d,0x3e48bf7b,0xbf0ebf55,0xbdc9bf7f,0xbe483f7b,0xbf223f46
.long 0xbf353f35,0xbf6d3ec4,0x3f35bf35,0x3f6dbec4,0x3f553f0e,0x3f223f46,0xbf7b3e48,0xbf7fbdc9,0x3ec4bf6d,0x3f0ebf55,0x3f6d3ec4,0x3f553f0e,0xbf7bbe48,0xbf75be95,0xbf0ebf55,0xbef1bf62
.long 0x3f80,0xbf800000,0x3f80,0xbf800000,0x3f6dbec4,0x3ef13f62,0x3ec4bf6d,0x3f753e95,0xbf35bf35,0x3f0ebf55,0xbf353f35,0xbf55bf0e,0xbec43f6d,0xbf7fbdc9,0x3f6dbec4,0x3f223f46
.long 0x3f800000,0x3ec43f6d,0xbf800000,0xbec4bf6d,0xbec4bf6d,0x3f22bf46,0x3f6d3ec4,0x3dc93f7f,0xbf353f35,0xbf7bbe48,0xbf35bf35,0x3e48bf7b,0x3f6d3ec4,0x3e953f75,0x3ec43f6d,0xbef13f62
.long 0xbf80,0x3f35bf35,0xbf80,0x3f35bf35,0xbf6d3ec4,0xbf75be95,0xbec43f6d,0xbf623ef1,0x3f353f35,0x3e483f7b,0x3f35bf35,0x3f7bbe48,0x3ec4bf6d,0x3f46bf22,0xbf6d3ec4,0xbf7fbdc9
.long 0xbf800000,0xbf6dbec4,0x3f800000,0x3f6d3ec4,0x3ec43f6d,0x3dc93f7f,0xbf6dbec4,0xbf46bf22,0x3f35bf35,0x3f55bf0e,0x3f353f35,0x3f0e3f55,0xbf6dbec4,0xbf62bef1,0xbec4bf6d,0xbe95bf75
.long 0xbf80,0x3f800000,0xbf80,0x3f800000,0xbf553f0e,0xbf22bf46,0xbe483f7b,0xbf7fbdc9,0x3f6d3ec4,0xbe483f7b,0x3ec4bf6d,0x3f7b3e48,0xbe48bf7b,0x3f62bef1,0xbf0e3f55,0xbf75be95
.long 0xbf353f35,0xbf6dbec4,0x3f35bf35,0x3f6d3ec4,0x3f7b3e48,0x3e953f75,0xbf553f0e,0xbf62bef1,0xbec4bf6d,0x3f0ebf55,0x3f6dbec4,0x3f553f0e,0xbf0e3f55,0xbf7f3dc9,0xbf7b3e48,0xbf46bf22
.long 0x3f800000,0x3f353f35,0x3f800000,0x3f353f35,0xbf0ebf55,0x3dc9bf7f,0xbf7bbe48,0xbf22bf46,0xbec43f6d,0xbf553f0e,0x3f6d3ec4,0x3f0e3f55,0x3f7bbe48,0x3f753e95,0xbf55bf0e,0xbef1bf62
.long 0xbf35bf35,0xbec4bf6d,0x3f353f35,0x3ec43f6d,0xbe483f7b,0xbef13f62,0xbf0ebf55,0xbe95bf75,0x3f6dbec4,0x3f7bbe48,0x3ec43f6d,0x3e483f7b,0xbf55bf0e,0xbf46bf22,0xbe48bf7b,0xbdc9bf7f
.long 320,128,1664,1472,3600,144,3600,1488,3616,160,3616,1504,3632,176,3632,1520
.long 3648,192,3648,1536,3664,208,3664,1552,3680,224,3680,1568,3696,240,3696,1584
.long 0,256,1344,1600,16,272,1360,1616,32,288,1376,1632,48,304,1392,1648
.long 64,3776,1408,3776,80,3792,1424,3792,96,3808,1440,3808,112,3824,1456,3824
.long 656,464,2000,3584,3600,480,3600,3600,3616,496,3616,3616,3632,512,3632,3632
.long 3648,528,3648,3648,3664,544,3664,3664,3680,560,3680,3680,3696,576,3696,3696
.long 336,592,3712,3712,352,608,3728,3728,368,624,3744,3744,384,640,3760,3760
.long 400,3776,3776,1680,416,3792,3792,1696,432,3808,3808,1712,448,3824,3824,1728
.long 992,800,2336,3584,3600,816,3600,3600,3616,832,3616,3616,3632,848,3632,3632
.long 3648,864,3648,3648,3664,880,3664,3664,3680,896,3680,3680,3696,912,3696,3696
.long 672,928,3712,3712,688,944,3728,3728,704,960,3744,3744,720,976,3760,3760
.long 736,3776,3776,2016,752,3792,3792,2032,768,3808,3808,2048,784,3824,3824,2064
.long 1328,1136,2672,3584,3600,1152,3600,3600,3616,1168,3616,3616,3632,1184,3632,3632
.long 3648,1200,3648,3648,3664,1216,3664,3664,3680,1232,3680,3680,3696,1248,3696,3696
.long 1008,1264,3712,3712,1024,1280,3728,3728,1040,1296,3744,3744,1056,1312,3760,3760
.long 1072,3776,3776,2352,1088,3792,3792,2368,1104,3808,3808,2384,1120,3824,3824,2400
.long 3584,3008,3584,2752,3600,3600,3600,2768,3616,3616,3616,2784,3632,3632,3632,2800
.long 3648,3648,3648,2816,3664,3664,3664,2832,3680,3680,3680,2848,3696,3696,3696,2864
.long 3712,3712,3712,2880,3728,3728,3728,2896,3744,3744,3744,2912,3760,3760,3760,2928
.long 3776,3776,2688,2944,3792,3792,2704,2960,3808,3808,2720,2976,3824,3824,2736,2992
.long 1744,3344,3584,3088,1760,3600,3600,3104,1776,3616,3616,3120,1792,3632,3632,3136
.long 1808,3648,3648,3152,1824,3664,3664,3168,1840,3680,3680,3184,1856,3696,3696,3200
.long 1872,3712,3712,3216,1888,3728,3728,3232,1904,3744,3744,3248,1920,3760,3760,3264
.long 1936,3776,3024,3280,1952,3792,3040,3296,1968,3808,3056,3312,1984,3824,3072,3328
.long 2080,3584,3584,3584,2096,3600,3600,3600,2112,3616,3616,3616,2128,3632,3632,3632
.long 2144,3648,3648,3648,2160,3664,3664,3664,2176,3680,3680,3680,2192,3696,3696,3696
.long 2208,3712,3712,3712,2224,3728,3728,3728,2240,3744,3744,3744,2256,3760,3760,3760
.long 2272,3776,3776,3776,2288,3792,3792,3792,2304,3808,3808,3808,2320,3824,3824,3824
.long 2416,3584,3584,3584,2432,3600,3600,3600,2448,3616,3616,3616,2464,3632,3632,3632
.long 2480,3648,3648,3648,2496,3664,3664,3664,2512,3680,3680,3680,2528,3696,3696,3696
.long 2544,3712,3712,3712,2560,3728,3728,3728,2576,3744,3744,3744,2592,3760,3760,3760
.long 2608,3776,3776,3776,2624,3792,3792,3792,2640,3808,3808,3808,2656,3824,3824,3824
.noaltmacro
.size tab_base,854016
```
